```python
import torch

def _softmax(x, axis=-1):
    return torch.softmax(x, dim=axis)
def _gelu(x):
    return torch.nn.functional.gelu(x, approximate="tanh")
def _silu(x):
    return torch.nn.functional.silu(x)
def _sigmoid(x):
    return torch.sigmoid(x)
def _layernorm(x, axis=-1, eps=1e-5):
    m = x.mean(dim=axis, keepdim=True)
    v = x.var(dim=axis, keepdim=True, unbiased=False)
    return (x - m) / torch.sqrt(v + eps)
def _scatter_add(tgt, idx, src, axis=0):
    return tgt.clone().index_add_(axis, idx, src)
def _segment_sum(src, seg, n):
    out = torch.zeros((n,) + src.shape[1:], dtype=src.dtype)
    return out.index_add_(0, seg, src)
def _pad(x, pw):
    flat = tuple(v for pair in reversed(pw) for v in pair)
    return torch.nn.functional.pad(x, flat)

kernel_name = 'parallel_sum__linear_kernel_hedgehog__glu_gated_swiglu__prompt'

def setup_inputs():

    _w = (lambda a: (lambda t: t.to(torch.bfloat16) if t.is_floating_point() else t)(torch.as_tensor(a)))
    def _A_setup():
        B, S, D, H = 1, 2048, 512, 32
        Dh = D // H
        return {
            "x": _w((lambda *s: torch.randn(*s, dtype=torch.bfloat16) * 0.05)(B, S, D)),
            "wqkv": _w((lambda *s: torch.randn(*s, dtype=torch.bfloat16) * 0.2)(D, 3 * D)),
            "w_phi": _w((lambda *s: torch.randn(*s, dtype=torch.bfloat16) * 0.2)(H, Dh, Dh) * (Dh ** -0.5)),
            "wo": _w((lambda *s: torch.randn(*s, dtype=torch.bfloat16) * 0.05)(D, D)),
        }
    _A_in = _A_setup()

    def _B_setup():
        B, S, D, F = 1, 2048, 512, 1376
        return {
            "x": _w((lambda *s: torch.randn(*s, dtype=torch.bfloat16) * 0.05)(B, S, D)),
            "w1": _w((lambda *s: torch.randn(*s, dtype=torch.bfloat16) * 0.4)(D, F) * (2.0 / D) ** 0.5),
            "w3": _w((lambda *s: torch.randn(*s, dtype=torch.bfloat16) * 0.4)(D, F) * (2.0 / D) ** 0.5),
            "w2": _w((lambda *s: torch.randn(*s, dtype=torch.bfloat16) * 0.4)(F, D) * (2.0 / F) ** 0.5),
        }
    _B_in = _B_setup()

    return {
        "A_x": _A_in["x"],
        "A_wqkv": _A_in["wqkv"],
        "A_w_phi": _A_in["w_phi"],
        "A_wo": _A_in["wo"],
        "B_x": _B_in["x"],
        "B_w1": _B_in["w1"],
        "B_w3": _B_in["w3"],
        "B_w2": _B_in["w2"],
    }

def reference(A_x, A_wqkv, A_w_phi, A_wo, B_x, B_w1, B_w3, B_w2):
    def _A_ref(x, wqkv, w_phi, wo):
        B, S, D = x.shape
        H = 32; Dh = D // H
        qkv = (lambda x, *d: x.permute(*d))((x @ wqkv).reshape(B, S, 3, H, Dh), 2, 0, 3, 1, 4)
        q, k, v = qkv[0], qkv[1], qkv[2]
        pq = torch.einsum("bhsd,hdf->bhsf", q, w_phi)
        pk = torch.einsum("bhsd,hdf->bhsf", k, w_phi)
        phi_q = torch.concatenate([_softmax(pq, axis=-1), _softmax(-pq, axis=-1)], axis=-1)
        phi_k = torch.concatenate([_softmax(pk, axis=-1), _softmax(-pk, axis=-1)], axis=-1)
        kv = torch.einsum("bhsf,bhsd->bhfd", phi_k, v)
        z  = torch.einsum("bhsf->bhf", phi_k)
        num = torch.einsum("bhqf,bhfd->bhqd", phi_q, kv)
        den = torch.einsum("bhqf,bhf->bhq", phi_q, z)[..., None] + 1e-6
        o = num / den
        return (lambda x, *d: x.permute(*d))(o, 0, 2, 1, 3).reshape(B, S, D) @ wo

    def _B_ref(x, w1, w3, w2):
        gate = torch.einsum("bsd,df->bsf", x, w1)
        up = torch.einsum("bsd,df->bsf", x, w3)
        h = _silu(gate) * up
        out = torch.einsum("bsf,fd->bsd", h, w2)
        return out

    x = A_x
    xn = _layernorm(x, axis=-1)
    return x + _A_ref(xn, A_wqkv, A_w_phi, A_wo) + _B_ref(xn, B_w1, B_w3, B_w2)
```

```asm
; @launch grid=(256,1,1) block=(512,1,1) lds=163840
.amdgcn_target "amdgcn-amd-amdhsa--gfx950"
.text
.globl parallel_sum__linear_kernel_hedgehog__glu_gated_swiglu__prompt_kernel
.p2align 8
.type parallel_sum__linear_kernel_hedgehog__glu_gated_swiglu__prompt_kernel,@function
parallel_sum__linear_kernel_hedgehog__glu_gated_swiglu__prompt_kernel:
    s_cmp_ge_u32 s2, 256
    s_cbranch_scc1 k_end
    s_load_dwordx4 s[4:7], s[0:1], 0
    s_load_dwordx4 s[12:15], s[0:1], 40
    s_load_dwordx4 s[8:11], s[0:1], 16
    s_load_dwordx4 s[16:19], s[0:1], 56
    s_load_dwordx4 s[20:23], s[0:1], 72
    v_mov_b32 v1, v0
    v_lshrrev_b32 v2, 6, v0
    v_and_b32 v0, 63, v0
    v_readfirstlane_b32 s68, v2
    v_lshlrev_b32 v4, 4, v0
    s_lshr_b32 s69, s2, 3
    s_and_b32 s70, s2, 3
    s_bfe_u32 s71, s2, 0x10002
    s_getpc_b64 s[96:97]
    s_lshl_b32 s78, s69, 3
    s_add_u32 s78, s78, s68
    s_lshl_b32 s78, s78, 9
    s_add_u32 s96, s96, s78
    s_addc_u32 s97, s97, 0
    v_and_b32 v5, 3, v0
    v_lshlrev_b32 v5, 7, v5
    s_mov_b32 m0, 161792
    s_nop 0
    global_load_lds_dword v5, s[96:97]
    s_cmp_ge_u32 s69, 28
    s_cbranch_scc1 k1_q
    s_cmp_ge_u32 s69, 20
    s_cbranch_scc1 k1_kv
k1_ffn:
    s_and_b32 s78, s69, 3
    s_lshl_b32 s72, s70, 2
    s_add_u32 s72, s72, s78
    s_lshr_b32 s78, s69, 2
    s_mul_i32 s73, s71, 5
    s_add_u32 s73, s73, s78
    s_lshl_b32 s79, s72, 17
    s_mul_i32 s91, s73, 288
    s_cmp_lt_u32 s68, 4
    s_cbranch_scc1 k1_ffn_c
    s_sub_u32 s74, s68, 4
    s_lshr_b32 s62, s69, 2
    s_add_u32 s62, s62, s69
    v_lshrrev_b32 v8, 3, v0
    v_and_b32 v9, 7, v0
    s_lshl_b32 s78, s74, 3
    v_add_u32 v10, s78, v8
    v_bfe_u32 v11, v10, 1, 3
    v_xor_b32 v11, v11, v9
    v_lshlrev_b32 v11, 4, v11
    v_lshl_add_u32 v16, v10, 10, v11
    s_lshl_b32 s77, s74, 10
    s_and_b32 s78, s74, 1
    s_mul_i32 s81, s78, 9216
    s_mul_i32 s78, s78, 88064
    s_add_u32 s91, s91, s78
    s_lshr_b32 s78, s74, 1
    s_mul_i32 s78, s78, 18560
    s_add_u32 s81, s81, s78
    s_mov_b32 s80, 2752
    s_mov_b32 s78, 3641
    s_waitcnt lgkmcnt(0)
    s_add_u32 s24, s4, s79
    s_addc_u32 s25, s5, 0
    s_and_b32 s25, s25, 0xffff
    s_mov_b32 s26, 131072
    s_mov_b32 s27, 0x20000
    s_bitcmp1_b32 s74, 1
    s_cselect_b32 s28, s14, s12
    s_cselect_b32 s29, s15, s13
    s_and_b32 s29, s29, 0xffff
    s_mov_b32 s30, 1409024
    s_mov_b32 s31, 0x20000
    s_mov_b32 s44, s4
    s_and_b32 s45, s5, 0xffff
    s_mov_b32 s46, 2097152
    s_mov_b32 s47, 0x20000
    s_lshl_b32 s85, s2, 2
    s_add_u32 s85, s85, s74
    s_lshl_b32 s78, s85, 11
    buffer_load_dwordx4 v[28:31], v4, s[44:47], s78 offen
    buffer_load_dwordx4 v[32:35], v4, s[44:47], s78 offen offset:1024
    s_and_b32 s78, s62, 0
    s_xor_b32 s78, s78, 0
    s_lshl_b32 s63, s78, 7
    s_mul_i32 s87, s78, 176128
    s_add_u32 m0, s77, 0
    s_add_u32 s78, s63, 0
    buffer_load_dwordx4 v16, s[24:27], s78 offen lds
    s_add_u32 m0, s77, 4096
    s_add_u32 s78, s63, 32768
    buffer_load_dwordx4 v16, s[24:27], s78 offen lds
    s_add_u32 m0, s77, 8192
    s_add_u32 s78, s63, 65536
    buffer_load_dwordx4 v16, s[24:27], s78 offen lds
    s_add_u32 m0, s77, 12288
    s_add_u32 s78, s63, 98304
    buffer_load_dwordx4 v16, s[24:27], s78 offen lds
    v_add_u32 v12, 0, v0
    v_mul_u32_u24 v13, 3641, v12
    v_lshrrev_b32 v13, 16, v13
    v_mul_u32_u24 v14, 18, v13
    v_sub_u32 v14, v12, v14
    v_lshlrev_b32 v14, 4, v14
    v_mad_u32_u24 v17, v13, s80, v14
    v_add_u32 v17, s91, v17
    s_add_u32 m0, s81, 16384
    s_add_u32 s78, s87, 0
    buffer_load_dwordx4 v17, s[28:31], s78 offen lds
    v_add_u32 v12, 64, v0
    v_mul_u32_u24 v13, 3641, v12
    v_lshrrev_b32 v13, 16, v13
    v_mul_u32_u24 v14, 18, v13
    v_sub_u32 v14, v12, v14
    v_lshlrev_b32 v14, 4, v14
    v_mad_u32_u24 v18, v13, s80, v14
    v_add_u32 v18, s91, v18
    s_add_u32 m0, s81, 17408
    s_add_u32 s78, s87, 0
    buffer_load_dwordx4 v18, s[28:31], s78 offen lds
    v_add_u32 v12, 128, v0
    v_mul_u32_u24 v13, 3641, v12
    v_lshrrev_b32 v13, 16, v13
    v_mul_u32_u24 v14, 18, v13
    v_sub_u32 v14, v12, v14
    v_lshlrev_b32 v14, 4, v14
    v_mad_u32_u24 v19, v13, s80, v14
    v_add_u32 v19, s91, v19
    s_add_u32 m0, s81, 18432
    s_add_u32 s78, s87, 0
    buffer_load_dwordx4 v19, s[28:31], s78 offen lds
    v_add_u32 v12, 192, v0
    v_mul_u32_u24 v13, 3641, v12
    v_lshrrev_b32 v13, 16, v13
    v_mul_u32_u24 v14, 18, v13
    v_sub_u32 v14, v12, v14
    v_lshlrev_b32 v14, 4, v14
    v_mad_u32_u24 v20, v13, s80, v14
    v_add_u32 v20, s91, v20
    s_add_u32 m0, s81, 19456
    s_add_u32 s78, s87, 0
    buffer_load_dwordx4 v20, s[28:31], s78 offen lds
    v_add_u32 v12, 256, v0
    v_mul_u32_u24 v13, 3641, v12
    v_lshrrev_b32 v13, 16, v13
    v_mul_u32_u24 v14, 18, v13
    v_sub_u32 v14, v12, v14
    v_lshlrev_b32 v14, 4, v14
    v_mad_u32_u24 v21, v13, s80, v14
    v_add_u32 v21, s91, v21
    s_add_u32 m0, s81, 20480
    s_add_u32 s78, s87, 0
    buffer_load_dwordx4 v21, s[28:31], s78 offen lds
    v_add_u32 v12, 320, v0
    v_mul_u32_u24 v13, 3641, v12
    v_lshrrev_b32 v13, 16, v13
    v_mul_u32_u24 v14, 18, v13
    v_sub_u32 v14, v12, v14
    v_lshlrev_b32 v14, 4, v14
    v_mad_u32_u24 v22, v13, s80, v14
    v_add_u32 v22, s91, v22
    s_add_u32 m0, s81, 21504
    s_add_u32 s78, s87, 0
    buffer_load_dwordx4 v22, s[28:31], s78 offen lds
    v_add_u32 v12, 384, v0
    v_mul_u32_u24 v13, 3641, v12
    v_lshrrev_b32 v13, 16, v13
    v_mul_u32_u24 v14, 18, v13
    v_sub_u32 v14, v12, v14
    v_lshlrev_b32 v14, 4, v14
    v_mad_u32_u24 v23, v13, s80, v14
    v_add_u32 v23, s91, v23
    s_add_u32 m0, s81, 22528
    s_add_u32 s78, s87, 0
    buffer_load_dwordx4 v23, s[28:31], s78 offen lds
    v_add_u32 v12, 448, v0
    v_mul_u32_u24 v13, 3641, v12
    v_lshrrev_b32 v13, 16, v13
    v_mul_u32_u24 v14, 18, v13
    v_sub_u32 v14, v12, v14
    v_lshlrev_b32 v14, 4, v14
    v_mad_u32_u24 v24, v13, s80, v14
    v_add_u32 v24, s91, v24
    s_add_u32 m0, s81, 23552
    s_add_u32 s78, s87, 0
    buffer_load_dwordx4 v24, s[28:31], s78 offen lds
    v_add_u32 v12, 512, v0
    v_mul_u32_u24 v13, 3641, v12
    v_lshrrev_b32 v13, 16, v13
    v_mul_u32_u24 v14, 18, v13
    v_sub_u32 v14, v12, v14
    v_lshlrev_b32 v14, 4, v14
    v_mad_u32_u24 v25, v13, s80, v14
    v_add_u32 v25, s91, v25
    s_add_u32 m0, s81, 24576
    s_add_u32 s78, s87, 0
    buffer_load_dwordx4 v25, s[28:31], s78 offen lds
    s_lshl_b32 s92, s70, 1
    s_add_u32 s92, s92, s71
    s_mov_b32 s64, s20
    s_and_b32 s65, s21, 0xffff
    s_mov_b32 s66, 256
    s_mov_b32 s67, 0x20000
    s_add_u32 s56, s22, 11534336
    s_addc_u32 s57, s23, 0
    s_and_b32 s57, s57, 0xffff
    s_mov_b32 s58, 81920
    s_mov_b32 s59, 0x20000
    s_and_b32 s93, s69, 3
    s_lshr_b32 s94, s69, 2
    s_mul_i32 s95, s94, 1
    s_mul_i32 s78, s93, 6
    s_add_u32 s95, s95, s78
    s_sub_u32 s78, s95, 22
    s_cmp_ge_u32 s95, 22
    s_cselect_b32 s95, s78, s95
    s_add_u32 s96, s95, 0
    s_sub_u32 s78, s96, 22
    s_cmp_ge_u32 s96, 22
    s_cselect_b32 s96, s78, s96
    s_lshl_b32 s95, s95, 12
    s_lshl_b32 s96, s96, 16
    s_lshl_b32 s78, s92, 2
    s_add_u32 s93, s93, s78
    s_mul_i32 s97, s74, 8192
    s_add_u32 s97, s97, 114944
    s_mul_i32 s60, s74, 12288
    s_add_u32 s60, s60, 0
    s_mul_i32 s61, s74, 10240
    s_add_u32 s61, s61, 53376
    s_add_u32 s48, s22, 9437184
    s_addc_u32 s49, s23, 0
    s_and_b32 s49, s49, 0xffff
    s_mov_b32 s50, 2097152
    s_mov_b32 s51, 0x20000
    s_lshl_b32 s78, s92, 3
    s_lshl_b32 s79, s74, 1
    s_add_u32 s78, s78, s79
    s_lshl_b32 s90, s78, 15
    s_add_u32 s91, s90, 32768
    s_lshl_b32 s89, s69, 10
    s_mov_b32 s36, s8
    s_and_b32 s37, s9, 0xffff
    s_mov_b32 s38, 16384
    s_mov_b32 s39, 0x20000
    s_mov_b32 s78, 0x10000
    s_lshr_b32 s79, s89, 1
    s_cmp_eq_u32 s74, 0
    s_cselect_b32 s78, s79, s78
    s_lshl_b32 s79, s74, 9
    s_add_u32 m0, s79, 160256
    s_cmp_lt_u32 s74, 1
    s_cselect_b32 exec_lo, -1, 1
    s_mov_b32 exec_hi, 0
    s_cselect_b32 m0, m0, 163840
    s_nop 0
    buffer_load_dwordx4 v4, s[36:39], s78 offen lds
    s_mov_b64 exec, -1
    v_mov_b32 v44, 0xffff0000
    v_mov_b32 v7, 0
    v_mov_b32 v6, 1
    v_mov_b32 v5, 163776
    v_mov_b32 v36, -1
    v_mov_b32 v37, -1
    v_mov_b32 v38, -1
    v_mov_b32 v39, -1
    ds_write_b32 v5, v7 offset:0
    ds_write_b32 v5, v7 offset:4
    ds_write_b32 v5, v7 offset:8
    ds_write_b32 v5, v7 offset:12
    ds_write_b32 v5, v7 offset:16
    ds_write_b32 v5, v7 offset:32
    ds_write_b32 v5, v7 offset:36
    ds_write_b32 v5, v7 offset:40
    ds_write_b32 v5, v7 offset:44
    ds_write_b32 v5, v7 offset:48
    ds_write_b32 v5, v7 offset:52
    ds_write_b32 v5, v7 offset:56
    ds_write_b32 v5, v7 offset:60
    s_waitcnt lgkmcnt(0)
    s_and_b32 s78, s62, 0
    s_xor_b32 s78, s78, 1
    s_lshl_b32 s63, s78, 7
    s_mul_i32 s87, s78, 176128
    s_add_u32 m0, s77, 53376
    s_add_u32 s78, s63, 0
    buffer_load_dwordx4 v16, s[24:27], s78 offen lds
    s_add_u32 m0, s77, 57472
    s_add_u32 s78, s63, 32768
    buffer_load_dwordx4 v16, s[24:27], s78 offen lds
    s_add_u32 m0, s77, 61568
    s_add_u32 s78, s63, 65536
    buffer_load_dwordx4 v16, s[24:27], s78 offen lds
    s_add_u32 m0, s77, 65664
    s_add_u32 s78, s63, 98304
    buffer_load_dwordx4 v16, s[24:27], s78 offen lds
    s_add_u32 m0, s81, 69760
    s_add_u32 s78, s87, 0
    buffer_load_dwordx4 v17, s[28:31], s78 offen lds
    s_add_u32 m0, s81, 70784
    s_add_u32 s78, s87, 0
    buffer_load_dwordx4 v18, s[28:31], s78 offen lds
    s_add_u32 m0, s81, 71808
    s_add_u32 s78, s87, 0
    buffer_load_dwordx4 v19, s[28:31], s78 offen lds
    s_add_u32 m0, s81, 72832
    s_add_u32 s78, s87, 0
    buffer_load_dwordx4 v20, s[28:31], s78 offen lds
    s_add_u32 m0, s81, 73856
    s_add_u32 s78, s87, 0
    buffer_load_dwordx4 v21, s[28:31], s78 offen lds
    s_add_u32 m0, s81, 74880
    s_add_u32 s78, s87, 0
    buffer_load_dwordx4 v22, s[28:31], s78 offen lds
    s_add_u32 m0, s81, 75904
    s_add_u32 s78, s87, 0
    buffer_load_dwordx4 v23, s[28:31], s78 offen lds
    s_add_u32 m0, s81, 76928
    s_add_u32 s78, s87, 0
    buffer_load_dwordx4 v24, s[28:31], s78 offen lds
    s_add_u32 m0, s81, 77952
    s_add_u32 s78, s87, 0
    buffer_load_dwordx4 v25, s[28:31], s78 offen lds
    s_waitcnt vmcnt(14)
    s_barrier
    s_waitcnt vmcnt(14)
    v_lshlrev_b32 v8, 16, v28
    v_lshlrev_b32 v10, 16, v32
    v_and_b32 v9, v44, v28
    v_and_b32 v11, v44, v32
    v_add_f32 v40, v8, v9
    v_add_f32 v42, v10, v11
    v_mul_f32 v41, v8, v8
    v_mul_f32 v43, v10, v10
    v_fmac_f32 v41, v9, v9
    v_fmac_f32 v43, v11, v11
    v_lshlrev_b32 v8, 16, v29
    v_lshlrev_b32 v10, 16, v33
    v_and_b32 v9, v44, v29
    v_and_b32 v11, v44, v33
    v_add_f32 v40, v40, v8
    v_add_f32 v42, v42, v10
    v_fmac_f32 v41, v8, v8
    v_fmac_f32 v43, v10, v10
    v_add_f32 v40, v40, v9
    v_add_f32 v42, v42, v11
    v_fmac_f32 v41, v9, v9
    v_fmac_f32 v43, v11, v11
    v_lshlrev_b32 v8, 16, v30
    v_lshlrev_b32 v10, 16, v34
    v_and_b32 v9, v44, v30
    v_and_b32 v11, v44, v34
    v_add_f32 v40, v40, v8
    v_add_f32 v42, v42, v10
    v_fmac_f32 v41, v8, v8
    v_fmac_f32 v43, v10, v10
    v_add_f32 v40, v40, v9
    v_add_f32 v42, v42, v11
    v_fmac_f32 v41, v9, v9
    v_fmac_f32 v43, v11, v11
    v_lshlrev_b32 v8, 16, v31
    v_lshlrev_b32 v10, 16, v35
    v_and_b32 v9, v44, v31
    v_and_b32 v11, v44, v35
    v_add_f32 v40, v40, v8
    v_add_f32 v42, v42, v10
    v_fmac_f32 v41, v8, v8
    v_fmac_f32 v43, v10, v10
    v_add_f32 v40, v40, v9
    v_add_f32 v42, v42, v11
    v_fmac_f32 v41, v9, v9
    v_fmac_f32 v43, v11, v11
    v_add_f32 v40, v40, v40 row_ror:8 row_mask:0xf bank_mask:0xf
    v_add_f32 v42, v42, v42 row_ror:8 row_mask:0xf bank_mask:0xf
    v_add_f32 v41, v41, v41 row_ror:8 row_mask:0xf bank_mask:0xf
    v_add_f32 v43, v43, v43 row_ror:8 row_mask:0xf bank_mask:0xf
    v_add_f32 v40, v40, v40 row_ror:4 row_mask:0xf bank_mask:0xf
    v_add_f32 v42, v42, v42 row_ror:4 row_mask:0xf bank_mask:0xf
    v_add_f32 v41, v41, v41 row_ror:4 row_mask:0xf bank_mask:0xf
    v_add_f32 v43, v43, v43 row_ror:4 row_mask:0xf bank_mask:0xf
    v_add_f32 v40, v40, v40 row_ror:2 row_mask:0xf bank_mask:0xf
    v_add_f32 v42, v42, v42 row_ror:2 row_mask:0xf bank_mask:0xf
    v_add_f32 v41, v41, v41 row_ror:2 row_mask:0xf bank_mask:0xf
    v_add_f32 v43, v43, v43 row_ror:2 row_mask:0xf bank_mask:0xf
    v_add_f32 v40, v40, v40 row_ror:1 row_mask:0xf bank_mask:0xf
    v_add_f32 v42, v42, v42 row_ror:1 row_mask:0xf bank_mask:0xf
    v_add_f32 v41, v41, v41 row_ror:1 row_mask:0xf bank_mask:0xf
    v_add_f32 v43, v43, v43 row_ror:1 row_mask:0xf bank_mask:0xf
    v_mov_b32 v8, v40
    v_mov_b32 v10, v42
    v_mov_b32 v9, v41
    v_mov_b32 v11, v43
    v_permlane16_swap_b32 v40, v8
    v_permlane16_swap_b32 v42, v10
    v_permlane16_swap_b32 v41, v9
    v_permlane16_swap_b32 v43, v11
    v_add_f32 v40, v40, v8
    v_add_f32 v42, v42, v10
    v_add_f32 v41, v41, v9
    v_add_f32 v43, v43, v11
    v_mov_b32 v8, v40
    v_mov_b32 v10, v42
    v_mov_b32 v9, v41
    v_mov_b32 v11, v43
    v_permlane32_swap_b32 v40, v8
    v_permlane32_swap_b32 v42, v10
    v_permlane32_swap_b32 v41, v9
    v_permlane32_swap_b32 v43, v11
    v_add_f32 v40, v40, v8
    v_add_f32 v42, v42, v10
    v_add_f32 v41, v41, v9
    v_add_f32 v43, v43, v11
    v_mul_f32 v40, 0xbb000000, v40
    v_mul_f32 v42, 0xbb000000, v42
    v_mul_f32 v41, 0x3b000000, v41
    v_mul_f32 v43, 0x3b000000, v43
    v_fma_f32 v41, -v40, v40, v41
    v_fma_f32 v43, -v42, v42, v43
    v_max_f32 v41, 0, v41
    v_max_f32 v43, 0, v43
    v_add_f32 v41, 0x3727c5ac, v41
    v_add_f32 v43, 0x3727c5ac, v43
    s_lshl_b32 s78, s85, 4
    s_add_u32 s78, s78, 65536
    s_mov_b64 exec, 1
    buffer_store_dwordx2 v[40:41], v7, s[56:59], s78 offen sc1
    buffer_store_dwordx2 v[42:43], v7, s[56:59], s78 offen offset:8 sc1
    s_and_b32 s78, s74, 1
    s_lshl_b32 s3, s72, 1
    s_add_u32 s3, s3, s78
    s_lshl_b32 s3, s3, 6
    s_lshl_b32 s78, s73, 1
    s_add_u32 s3, s3, s78
    s_lshr_b32 s78, s74, 1
    s_add_u32 s3, s3, s78
    s_lshl_b32 s3, s3, 2
    buffer_store_dword v7, v7, s[56:59], s3 offen sc1
    s_mov_b64 exec, -1
    s_add_u32 s78, s90, s89
    buffer_store_dwordx4 v[36:39], v4, s[48:51], s78 offen sc1
    s_add_u32 s78, s91, s89
    buffer_store_dwordx4 v[36:39], v4, s[48:51], s78 offen sc1
    s_and_b32 s78, s62, 1
    s_xor_b32 s78, s78, 2
    s_lshl_b32 s63, s78, 7
    s_mul_i32 s87, s78, 176128
    s_add_u32 m0, s77, 106752
    s_add_u32 s78, s63, 0
    buffer_load_dwordx4 v16, s[24:27], s78 offen lds
    s_add_u32 m0, s77, 110848
    s_add_u32 s78, s63, 32768
    buffer_load_dwordx4 v16, s[24:27], s78 offen lds
    s_add_u32 m0, s77, 114944
    s_add_u32 s78, s63, 65536
    buffer_load_dwordx4 v16, s[24:27], s78 offen lds
    s_add_u32 m0, s77, 119040
    s_add_u32 s78, s63, 98304
    buffer_load_dwordx4 v16, s[24:27], s78 offen lds
    s_add_u32 m0, s81, 123136
    s_add_u32 s78, s87, 0
    buffer_load_dwordx4 v17, s[28:31], s78 offen lds
    s_add_u32 m0, s81, 124160
    s_add_u32 s78, s87, 0
    buffer_load_dwordx4 v18, s[28:31], s78 offen lds
    s_add_u32 m0, s81, 125184
    s_add_u32 s78, s87, 0
    buffer_load_dwordx4 v19, s[28:31], s78 offen lds
    s_add_u32 m0, s81, 126208
    s_add_u32 s78, s87, 0
    buffer_load_dwordx4 v20, s[28:31], s78 offen lds
    s_add_u32 m0, s81, 127232
    s_add_u32 s78, s87, 0
    buffer_load_dwordx4 v21, s[28:31], s78 offen lds
    s_add_u32 m0, s81, 128256
    s_add_u32 s78, s87, 0
    buffer_load_dwordx4 v22, s[28:31], s78 offen lds
    s_add_u32 m0, s81, 129280
    s_add_u32 s78, s87, 0
    buffer_load_dwordx4 v23, s[28:31], s78 offen lds
    s_add_u32 m0, s81, 130304
    s_add_u32 s78, s87, 0
    buffer_load_dwordx4 v24, s[28:31], s78 offen lds
    s_add_u32 m0, s81, 131328
    s_add_u32 s78, s87, 0
    buffer_load_dwordx4 v25, s[28:31], s78 offen lds
    s_waitcnt vmcnt(18)
    s_barrier
    s_and_b32 s78, s62, 1
    s_xor_b32 s78, s78, 3
    s_lshl_b32 s63, s78, 7
    s_mul_i32 s87, s78, 176128
    s_add_u32 m0, s77, 0
    s_add_u32 s78, s63, 0
    buffer_load_dwordx4 v16, s[24:27], s78 offen lds
    s_add_u32 m0, s77, 4096
    s_add_u32 s78, s63, 32768
    buffer_load_dwordx4 v16, s[24:27], s78 offen lds
    s_add_u32 m0, s77, 8192
    s_add_u32 s78, s63, 65536
    buffer_load_dwordx4 v16, s[24:27], s78 offen lds
    s_add_u32 m0, s77, 12288
    s_add_u32 s78, s63, 98304
    buffer_load_dwordx4 v16, s[24:27], s78 offen lds
    s_add_u32 m0, s81, 16384
    s_add_u32 s78, s87, 0
    buffer_load_dwordx4 v17, s[28:31], s78 offen lds
    s_add_u32 m0, s81, 17408
    s_add_u32 s78, s87, 0
    buffer_load_dwordx4 v18, s[28:31], s78 offen lds
    s_add_u32 m0, s81, 18432
    s_add_u32 s78, s87, 0
    buffer_load_dwordx4 v19, s[28:31], s78 offen lds
    s_add_u32 m0, s81, 19456
    s_add_u32 s78, s87, 0
    buffer_load_dwordx4 v20, s[28:31], s78 offen lds
    s_add_u32 m0, s81, 20480
    s_add_u32 s78, s87, 0
    buffer_load_dwordx4 v21, s[28:31], s78 offen lds
    s_add_u32 m0, s81, 21504
    s_add_u32 s78, s87, 0
    buffer_load_dwordx4 v22, s[28:31], s78 offen lds
    s_add_u32 m0, s81, 22528
    s_add_u32 s78, s87, 0
    buffer_load_dwordx4 v23, s[28:31], s78 offen lds
    s_add_u32 m0, s81, 23552
    s_add_u32 s78, s87, 0
    buffer_load_dwordx4 v24, s[28:31], s78 offen lds
    s_add_u32 m0, s81, 24576
    s_add_u32 s78, s87, 0
    buffer_load_dwordx4 v25, s[28:31], s78 offen lds
    s_waitcnt vmcnt(13)
    s_barrier
    s_lshl_b32 s78, s74, 12
    s_and_b32 s79, s2, 15
    s_lshl_b32 s79, s79, 4
    s_add_u32 s78, s78, s79
    s_mov_b64 exec, 1
    buffer_atomic_add v6, v7, s[64:67], s78 offen
    s_mov_b64 exec, -1
    s_and_b32 s78, s62, 3
    s_xor_b32 s78, s78, 4
    s_lshl_b32 s63, s78, 7
    s_mul_i32 s87, s78, 176128
    s_add_u32 m0, s77, 53376
    s_add_u32 s78, s63, 0
    buffer_load_dwordx4 v16, s[24:27], s78 offen lds
    s_add_u32 m0, s77, 57472
    s_add_u32 s78, s63, 32768
    buffer_load_dwordx4 v16, s[24:27], s78 offen lds
    s_add_u32 m0, s77, 61568
    s_add_u32 s78, s63, 65536
    buffer_load_dwordx4 v16, s[24:27], s78 offen lds
    s_add_u32 m0, s77, 65664
    s_add_u32 s78, s63, 98304
    buffer_load_dwordx4 v16, s[24:27], s78 offen lds
    s_add_u32 m0, s81, 69760
    s_add_u32 s78, s87, 0
    buffer_load_dwordx4 v17, s[28:31], s78 offen lds
    s_add_u32 m0, s81, 70784
    s_add_u32 s78, s87, 0
    buffer_load_dwordx4 v18, s[28:31], s78 offen lds
    s_add_u32 m0, s81, 71808
    s_add_u32 s78, s87, 0
    buffer_load_dwordx4 v19, s[28:31], s78 offen lds
    s_add_u32 m0, s81, 72832
    s_add_u32 s78, s87, 0
    buffer_load_dwordx4 v20, s[28:31], s78 offen lds
    s_add_u32 m0, s81, 73856
    s_add_u32 s78, s87, 0
    buffer_load_dwordx4 v21, s[28:31], s78 offen lds
    s_add_u32 m0, s81, 74880
    s_add_u32 s78, s87, 0
    buffer_load_dwordx4 v22, s[28:31], s78 offen lds
    s_add_u32 m0, s81, 75904
    s_add_u32 s78, s87, 0
    buffer_load_dwordx4 v23, s[28:31], s78 offen lds
    s_add_u32 m0, s81, 76928
    s_add_u32 s78, s87, 0
    buffer_load_dwordx4 v24, s[28:31], s78 offen lds
    s_add_u32 m0, s81, 77952
    s_add_u32 s78, s87, 0
    buffer_load_dwordx4 v25, s[28:31], s78 offen lds
    s_waitcnt vmcnt(14)
    s_barrier
    s_and_b32 s78, s62, 3
    s_xor_b32 s78, s78, 5
    s_lshl_b32 s63, s78, 7
    s_mul_i32 s87, s78, 176128
    s_add_u32 m0, s77, 106752
    s_add_u32 s78, s63, 0
    buffer_load_dwordx4 v16, s[24:27], s78 offen lds
    s_add_u32 m0, s77, 110848
    s_add_u32 s78, s63, 32768
    buffer_load_dwordx4 v16, s[24:27], s78 offen lds
    s_add_u32 m0, s77, 114944
    s_add_u32 s78, s63, 65536
    buffer_load_dwordx4 v16, s[24:27], s78 offen lds
    s_add_u32 m0, s77, 119040
    s_add_u32 s78, s63, 98304
    buffer_load_dwordx4 v16, s[24:27], s78 offen lds
    s_add_u32 m0, s81, 123136
    s_add_u32 s78, s87, 0
    buffer_load_dwordx4 v17, s[28:31], s78 offen lds
    s_add_u32 m0, s81, 124160
    s_add_u32 s78, s87, 0
    buffer_load_dwordx4 v18, s[28:31], s78 offen lds
    s_add_u32 m0, s81, 125184
    s_add_u32 s78, s87, 0
    buffer_load_dwordx4 v19, s[28:31], s78 offen lds
    s_add_u32 m0, s81, 126208
    s_add_u32 s78, s87, 0
    buffer_load_dwordx4 v20, s[28:31], s78 offen lds
    s_add_u32 m0, s81, 127232
    s_add_u32 s78, s87, 0
    buffer_load_dwordx4 v21, s[28:31], s78 offen lds
    s_add_u32 m0, s81, 128256
    s_add_u32 s78, s87, 0
    buffer_load_dwordx4 v22, s[28:31], s78 offen lds
    s_add_u32 m0, s81, 129280
    s_add_u32 s78, s87, 0
    buffer_load_dwordx4 v23, s[28:31], s78 offen lds
    s_add_u32 m0, s81, 130304
    s_add_u32 s78, s87, 0
    buffer_load_dwordx4 v24, s[28:31], s78 offen lds
    s_add_u32 m0, s81, 131328
    s_add_u32 s78, s87, 0
    buffer_load_dwordx4 v25, s[28:31], s78 offen lds
    s_waitcnt vmcnt(13)
    s_barrier
    s_and_b32 s78, s62, 3
    s_xor_b32 s78, s78, 6
    s_lshl_b32 s63, s78, 7
    s_mul_i32 s87, s78, 176128
    s_add_u32 m0, s77, 0
    s_add_u32 s78, s63, 0
    buffer_load_dwordx4 v16, s[24:27], s78 offen lds
    s_add_u32 m0, s77, 4096
    s_add_u32 s78, s63, 32768
    buffer_load_dwordx4 v16, s[24:27], s78 offen lds
    s_add_u32 m0, s77, 8192
    s_add_u32 s78, s63, 65536
    buffer_load_dwordx4 v16, s[24:27], s78 offen lds
    s_add_u32 m0, s77, 12288
    s_add_u32 s78, s63, 98304
    buffer_load_dwordx4 v16, s[24:27], s78 offen lds
    s_add_u32 m0, s81, 16384
    s_add_u32 s78, s87, 0
    buffer_load_dwordx4 v17, s[28:31], s78 offen lds
    s_add_u32 m0, s81, 17408
    s_add_u32 s78, s87, 0
    buffer_load_dwordx4 v18, s[28:31], s78 offen lds
    s_add_u32 m0, s81, 18432
    s_add_u32 s78, s87, 0
    buffer_load_dwordx4 v19, s[28:31], s78 offen lds
    s_add_u32 m0, s81, 19456
    s_add_u32 s78, s87, 0
    buffer_load_dwordx4 v20, s[28:31], s78 offen lds
    s_add_u32 m0, s81, 20480
    s_add_u32 s78, s87, 0
    buffer_load_dwordx4 v21, s[28:31], s78 offen lds
    s_add_u32 m0, s81, 21504
    s_add_u32 s78, s87, 0
    buffer_load_dwordx4 v22, s[28:31], s78 offen lds
    s_add_u32 m0, s81, 22528
    s_add_u32 s78, s87, 0
    buffer_load_dwordx4 v23, s[28:31], s78 offen lds
    s_add_u32 m0, s81, 23552
    s_add_u32 s78, s87, 0
    buffer_load_dwordx4 v24, s[28:31], s78 offen lds
    s_add_u32 m0, s81, 24576
    s_add_u32 s78, s87, 0
    buffer_load_dwordx4 v25, s[28:31], s78 offen lds
    s_waitcnt vmcnt(13)
    s_barrier
    s_and_b32 s78, s62, 3
    s_xor_b32 s78, s78, 7
    s_lshl_b32 s63, s78, 7
    s_mul_i32 s87, s78, 176128
    s_add_u32 m0, s77, 53376
    s_add_u32 s78, s63, 0
    buffer_load_dwordx4 v16, s[24:27], s78 offen lds
    s_add_u32 m0, s77, 57472
    s_add_u32 s78, s63, 32768
    buffer_load_dwordx4 v16, s[24:27], s78 offen lds
    s_add_u32 m0, s77, 61568
    s_add_u32 s78, s63, 65536
    buffer_load_dwordx4 v16, s[24:27], s78 offen lds
    s_add_u32 m0, s77, 65664
    s_add_u32 s78, s63, 98304
    buffer_load_dwordx4 v16, s[24:27], s78 offen lds
    s_add_u32 m0, s81, 69760
    s_add_u32 s78, s87, 0
    buffer_load_dwordx4 v17, s[28:31], s78 offen lds
    s_add_u32 m0, s81, 70784
    s_add_u32 s78, s87, 0
    buffer_load_dwordx4 v18, s[28:31], s78 offen lds
    s_add_u32 m0, s81, 71808
    s_add_u32 s78, s87, 0
    buffer_load_dwordx4 v19, s[28:31], s78 offen lds
    s_add_u32 m0, s81, 72832
    s_add_u32 s78, s87, 0
    buffer_load_dwordx4 v20, s[28:31], s78 offen lds
    s_add_u32 m0, s81, 73856
    s_add_u32 s78, s87, 0
    buffer_load_dwordx4 v21, s[28:31], s78 offen lds
    s_add_u32 m0, s81, 74880
    s_add_u32 s78, s87, 0
    buffer_load_dwordx4 v22, s[28:31], s78 offen lds
    s_add_u32 m0, s81, 75904
    s_add_u32 s78, s87, 0
    buffer_load_dwordx4 v23, s[28:31], s78 offen lds
    s_add_u32 m0, s81, 76928
    s_add_u32 s78, s87, 0
    buffer_load_dwordx4 v24, s[28:31], s78 offen lds
    s_add_u32 m0, s81, 77952
    s_add_u32 s78, s87, 0
    buffer_load_dwordx4 v25, s[28:31], s78 offen lds
    s_mov_b32 s32, s16
    s_and_b32 s33, s17, 0xffff
    s_mov_b32 s34, 1409024
    s_mov_b32 s35, 0x20000
    v_lshrrev_b32 v8, 3, v0
    v_and_b32 v9, 7, v0
    v_and_b32 v10, 2, v8
    v_lshlrev_b32 v10, 1, v10
    v_xor_b32 v10, v10, v9
    v_lshlrev_b32 v10, 4, v10
    v_lshl_add_u32 v2, v8, 10, v10
    s_lshl_b32 s78, s74, 14
    s_lshl_b32 s79, s94, 7
    s_add_u32 s78, s78, s79
    v_add_u32 v2, s78, v2
    v_add_u32 v3, 8192, v2
    s_waitcnt vmcnt(13)
    s_barrier
    s_add_u32 m0, s97, 0
    s_nop 0
    buffer_load_dwordx4 v2, s[32:35], s96 offen lds
    s_add_u32 m0, s97, 1024
    s_nop 0
    buffer_load_dwordx4 v3, s[32:35], s96 offen lds
    s_add_u32 s96, s96, 65536
    s_cmp_eq_u32 s96, 1441792
    s_cselect_b32 s96, 0, s96
    s_add_u32 m0, s97, 2048
    s_nop 0
    buffer_load_dwordx4 v2, s[32:35], s96 offen lds
    s_add_u32 m0, s97, 3072
    s_nop 0
    buffer_load_dwordx4 v3, s[32:35], s96 offen lds
    s_add_u32 s96, s96, 65536
    s_cmp_eq_u32 s96, 1441792
    s_cselect_b32 s96, 0, s96
    s_add_u32 m0, s97, 4096
    s_nop 0
    buffer_load_dwordx4 v2, s[32:35], s96 offen lds
    s_add_u32 m0, s97, 5120
    s_nop 0
    buffer_load_dwordx4 v3, s[32:35], s96 offen lds
    s_add_u32 s96, s96, 65536
    s_cmp_eq_u32 s96, 1441792
    s_cselect_b32 s96, 0, s96
    s_add_u32 m0, s97, 6144
    s_nop 0
    buffer_load_dwordx4 v2, s[32:35], s96 offen lds
    s_add_u32 m0, s97, 7168
    s_nop 0
    buffer_load_dwordx4 v3, s[32:35], s96 offen lds
    s_add_u32 s96, s96, 65536
    s_cmp_eq_u32 s96, 1441792
    s_cselect_b32 s96, 0, s96
    s_waitcnt vmcnt(0)
    s_barrier
    s_add_u32 m0, s60, 0
    s_nop 0
    buffer_load_dwordx4 v2, s[32:35], s96 offen lds
    s_add_u32 m0, s60, 1024
    s_nop 0
    buffer_load_dwordx4 v3, s[32:35], s96 offen lds
    s_add_u32 s96, s96, 65536
    s_cmp_eq_u32 s96, 1441792
    s_cselect_b32 s96, 0, s96
    s_add_u32 m0, s60, 2048
    s_nop 0
    buffer_load_dwordx4 v2, s[32:35], s96 offen lds
    s_add_u32 m0, s60, 3072
    s_nop 0
    buffer_load_dwordx4 v3, s[32:35], s96 offen lds
    s_add_u32 s96, s96, 65536
    s_cmp_eq_u32 s96, 1441792
    s_cselect_b32 s96, 0, s96
    s_add_u32 m0, s60, 4096
    s_nop 0
    buffer_load_dwordx4 v2, s[32:35], s96 offen lds
    s_add_u32 m0, s60, 5120
    s_nop 0
    buffer_load_dwordx4 v3, s[32:35], s96 offen lds
    s_add_u32 s96, s96, 65536
    s_cmp_eq_u32 s96, 1441792
    s_cselect_b32 s96, 0, s96
    s_add_u32 m0, s60, 6144
    s_nop 0
    buffer_load_dwordx4 v2, s[32:35], s96 offen lds
    s_add_u32 m0, s60, 7168
    s_nop 0
    buffer_load_dwordx4 v3, s[32:35], s96 offen lds
    s_add_u32 s96, s96, 65536
    s_cmp_eq_u32 s96, 1441792
    s_cselect_b32 s96, 0, s96
    s_add_u32 m0, s60, 8192
    s_nop 0
    buffer_load_dwordx4 v2, s[32:35], s96 offen lds
    s_add_u32 m0, s60, 9216
    s_nop 0
    buffer_load_dwordx4 v3, s[32:35], s96 offen lds
    s_add_u32 s96, s96, 65536
    s_cmp_eq_u32 s96, 1441792
    s_cselect_b32 s96, 0, s96
    s_add_u32 m0, s60, 10240
    s_nop 0
    buffer_load_dwordx4 v2, s[32:35], s96 offen lds
    s_add_u32 m0, s60, 11264
    s_nop 0
    buffer_load_dwordx4 v3, s[32:35], s96 offen lds
    s_add_u32 s96, s96, 65536
    s_cmp_eq_u32 s96, 1441792
    s_cselect_b32 s96, 0, s96
    s_barrier
    s_add_u32 s24, s22, 8388608
    s_addc_u32 s25, s23, 0
    s_and_b32 s25, s25, 0xffff
    s_mov_b32 s26, 1048576
    s_mov_b32 s27, 0x20000
    s_add_u32 s28, s22, 6291456
    s_addc_u32 s29, s23, 0
    s_and_b32 s29, s29, 0xffff
    s_mov_b32 s30, 2097152
    s_mov_b32 s31, 0x20000
    s_mov_b32 s82, 1069066811
    s_add_u32 m0, s61, 0
    s_nop 0
    buffer_load_dwordx4 v2, s[32:35], s96 offen lds
    s_add_u32 m0, s61, 1024
    s_nop 0
    buffer_load_dwordx4 v3, s[32:35], s96 offen lds
    s_add_u32 s96, s96, 65536
    s_cmp_eq_u32 s96, 1441792
    s_cselect_b32 s96, 0, s96
    s_add_u32 m0, s61, 2048
    s_nop 0
    buffer_load_dwordx4 v2, s[32:35], s96 offen lds
    s_add_u32 m0, s61, 3072
    s_nop 0
    buffer_load_dwordx4 v3, s[32:35], s96 offen lds
    s_add_u32 s96, s96, 65536
    s_cmp_eq_u32 s96, 1441792
    s_cselect_b32 s96, 0, s96
    s_add_u32 m0, s61, 4096
    s_nop 0
    buffer_load_dwordx4 v2, s[32:35], s96 offen lds
    s_add_u32 m0, s61, 5120
    s_nop 0
    buffer_load_dwordx4 v3, s[32:35], s96 offen lds
    s_add_u32 s96, s96, 65536
    s_cmp_eq_u32 s96, 1441792
    s_cselect_b32 s96, 0, s96
    s_add_u32 m0, s61, 6144
    s_nop 0
    buffer_load_dwordx4 v2, s[32:35], s96 offen lds
    s_add_u32 m0, s61, 7168
    s_nop 0
    buffer_load_dwordx4 v3, s[32:35], s96 offen lds
    s_add_u32 s96, s96, 65536
    s_cmp_eq_u32 s96, 1441792
    s_cselect_b32 s96, 0, s96
    s_add_u32 m0, s61, 8192
    s_nop 0
    buffer_load_dwordx4 v2, s[32:35], s96 offen lds
    s_add_u32 m0, s61, 9216
    s_nop 0
    buffer_load_dwordx4 v3, s[32:35], s96 offen lds
    s_add_u32 s96, s96, 65536
    s_cmp_eq_u32 s96, 1441792
    s_cselect_b32 s96, 0, s96
    s_waitcnt vmcnt(10)
    s_mov_b64 exec, 1
    ds_add_u32 v5, v6 offset:16
    s_mov_b64 exec, -1
    v_mov_b32 v120, 1069066811
    s_lshl_b32 s80, s92, 2
    s_add_u32 s80, s80, s74
    s_lshl_b32 s80, s80, 8
    s_lshr_b32 s78, s69, 4
    s_lshl_b32 s78, s78, 3
    s_add_u32 s80, s80, s78
    v_and_b32 v23, 1, v0
    v_lshlrev_b32 v23, 2, v23
    buffer_load_dword v22, v23, s[56:59], s80 offen offset:192 sc1
    v_and_b32 v16, 31, v0
    v_min_u32 v16, 16, v16
    v_and_b32 v17, 32, v0
    v_add_u32 v16, v16, v17
    v_lshlrev_b32 v24, 4, v16
    s_lshl_b32 s75, s74, 10
    v_mov_b32 v18, 163776
    v_mov_b32 v19, 1
    v_lshrrev_b32 v20, 5, v0
    v_bfe_u32 v21, v0, 2, 2
    v_lshl_add_u32 v25, v20, 2, v21
    v_lshlrev_b32 v25, 5, v25
    v_and_b32 v21, 3, v0
    v_lshl_add_u32 v25, v21, 3, v25
    v_add_u32 v25, 160256, v25
    ds_read_b64_tr_b16 v[40:41], v25 offset:0
    ds_read_b64_tr_b16 v[42:43], v25 offset:256
    v_bfe_u32 v21, v0, 4, 1
    v_mul_u32_u24 v26, 0x8000, v21
    v_lshl_or_b32 v26, v26, 16, v26
    s_lshl_b32 s78, s74, 9
    v_lshlrev_b32 v28, 3, v0
    v_add_u32 v28, 147712, v28
    v_add_u32 v27, s78, v28
    s_waitcnt vmcnt(0) lgkmcnt(0)
    s_mov_b64 exec, 1
    ds_add_u32 v18, v19 offset:12
    s_mov_b64 exec, -1
    v_xor_b32 v40, v40, v26
    v_xor_b32 v41, v41, v26
    v_xor_b32 v42, v42, v26
    v_xor_b32 v43, v43, v26
    s_mov_b32 s98, 0
k1_ffn_lq_chk:
    s_waitcnt vmcnt(0)
    v_cmp_ne_u32 vcc, 1, v22
    s_cbranch_vccz k1_ffn_lq_ok
    s_add_u32 s98, s98, 1
    s_cmp_gt_u32 s98, 0x8000
    s_cbranch_scc1 k1_ffn_lq_ok
    s_sleep 4
    buffer_load_dword v22, v23, s[56:59], s80 offen offset:192 sc1
    s_branch k1_ffn_lq_chk
k1_ffn_lq_ok:
    s_add_u32 s78, s90, s89
    buffer_load_dwordx4 v[32:35], v4, s[28:31], s78 offen sc1
    s_add_u32 s78, s91, s89
    buffer_load_dwordx4 v[36:39], v4, s[28:31], s78 offen sc1
    v_and_b32 v23, 7, v0
    v_lshlrev_b32 v23, 17, v23
    v_lshrrev_b32 v16, 3, v0
    v_mov_b32 v17, s89
    v_lshl_add_u32 v23, v17, 2, v23
    s_waitcnt vmcnt(0)
    v_mfma_f32_32x32x16_bf16 v[64:79], v[40:43], v[32:35], 0
    v_mfma_f32_32x32x16_bf16 v[80:95], v[40:43], v[36:39], 0
    s_nop 10
    v_max3_f32 v112, v64, v65, v66
    v_max3_f32 v116, v80, v81, v82
    v_max3_f32 v113, v72, v73, v74
    v_max3_f32 v117, v88, v89, v90
    v_max3_f32 v114, v67, v68, v69
    v_max3_f32 v118, v83, v84, v85
    v_max3_f32 v115, v75, v76, v77
    v_max3_f32 v119, v91, v92, v93
    v_max3_f32 v112, v70, v71, v112
    v_max3_f32 v116, v86, v87, v116
    v_max3_f32 v113, v78, v79, v113
    v_max3_f32 v117, v94, v95, v117
    v_max_f32 v112, v112, v114
    v_max_f32 v116, v116, v118
    v_max_f32 v113, v113, v115
    v_max_f32 v117, v117, v119
    s_nop 0
    v_permlane32_swap_b32 v112, v113
    v_permlane32_swap_b32 v116, v117
    v_max_f32 v112, v112, v113
    v_max_f32 v116, v116, v117
    v_mul_f32 v112, v120, v112
    v_mul_f32 v116, v120, v116
    v_mov_b32 v113, v112
    v_mov_b32 v117, v116
    s_nop 0
    v_permlane32_swap_b32 v112, v113
    v_permlane32_swap_b32 v116, v117
    v_fma_f32 v64, v64, v120, -v112
    v_fma_f32 v80, v80, v120, -v116
    v_fma_f32 v65, v65, v120, -v112
    v_fma_f32 v81, v81, v120, -v116
    v_fma_f32 v66, v66, v120, -v112
    v_fma_f32 v82, v82, v120, -v116
    v_fma_f32 v67, v67, v120, -v112
    v_fma_f32 v83, v83, v120, -v116
    v_fma_f32 v68, v68, v120, -v112
    v_fma_f32 v84, v84, v120, -v116
    v_fma_f32 v69, v69, v120, -v112
    v_fma_f32 v85, v85, v120, -v116
    v_fma_f32 v70, v70, v120, -v112
    v_fma_f32 v86, v86, v120, -v116
    v_fma_f32 v71, v71, v120, -v112
    v_fma_f32 v87, v87, v120, -v116
    v_fma_f32 v72, v72, v120, -v113
    v_fma_f32 v88, v88, v120, -v117
    v_fma_f32 v73, v73, v120, -v113
    v_fma_f32 v89, v89, v120, -v117
    v_fma_f32 v74, v74, v120, -v113
    v_fma_f32 v90, v90, v120, -v117
    v_fma_f32 v75, v75, v120, -v113
    v_fma_f32 v91, v91, v120, -v117
    v_fma_f32 v76, v76, v120, -v113
    v_fma_f32 v92, v92, v120, -v117
    v_fma_f32 v77, v77, v120, -v113
    v_fma_f32 v93, v93, v120, -v117
    v_fma_f32 v78, v78, v120, -v113
    v_fma_f32 v94, v94, v120, -v117
    v_fma_f32 v79, v79, v120, -v113
    v_fma_f32 v95, v95, v120, -v117
    v_exp_f32 v64, v64
    v_exp_f32 v80, v80
    v_exp_f32 v65, v65
    v_exp_f32 v81, v81
    v_exp_f32 v66, v66
    v_exp_f32 v82, v82
    v_exp_f32 v67, v67
    v_exp_f32 v83, v83
    v_exp_f32 v68, v68
    v_exp_f32 v84, v84
    v_exp_f32 v69, v69
    v_exp_f32 v85, v85
    v_exp_f32 v70, v70
    v_exp_f32 v86, v86
    v_exp_f32 v71, v71
    v_exp_f32 v87, v87
    v_exp_f32 v72, v72
    v_exp_f32 v88, v88
    v_exp_f32 v73, v73
    v_exp_f32 v89, v89
    v_exp_f32 v74, v74
    v_exp_f32 v90, v90
    v_exp_f32 v75, v75
    v_exp_f32 v91, v91
    v_exp_f32 v76, v76
    v_exp_f32 v92, v92
    v_exp_f32 v77, v77
    v_exp_f32 v93, v93
    v_exp_f32 v78, v78
    v_exp_f32 v94, v94
    v_exp_f32 v79, v79
    v_exp_f32 v95, v95
    v_add_f32 v112, v64, v65
    v_add_f32 v116, v80, v81
    v_add_f32 v113, v72, v73
    v_add_f32 v117, v88, v89
    v_add_f32 v114, v66, v67
    v_add_f32 v118, v82, v83
    v_add_f32 v115, v74, v75
    v_add_f32 v119, v90, v91
    v_add_f32 v112, v112, v68
    v_add_f32 v116, v116, v84
    v_add_f32 v113, v113, v76
    v_add_f32 v117, v117, v92
    v_add_f32 v114, v114, v69
    v_add_f32 v118, v118, v85
    v_add_f32 v115, v115, v77
    v_add_f32 v119, v119, v93
    v_add_f32 v112, v112, v70
    v_add_f32 v116, v116, v86
    v_add_f32 v113, v113, v78
    v_add_f32 v117, v117, v94
    v_add_f32 v114, v114, v71
    v_add_f32 v118, v118, v87
    v_add_f32 v115, v115, v79
    v_add_f32 v119, v119, v95
    v_add_f32 v112, v112, v114
    v_add_f32 v116, v116, v118
    v_add_f32 v113, v113, v115
    buffer_load_dword v22, v23, s[24:27], s75 offen sc1
    v_add_f32 v117, v117, v119
    v_permlane32_swap_b32 v112, v113
    s_nop 0
    v_permlane32_swap_b32 v116, v117
    v_add_f32 v112, v112, v113
    v_add_f32 v116, v116, v117
    v_rcp_f32 v112, v112
    v_rcp_f32 v116, v116
    v_mov_b32 v113, v112
    v_mov_b32 v117, v116
    s_nop 0
    v_permlane32_swap_b32 v112, v113
    v_permlane32_swap_b32 v116, v117
    v_mul_f32 v64, v64, v112
    v_mul_f32 v80, v80, v116
    v_mul_f32 v65, v65, v112
    v_mul_f32 v81, v81, v116
    v_mul_f32 v66, v66, v112
    v_mul_f32 v82, v82, v116
    v_mul_f32 v67, v67, v112
    v_mul_f32 v83, v83, v116
    v_mul_f32 v68, v68, v112
    v_mul_f32 v84, v84, v116
    v_mul_f32 v69, v69, v112
    v_mul_f32 v85, v85, v116
    v_mul_f32 v70, v70, v112
    v_mul_f32 v86, v86, v116
    v_mul_f32 v71, v71, v112
    v_mul_f32 v87, v87, v116
    v_mul_f32 v72, v72, v113
    v_mul_f32 v88, v88, v117
    v_mul_f32 v73, v73, v113
    v_mul_f32 v89, v89, v117
    v_mul_f32 v74, v74, v113
    v_mul_f32 v90, v90, v117
    v_mul_f32 v75, v75, v113
    v_mul_f32 v91, v91, v117
    v_mul_f32 v76, v76, v113
    v_mul_f32 v92, v92, v117
    v_mul_f32 v77, v77, v113
    v_mul_f32 v93, v93, v117
    v_mul_f32 v78, v78, v113
    v_mul_f32 v94, v94, v117
    v_mul_f32 v79, v79, v113
    v_mul_f32 v95, v95, v117
    v_cvt_pk_bf16_f32 v96, v64, v65
    v_cvt_pk_bf16_f32 v104, v80, v81
    v_cvt_pk_bf16_f32 v97, v66, v67
    v_cvt_pk_bf16_f32 v105, v82, v83
    v_cvt_pk_bf16_f32 v98, v68, v69
    v_cvt_pk_bf16_f32 v106, v84, v85
    v_cvt_pk_bf16_f32 v99, v70, v71
    v_cvt_pk_bf16_f32 v107, v86, v87
    v_cvt_pk_bf16_f32 v100, v72, v73
    v_cvt_pk_bf16_f32 v108, v88, v89
    v_cvt_pk_bf16_f32 v101, v74, v75
    v_cvt_pk_bf16_f32 v109, v90, v91
    v_cvt_pk_bf16_f32 v102, v76, v77
    v_cvt_pk_bf16_f32 v110, v92, v93
    v_cvt_pk_bf16_f32 v103, v78, v79
    v_cvt_pk_bf16_f32 v111, v94, v95
    s_setprio 3
    s_mov_b32 s98, 0
k1_ffn_lp_chk:
    s_waitcnt vmcnt(0)
    v_cmp_eq_u32 vcc, -1, v22
    s_nop 0
    s_and_b32 s78, vcc_lo, 255
    s_bcnt1_i32_b32 s78, s78
    s_cmp_le_u32 s78, 2
    s_cbranch_scc1 k1_ffn_lp_ok
    s_add_u32 s98, s98, 1
    s_cmp_gt_u32 s98, 0x8000
    s_cbranch_scc1 k1_ffn_lp_ok
    s_sleep 6
    buffer_load_dword v22, v23, s[24:27], s75 offen sc1
    s_branch k1_ffn_lp_chk
k1_ffn_lp_ok:
    s_mov_b32 s98, 0
k1_ffn_lk_ld:
    s_lshl_b32 s79, s89, 2
    s_add_u32 s79, s79, s75
    s_add_u32 s76, s79, 0
    buffer_load_dwordx4 v[32:35], v24, s[24:27], s76 offen sc1
    s_add_u32 s76, s79, 131072
    buffer_load_dwordx4 v[36:39], v24, s[24:27], s76 offen sc1
    s_add_u32 s76, s79, 262144
    buffer_load_dwordx4 v[40:43], v24, s[24:27], s76 offen sc1
    s_add_u32 s76, s79, 393216
    buffer_load_dwordx4 v[44:47], v24, s[24:27], s76 offen sc1
    s_add_u32 s76, s79, 524288
    buffer_load_dwordx4 v[48:51], v24, s[24:27], s76 offen sc1
    s_add_u32 s76, s79, 655360
    buffer_load_dwordx4 v[52:55], v24, s[24:27], s76 offen sc1
    s_add_u32 s76, s79, 786432
    buffer_load_dwordx4 v[56:59], v24, s[24:27], s76 offen sc1
    s_add_u32 s76, s79, 917504
    buffer_load_dwordx4 v[60:63], v24, s[24:27], s76 offen sc1
    s_waitcnt vmcnt(0)
    v_max3_u32 v20, v32, v33, v34
    v_max3_u32 v21, v35, v36, v37
    v_max3_u32 v20, v38, v39, v20
    v_max_u32 v20, v20, v21
    v_max3_u32 v22, v40, v41, v42
    v_max3_u32 v21, v43, v44, v45
    v_max3_u32 v22, v46, v47, v22
    v_max_u32 v22, v22, v21
    v_max_u32 v20, v20, v22
    v_max3_u32 v22, v48, v49, v50
    v_max3_u32 v21, v51, v52, v53
    v_max3_u32 v22, v54, v55, v22
    v_max_u32 v22, v22, v21
    v_max_u32 v20, v20, v22
    v_max3_u32 v22, v56, v57, v58
    v_max3_u32 v21, v59, v60, v61
    v_max3_u32 v22, v62, v63, v22
    v_max_u32 v22, v22, v21
    v_max_u32 v20, v20, v22
    v_cmp_eq_u32 vcc, -1, v20
    s_cbranch_vccz k1_ffn_lk_ok
    s_add_u32 s98, s98, 1
    s_cmp_gt_u32 s98, 0x8000
    s_cbranch_scc1 k1_ffn_lk_ok
    s_sleep 2
    s_branch k1_ffn_lk_ld
k1_ffn_lk_ok:
    v_add_f32 v32, v32, v48
    v_add_f32 v33, v33, v49
    v_add_f32 v34, v34, v50
    v_add_f32 v35, v35, v51
    v_add_f32 v36, v36, v52
    v_add_f32 v37, v37, v53
    v_add_f32 v38, v38, v54
    v_add_f32 v39, v39, v55
    v_add_f32 v40, v40, v56
    v_add_f32 v41, v41, v57
    v_add_f32 v42, v42, v58
    v_add_f32 v43, v43, v59
    v_add_f32 v44, v44, v60
    v_add_f32 v45, v45, v61
    v_add_f32 v46, v46, v62
    v_add_f32 v47, v47, v63
    v_add_f32 v32, v32, v40
    v_add_f32 v33, v33, v41
    v_add_f32 v34, v34, v42
    v_add_f32 v35, v35, v43
    v_add_f32 v36, v36, v44
    v_add_f32 v37, v37, v45
    v_add_f32 v38, v38, v46
    v_add_f32 v39, v39, v47
    v_add_f32 v32, v32, v36
    v_add_f32 v33, v33, v37
    v_add_f32 v34, v34, v38
    v_add_f32 v35, v35, v39
    v_cvt_pk_bf16_f32 v36, v32, v33
    v_cvt_pk_bf16_f32 v37, v34, v35
    ds_write_b64 v27, v[36:37] offset:0
    s_waitcnt lgkmcnt(0)
    s_mov_b64 exec, 1
    ds_add_u32 v18, v19 offset:0
    s_mov_b64 exec, -1
    s_mov_b32 s98, 0
k1_ffn_l_pc_w:
    ds_read_b32 v20, v18 offset:0
    s_waitcnt lgkmcnt(0)
    v_readfirstlane_b32 s79, v20
    s_add_u32 s98, s98, 1
    s_cmp_gt_u32 s98, 0x100000
    s_cbranch_scc1 k1_ffn_l_pc_k
    s_cmp_lt_u32 s79, 4
    s_cbranch_scc1 k1_ffn_l_pc_w
k1_ffn_l_pc_k:
    ds_read_b64 v[32:33], v28 offset:0
    ds_read_b64 v[34:35], v28 offset:512
    ds_read_b64 v[36:37], v28 offset:1024
    ds_read_b64 v[38:39], v28 offset:1536
    s_waitcnt lgkmcnt(0)
    v_mfma_f32_32x32x16_bf16 v[48:63], v[32:35], v[96:99], 0
    v_mfma_f32_32x32x16_bf16 v[64:79], v[32:35], v[104:107], 0
    v_mfma_f32_32x32x16_bf16 v[48:63], v[36:39], v[100:103], v[48:63]
    v_mfma_f32_32x32x16_bf16 v[64:79], v[36:39], v[108:111], v[64:79]
    s_nop 10
    v_add_f32 v56, 0x358637bd, v56
    v_rcp_f32 v56, v56
    s_add_u32 s78, s90, s89
    v_mul_f32 v48, v48, v56
    v_mul_f32 v49, v49, v56
    v_mul_f32 v50, v50, v56
    v_mul_f32 v51, v51, v56
    v_mul_f32 v52, v52, v56
    v_mul_f32 v53, v53, v56
    v_mul_f32 v54, v54, v56
    v_mul_f32 v55, v55, v56
    v_cvt_pk_bf16_f32 v60, v48, v49
    v_cvt_pk_bf16_f32 v61, v50, v51
    v_cvt_pk_bf16_f32 v62, v52, v53
    v_cvt_pk_bf16_f32 v63, v54, v55
    buffer_store_dwordx4 v[60:63], v4, s[48:51], s78 offen sc1
    v_add_f32 v72, 0x358637bd, v72
    v_rcp_f32 v72, v72
    s_add_u32 s78, s91, s89
    v_mul_f32 v64, v64, v72
    v_mul_f32 v65, v65, v72
    v_mul_f32 v66, v66, v72
    v_mul_f32 v67, v67, v72
    v_mul_f32 v68, v68, v72
    v_mul_f32 v69, v69, v72
    v_mul_f32 v70, v70, v72
    v_mul_f32 v71, v71, v72
    v_cvt_pk_bf16_f32 v76, v64, v65
    v_cvt_pk_bf16_f32 v77, v66, v67
    v_cvt_pk_bf16_f32 v78, v68, v69
    v_cvt_pk_bf16_f32 v79, v70, v71
    buffer_store_dwordx4 v[76:79], v4, s[48:51], s78 offen sc1
    s_endpgm
k1_ffn_c:
    s_and_b32 s74, s68, 1
    s_lshr_b32 s75, s68, 1
    s_lshl_b32 s76, s74, 1
    s_add_u32 s76, s76, s75
    s_mov_b32 s83, s76
    s_xor_b32 s84, s83, 1
    v_and_b32 v1, 31, v0
    v_lshrrev_b32 v250, 5, v0
    v_bfe_u32 v251, v0, 1, 3
    v_bfe_u32 v253, v0, 2, 2
    v_lshl_add_u32 v253, v250, 3, v253
    v_and_b32 v254, 3, v0
    v_lshlrev_b32 v254, 3, v254
    v_bfe_u32 v6, v0, 4, 1
    s_mov_b32 s80, 18560
    v_mad_u32_u24 v254, v6, s80, v254
    v_mul_u32_u24 v253, 288, v253
    v_add_u32 v254, v254, v253
    s_lshl_b32 s80, s75, 7
    s_add_u32 s80, s80, 16384
    s_add_u32 s78, s76, 0
    s_and_b32 s78, s78, 3
    s_lshl_b32 s79, s78, 1
    v_add_u32 v252, s79, v250
    v_xor_b32 v252, v252, v251
    v_lshlrev_b32 v252, 4, v252
    v_lshl_add_u32 v252, v1, 7, v252
    s_lshl_b32 s79, s83, 12
    v_add_u32 v208, s79, v252
    s_lshl_b32 s79, s84, 12
    v_add_u32 v212, s79, v252
    s_mul_i32 s78, s78, 4608
    s_add_u32 s79, s78, s80
    v_add_u32 v216, s79, v254
    s_add_u32 s79, s78, 16640
    v_add_u32 v220, s79, v254
    s_add_u32 s78, s76, 1
    s_and_b32 s78, s78, 3
    s_lshl_b32 s79, s78, 1
    v_add_u32 v252, s79, v250
    v_xor_b32 v252, v252, v251
    v_lshlrev_b32 v252, 4, v252
    v_lshl_add_u32 v252, v1, 7, v252
    s_lshl_b32 s79, s83, 12
    v_add_u32 v209, s79, v252
    s_lshl_b32 s79, s84, 12
    v_add_u32 v213, s79, v252
    s_mul_i32 s78, s78, 4608
    s_add_u32 s79, s78, s80
    v_add_u32 v217, s79, v254
    s_add_u32 s79, s78, 16640
    v_add_u32 v221, s79, v254
    s_add_u32 s78, s76, 2
    s_and_b32 s78, s78, 3
    s_lshl_b32 s79, s78, 1
    v_add_u32 v252, s79, v250
    v_xor_b32 v252, v252, v251
    v_lshlrev_b32 v252, 4, v252
    v_lshl_add_u32 v252, v1, 7, v252
    s_lshl_b32 s79, s83, 12
    v_add_u32 v210, s79, v252
    s_lshl_b32 s79, s84, 12
    v_add_u32 v214, s79, v252
    s_mul_i32 s78, s78, 4608
    s_add_u32 s79, s78, s80
    v_add_u32 v218, s79, v254
    s_add_u32 s79, s78, 16640
    v_add_u32 v222, s79, v254
    s_add_u32 s78, s76, 3
    s_and_b32 s78, s78, 3
    s_lshl_b32 s79, s78, 1
    v_add_u32 v252, s79, v250
    v_xor_b32 v252, v252, v251
    v_lshlrev_b32 v252, 4, v252
    v_lshl_add_u32 v252, v1, 7, v252
    s_lshl_b32 s79, s83, 12
    v_add_u32 v211, s79, v252
    s_lshl_b32 s79, s84, 12
    v_add_u32 v215, s79, v252
    s_mul_i32 s78, s78, 4608
    s_add_u32 s79, s78, s80
    v_add_u32 v219, s79, v254
    s_add_u32 s79, s78, 16640
    v_add_u32 v223, s79, v254
    v_lshrrev_b32 v1, 4, v0
    v_xor_b32 v1, v1, v0
    v_and_b32 v1, 1, v1
    v_add_u32 v1, -1, v1
    v_and_b32 v232, 0x3f803f80, v1
    v_and_b32 v233, 0x3f803f80, v1
    v_and_b32 v234, 0x3f803f80, v1
    v_and_b32 v235, 0x3f803f80, v1
    v_mov_b32 v224, 0
    v_mov_b32 v225, 0
    v_mov_b32 v226, 0
    v_mov_b32 v227, 0
    v_mov_b32 v228, 0
    v_mov_b32 v229, 0
    v_mov_b32 v230, 0
    v_mov_b32 v231, 0
    v_mov_b32 v244, 0
    v_mov_b32 v245, 0
    v_mov_b32 v246, 0
    v_mov_b32 v247, 0
    v_mov_b32 v248, 0
    v_mov_b32 v249, 0
    s_mov_b32 s86, 0xffff0000
    s_mov_b32 s82, 1069066811
    s_waitcnt lgkmcnt(0)
    s_lshl_b32 s92, s70, 1
    s_add_u32 s92, s92, s71
    s_mov_b32 s64, s20
    s_and_b32 s65, s21, 0xffff
    s_mov_b32 s66, 256
    s_mov_b32 s67, 0x20000
    s_add_u32 s56, s22, 11534336
    s_addc_u32 s57, s23, 0
    s_and_b32 s57, s57, 0xffff
    s_mov_b32 s58, 81920
    s_mov_b32 s59, 0x20000
    s_and_b32 s93, s69, 3
    s_lshr_b32 s94, s69, 2
    s_mul_i32 s95, s94, 1
    s_mul_i32 s78, s93, 6
    s_add_u32 s95, s95, s78
    s_sub_u32 s78, s95, 22
    s_cmp_ge_u32 s95, 22
    s_cselect_b32 s95, s78, s95
    s_add_u32 s96, s95, 15
    s_sub_u32 s78, s96, 22
    s_cmp_ge_u32 s96, 22
    s_cselect_b32 s96, s78, s96
    s_lshl_b32 s95, s95, 12
    s_lshl_b32 s96, s96, 16
    s_lshl_b32 s78, s92, 2
    s_add_u32 s93, s93, s78
    s_mul_i32 s97, s68, 8192
    s_add_u32 s97, s97, 114944
    s_mul_i32 s60, s68, 12288
    s_add_u32 s60, s60, 0
    s_mul_i32 s61, s68, 10240
    s_add_u32 s61, s61, 53376
    s_lshl_b32 s78, s93, 16
    s_add_u32 s78, s78, 9437184
    s_add_u32 s48, s22, s78
    s_addc_u32 s49, s23, 0
    s_and_b32 s49, s49, 0xffff
    s_mov_b32 s50, 32768
    s_mov_b32 s51, 0x20000
    s_add_u32 s78, s78, 32768
    s_add_u32 s52, s22, s78
    s_addc_u32 s53, s23, 0
    s_and_b32 s53, s53, 0xffff
    s_mov_b32 s54, 32768
    s_mov_b32 s55, 0x20000
    s_lshl_b32 s78, s72, 2
    s_add_u32 s78, s78, s83
    s_mul_i32 s78, s78, 88064
    s_add_u32 s40, s22, s78
    s_addc_u32 s41, s23, 0
    s_and_b32 s41, s41, 0xffff
    s_mov_b32 s42, 88064
    s_mov_b32 s43, 0x20000
    s_lshl_b32 s78, s72, 2
    s_add_u32 s78, s78, s84
    s_mul_i32 s78, s78, 88064
    s_add_u32 s44, s22, s78
    s_addc_u32 s45, s23, 0
    s_and_b32 s45, s45, 0xffff
    s_mov_b32 s46, 88064
    s_mov_b32 s47, 0x20000
    s_mul_i32 s89, s73, 9216
    s_lshl_b32 s88, s75, 12
    s_add_u32 s88, s88, s89
    s_add_u32 s89, s89, 8192
    s_and_b32 s78, s68, 1
    s_lshl_b32 s3, s72, 1
    s_add_u32 s3, s3, s78
    s_lshl_b32 s3, s3, 6
    s_lshl_b32 s78, s73, 1
    s_add_u32 s3, s3, s78
    s_lshr_b32 s78, s68, 1
    s_add_u32 s3, s3, s78
    s_lshl_b32 s3, s3, 2
    s_mul_i32 s78, s93, 176128
    s_add_u32 s24, s22, s78
    s_addc_u32 s25, s23, 0
    s_and_b32 s25, s25, 0xffff
    s_mov_b32 s26, 88064
    s_mov_b32 s27, 0x20000
    s_add_u32 s78, s78, 88064
    s_add_u32 s28, s22, s78
    s_addc_u32 s29, s23, 0
    s_and_b32 s29, s29, 0xffff
    s_mov_b32 s30, 88064
    s_mov_b32 s31, 0x20000
    s_mov_b32 s32, s16
    s_and_b32 s33, s17, 0xffff
    s_mov_b32 s34, 1409024
    s_mov_b32 s35, 0x20000
    s_mov_b32 s36, s10
    s_and_b32 s37, s11, 0xffff
    s_mov_b32 s38, 524288
    s_mov_b32 s39, 0x20000
    s_barrier
    ds_read_b128 v[152:155], v208 offset:0
    ds_read_b64_tr_b16 v[160:161], v216 offset:0
    ds_read_b64_tr_b16 v[162:163], v216 offset:1152
    ds_read_b128 v[156:159], v212 offset:0
    ds_read_b64_tr_b16 v[164:165], v216 offset:32
    ds_read_b64_tr_b16 v[166:167], v216 offset:1184
    ds_read_b64_tr_b16 v[168:169], v216 offset:64
    ds_read_b64_tr_b16 v[170:171], v216 offset:1216
    ds_read_b64_tr_b16 v[172:173], v216 offset:96
    ds_read_b64_tr_b16 v[174:175], v216 offset:1248
    ds_read_b64_tr_b16 v[176:177], v220 offset:0
    ds_read_b64_tr_b16 v[178:179], v220 offset:1152
    s_waitcnt lgkmcnt(0)
    v_mfma_f32_32x32x16_bf16 v[8:23], v[160:163], v[152:155], 0
    ds_read_b128 v[180:183], v209 offset:0
    v_lshlrev_b32 v2, 16, v168
    ds_read_b64_tr_b16 v[188:189], v217 offset:0
    v_and_b32 v3, s86, v168
    ds_read_b64_tr_b16 v[190:191], v217 offset:1152
    v_lshlrev_b32 v6, 16, v172
    v_mfma_f32_32x32x16_bf16 v[72:87], v[160:163], v[156:159], 0
    ds_read_b128 v[184:187], v213 offset:0
    v_and_b32 v7, s86, v172
    ds_read_b64_tr_b16 v[192:193], v217 offset:32
    v_add_f32 v244, v244, v2
    ds_read_b64_tr_b16 v[194:195], v217 offset:1184
    v_add_f32 v245, v245, v3
    v_mfma_f32_16x16x32_bf16 v[224:227], v[160:163], v[232:235], v[224:227]
    ds_read_b64_tr_b16 v[196:197], v217 offset:64
    v_add_f32 v246, v246, v6
    ds_read_b64_tr_b16 v[198:199], v217 offset:1216
    v_add_f32 v247, v247, v7
    ds_read_b64_tr_b16 v[200:201], v217 offset:96
    v_mfma_f32_32x32x16_bf16 v[24:39], v[164:167], v[152:155], 0
    v_lshlrev_b32 v2, 16, v176
    ds_read_b64_tr_b16 v[202:203], v217 offset:1248
    v_and_b32 v3, s86, v176
    ds_read_b64_tr_b16 v[204:205], v221 offset:0
    v_lshlrev_b32 v6, 16, v169
    ds_read_b64_tr_b16 v[206:207], v221 offset:1152
    v_mfma_f32_16x16x32_bf16 v[228:231], v[164:167], v[232:235], v[228:231]
    v_and_b32 v7, s86, v169
    v_add_f32 v248, v248, v2
    v_add_f32 v249, v249, v3
    v_add_f32 v244, v244, v6
    v_add_f32 v245, v245, v7
    v_mfma_f32_32x32x16_bf16 v[88:103], v[164:167], v[156:159], 0
    v_lshlrev_b32 v2, 16, v173
    v_and_b32 v3, s86, v173
    v_lshlrev_b32 v6, 16, v177
    v_and_b32 v7, s86, v177
    v_add_f32 v246, v246, v2
    v_add_f32 v247, v247, v3
    v_mfma_f32_32x32x16_bf16 v[40:55], v[168:171], v[152:155], 0
    v_add_f32 v248, v248, v6
    v_add_f32 v249, v249, v7
    v_lshlrev_b32 v2, 16, v170
    v_and_b32 v3, s86, v170
    v_lshlrev_b32 v6, 16, v174
    v_mfma_f32_32x32x16_bf16 v[104:119], v[168:171], v[156:159], 0
    v_and_b32 v7, s86, v174
    v_add_f32 v244, v244, v2
    v_add_f32 v245, v245, v3
    v_add_f32 v246, v246, v6
    v_add_f32 v247, v247, v7
    v_mfma_f32_32x32x16_bf16 v[56:71], v[172:175], v[152:155], 0
    v_lshlrev_b32 v2, 16, v178
    v_and_b32 v3, s86, v178
    v_lshlrev_b32 v6, 16, v171
    v_and_b32 v7, s86, v171
    v_add_f32 v248, v248, v2
    v_add_f32 v249, v249, v3
    v_mfma_f32_32x32x16_bf16 v[120:135], v[172:175], v[156:159], 0
    v_add_f32 v244, v244, v6
    v_add_f32 v245, v245, v7
    v_lshlrev_b32 v2, 16, v175
    v_and_b32 v3, s86, v175
    v_lshlrev_b32 v6, 16, v179
    v_mfma_f32_32x32x16_bf16 v[136:151], v[176:179], v[152:155], 0
    v_and_b32 v7, s86, v179
    v_add_f32 v246, v246, v2
    v_add_f32 v247, v247, v3
    v_add_f32 v248, v248, v6
    v_add_f32 v249, v249, v7
    s_waitcnt lgkmcnt(0)
    v_mfma_f32_32x32x16_bf16 v[8:23], v[188:191], v[180:183], v[8:23]
    ds_read_b128 v[152:155], v210 offset:0
    v_lshlrev_b32 v2, 16, v196
    ds_read_b64_tr_b16 v[160:161], v218 offset:0
    v_and_b32 v3, s86, v196
    v_mfma_f32_32x32x16_bf16 v[72:87], v[188:191], v[184:187], v[72:87]
    ds_read_b64_tr_b16 v[162:163], v218 offset:1152
    v_lshlrev_b32 v6, 16, v200
    ds_read_b128 v[156:159], v214 offset:0
    v_and_b32 v7, s86, v200
    v_mfma_f32_16x16x32_bf16 v[224:227], v[188:191], v[232:235], v[224:227]
    ds_read_b64_tr_b16 v[164:165], v218 offset:32
    v_add_f32 v244, v244, v2
    ds_read_b64_tr_b16 v[166:167], v218 offset:1184
    v_add_f32 v245, v245, v3
    v_mfma_f32_32x32x16_bf16 v[24:39], v[192:195], v[180:183], v[24:39]
    ds_read_b64_tr_b16 v[168:169], v218 offset:64
    v_add_f32 v246, v246, v6
    ds_read_b64_tr_b16 v[170:171], v218 offset:1216
    v_add_f32 v247, v247, v7
    v_mfma_f32_16x16x32_bf16 v[228:231], v[192:195], v[232:235], v[228:231]
    ds_read_b64_tr_b16 v[172:173], v218 offset:96
    ds_read_b64_tr_b16 v[174:175], v218 offset:1248
    ds_read_b64_tr_b16 v[176:177], v222 offset:0
    ds_read_b64_tr_b16 v[178:179], v222 offset:1152
    v_mfma_f32_32x32x16_bf16 v[88:103], v[192:195], v[184:187], v[88:103]
    v_lshlrev_b32 v2, 16, v197
    v_and_b32 v3, s86, v197
    v_lshlrev_b32 v6, 16, v201
    v_and_b32 v7, s86, v201
    v_mfma_f32_32x32x16_bf16 v[40:55], v[196:199], v[180:183], v[40:55]
    v_add_f32 v244, v244, v2
    v_add_f32 v245, v245, v3
    v_add_f32 v246, v246, v6
    v_add_f32 v247, v247, v7
    v_mfma_f32_32x32x16_bf16 v[104:119], v[196:199], v[184:187], v[104:119]
    v_lshlrev_b32 v2, 16, v198
    v_and_b32 v3, s86, v198
    v_lshlrev_b32 v6, 16, v202
    v_and_b32 v7, s86, v202
    v_mfma_f32_32x32x16_bf16 v[56:71], v[200:203], v[180:183], v[56:71]
    v_add_f32 v244, v244, v2
    v_add_f32 v245, v245, v3
    v_add_f32 v246, v246, v6
    v_add_f32 v247, v247, v7
    v_mfma_f32_32x32x16_bf16 v[120:135], v[200:203], v[184:187], v[120:135]
    v_lshlrev_b32 v2, 16, v199
    v_and_b32 v3, s86, v199
    v_lshlrev_b32 v6, 16, v203
    v_and_b32 v7, s86, v203
    v_mfma_f32_32x32x16_bf16 v[136:151], v[204:207], v[180:183], v[136:151]
    v_add_f32 v244, v244, v2
    v_add_f32 v245, v245, v3
    v_add_f32 v246, v246, v6
    v_add_f32 v247, v247, v7
    s_waitcnt lgkmcnt(0)
    v_mfma_f32_32x32x16_bf16 v[8:23], v[160:163], v[152:155], v[8:23]
    ds_read_b128 v[180:183], v211 offset:0
    ds_read_b64_tr_b16 v[188:189], v219 offset:0
    ds_read_b64_tr_b16 v[190:191], v219 offset:1152
    v_mfma_f32_32x32x16_bf16 v[72:87], v[160:163], v[156:159], v[72:87]
    ds_read_b128 v[184:187], v215 offset:0
    ds_read_b64_tr_b16 v[192:193], v219 offset:32
    ds_read_b64_tr_b16 v[194:195], v219 offset:1184
    v_mfma_f32_32x32x16_bf16 v[24:39], v[164:167], v[152:155], v[24:39]
    ds_read_b64_tr_b16 v[196:197], v219 offset:64
    ds_read_b64_tr_b16 v[198:199], v219 offset:1216
    ds_read_b64_tr_b16 v[200:201], v219 offset:96
    v_mfma_f32_32x32x16_bf16 v[88:103], v[164:167], v[156:159], v[88:103]
    ds_read_b64_tr_b16 v[202:203], v219 offset:1248
    ds_read_b64_tr_b16 v[204:205], v223 offset:0
    ds_read_b64_tr_b16 v[206:207], v223 offset:1152
    v_mfma_f32_32x32x16_bf16 v[40:55], v[168:171], v[152:155], v[40:55]
    v_mfma_f32_32x32x16_bf16 v[104:119], v[168:171], v[156:159], v[104:119]
    v_mfma_f32_32x32x16_bf16 v[56:71], v[172:175], v[152:155], v[56:71]
    v_mfma_f32_32x32x16_bf16 v[120:135], v[172:175], v[156:159], v[120:135]
    v_mfma_f32_32x32x16_bf16 v[136:151], v[176:179], v[152:155], v[136:151]
    s_waitcnt lgkmcnt(0)
    s_barrier
    v_mfma_f32_32x32x16_bf16 v[8:23], v[188:191], v[180:183], v[8:23]
    ds_read_b128 v[152:155], v208 offset:53376
    ds_read_b64_tr_b16 v[160:161], v216 offset:53376
    ds_read_b64_tr_b16 v[162:163], v216 offset:54528
    v_mfma_f32_32x32x16_bf16 v[72:87], v[188:191], v[184:187], v[72:87]
    ds_read_b128 v[156:159], v212 offset:53376
    ds_read_b64_tr_b16 v[164:165], v216 offset:53408
    ds_read_b64_tr_b16 v[166:167], v216 offset:54560
    v_mfma_f32_32x32x16_bf16 v[24:39], v[192:195], v[180:183], v[24:39]
    ds_read_b64_tr_b16 v[168:169], v216 offset:53440
    ds_read_b64_tr_b16 v[170:171], v216 offset:54592
    ds_read_b64_tr_b16 v[172:173], v216 offset:53472
    v_mfma_f32_32x32x16_bf16 v[88:103], v[192:195], v[184:187], v[88:103]
    ds_read_b64_tr_b16 v[174:175], v216 offset:54624
    ds_read_b64_tr_b16 v[176:177], v220 offset:53376
    ds_read_b64_tr_b16 v[178:179], v220 offset:54528
    v_mfma_f32_32x32x16_bf16 v[40:55], v[196:199], v[180:183], v[40:55]
    v_mfma_f32_32x32x16_bf16 v[104:119], v[196:199], v[184:187], v[104:119]
    v_mfma_f32_32x32x16_bf16 v[56:71], v[200:203], v[180:183], v[56:71]
    v_mfma_f32_32x32x16_bf16 v[120:135], v[200:203], v[184:187], v[120:135]
    v_mfma_f32_32x32x16_bf16 v[136:151], v[204:207], v[180:183], v[136:151]
    s_waitcnt lgkmcnt(0)
    v_mfma_f32_32x32x16_bf16 v[8:23], v[160:163], v[152:155], v[8:23]
    ds_read_b128 v[180:183], v209 offset:53376
    v_lshlrev_b32 v2, 16, v168
    ds_read_b64_tr_b16 v[188:189], v217 offset:53376
    v_and_b32 v3, s86, v168
    ds_read_b64_tr_b16 v[190:191], v217 offset:54528
    v_lshlrev_b32 v6, 16, v172
    v_mfma_f32_32x32x16_bf16 v[72:87], v[160:163], v[156:159], v[72:87]
    ds_read_b128 v[184:187], v213 offset:53376
    v_and_b32 v7, s86, v172
    ds_read_b64_tr_b16 v[192:193], v217 offset:53408
    v_add_f32 v244, v244, v2
    ds_read_b64_tr_b16 v[194:195], v217 offset:54560
    v_add_f32 v245, v245, v3
    v_mfma_f32_16x16x32_bf16 v[224:227], v[160:163], v[232:235], v[224:227]
    ds_read_b64_tr_b16 v[196:197], v217 offset:53440
    v_add_f32 v246, v246, v6
    ds_read_b64_tr_b16 v[198:199], v217 offset:54592
    v_add_f32 v247, v247, v7
    ds_read_b64_tr_b16 v[200:201], v217 offset:53472
    v_mfma_f32_32x32x16_bf16 v[24:39], v[164:167], v[152:155], v[24:39]
    v_lshlrev_b32 v2, 16, v176
    ds_read_b64_tr_b16 v[202:203], v217 offset:54624
    v_and_b32 v3, s86, v176
    ds_read_b64_tr_b16 v[204:205], v221 offset:53376
    v_lshlrev_b32 v6, 16, v169
    ds_read_b64_tr_b16 v[206:207], v221 offset:54528
    v_mfma_f32_16x16x32_bf16 v[228:231], v[164:167], v[232:235], v[228:231]
    v_and_b32 v7, s86, v169
    v_add_f32 v248, v248, v2
    v_add_f32 v249, v249, v3
    v_add_f32 v244, v244, v6
    v_add_f32 v245, v245, v7
    v_mfma_f32_32x32x16_bf16 v[88:103], v[164:167], v[156:159], v[88:103]
    v_lshlrev_b32 v2, 16, v173
    v_and_b32 v3, s86, v173
    v_lshlrev_b32 v6, 16, v177
    v_and_b32 v7, s86, v177
    v_add_f32 v246, v246, v2
    v_add_f32 v247, v247, v3
    v_mfma_f32_32x32x16_bf16 v[40:55], v[168:171], v[152:155], v[40:55]
    v_add_f32 v248, v248, v6
    v_add_f32 v249, v249, v7
    v_lshlrev_b32 v2, 16, v170
    v_and_b32 v3, s86, v170
    v_lshlrev_b32 v6, 16, v174
    v_mfma_f32_32x32x16_bf16 v[104:119], v[168:171], v[156:159], v[104:119]
    v_and_b32 v7, s86, v174
    v_add_f32 v244, v244, v2
    v_add_f32 v245, v245, v3
    v_add_f32 v246, v246, v6
    v_add_f32 v247, v247, v7
    v_mfma_f32_32x32x16_bf16 v[56:71], v[172:175], v[152:155], v[56:71]
    v_lshlrev_b32 v2, 16, v178
    v_and_b32 v3, s86, v178
    v_lshlrev_b32 v6, 16, v171
    v_and_b32 v7, s86, v171
    v_add_f32 v248, v248, v2
    v_add_f32 v249, v249, v3
    v_mfma_f32_32x32x16_bf16 v[120:135], v[172:175], v[156:159], v[120:135]
    v_add_f32 v244, v244, v6
    v_add_f32 v245, v245, v7
    v_lshlrev_b32 v2, 16, v175
    v_and_b32 v3, s86, v175
    v_lshlrev_b32 v6, 16, v179
    v_mfma_f32_32x32x16_bf16 v[136:151], v[176:179], v[152:155], v[136:151]
    v_and_b32 v7, s86, v179
    v_add_f32 v246, v246, v2
    v_add_f32 v247, v247, v3
    v_add_f32 v248, v248, v6
    v_add_f32 v249, v249, v7
    s_waitcnt lgkmcnt(0)
    v_mfma_f32_32x32x16_bf16 v[8:23], v[188:191], v[180:183], v[8:23]
    ds_read_b128 v[152:155], v210 offset:53376
    v_lshlrev_b32 v2, 16, v196
    ds_read_b64_tr_b16 v[160:161], v218 offset:53376
    v_and_b32 v3, s86, v196
    v_mfma_f32_32x32x16_bf16 v[72:87], v[188:191], v[184:187], v[72:87]
    ds_read_b64_tr_b16 v[162:163], v218 offset:54528
    v_lshlrev_b32 v6, 16, v200
    ds_read_b128 v[156:159], v214 offset:53376
    v_and_b32 v7, s86, v200
    v_mfma_f32_16x16x32_bf16 v[224:227], v[188:191], v[232:235], v[224:227]
    ds_read_b64_tr_b16 v[164:165], v218 offset:53408
    v_add_f32 v244, v244, v2
    ds_read_b64_tr_b16 v[166:167], v218 offset:54560
    v_add_f32 v245, v245, v3
    v_mfma_f32_32x32x16_bf16 v[24:39], v[192:195], v[180:183], v[24:39]
    ds_read_b64_tr_b16 v[168:169], v218 offset:53440
    v_add_f32 v246, v246, v6
    ds_read_b64_tr_b16 v[170:171], v218 offset:54592
    v_add_f32 v247, v247, v7
    v_mfma_f32_16x16x32_bf16 v[228:231], v[192:195], v[232:235], v[228:231]
    ds_read_b64_tr_b16 v[172:173], v218 offset:53472
    ds_read_b64_tr_b16 v[174:175], v218 offset:54624
    ds_read_b64_tr_b16 v[176:177], v222 offset:53376
    ds_read_b64_tr_b16 v[178:179], v222 offset:54528
    v_mfma_f32_32x32x16_bf16 v[88:103], v[192:195], v[184:187], v[88:103]
    v_lshlrev_b32 v2, 16, v197
    v_and_b32 v3, s86, v197
    v_lshlrev_b32 v6, 16, v201
    v_and_b32 v7, s86, v201
    v_mfma_f32_32x32x16_bf16 v[40:55], v[196:199], v[180:183], v[40:55]
    v_add_f32 v244, v244, v2
    v_add_f32 v245, v245, v3
    v_add_f32 v246, v246, v6
    v_add_f32 v247, v247, v7
    v_mfma_f32_32x32x16_bf16 v[104:119], v[196:199], v[184:187], v[104:119]
    v_lshlrev_b32 v2, 16, v198
    v_and_b32 v3, s86, v198
    v_lshlrev_b32 v6, 16, v202
    v_and_b32 v7, s86, v202
    v_mfma_f32_32x32x16_bf16 v[56:71], v[200:203], v[180:183], v[56:71]
    v_add_f32 v244, v244, v2
    v_add_f32 v245, v245, v3
    v_add_f32 v246, v246, v6
    v_add_f32 v247, v247, v7
    v_mfma_f32_32x32x16_bf16 v[120:135], v[200:203], v[184:187], v[120:135]
    v_lshlrev_b32 v2, 16, v199
    v_and_b32 v3, s86, v199
    v_lshlrev_b32 v6, 16, v203
    v_and_b32 v7, s86, v203
    v_mfma_f32_32x32x16_bf16 v[136:151], v[204:207], v[180:183], v[136:151]
    v_add_f32 v244, v244, v2
    v_add_f32 v245, v245, v3
    v_add_f32 v246, v246, v6
    v_add_f32 v247, v247, v7
    s_waitcnt lgkmcnt(0)
    v_mfma_f32_32x32x16_bf16 v[8:23], v[160:163], v[152:155], v[8:23]
    ds_read_b128 v[180:183], v211 offset:53376
    ds_read_b64_tr_b16 v[188:189], v219 offset:53376
    ds_read_b64_tr_b16 v[190:191], v219 offset:54528
    v_mfma_f32_32x32x16_bf16 v[72:87], v[160:163], v[156:159], v[72:87]
    ds_read_b128 v[184:187], v215 offset:53376
    ds_read_b64_tr_b16 v[192:193], v219 offset:53408
    ds_read_b64_tr_b16 v[194:195], v219 offset:54560
    v_mfma_f32_32x32x16_bf16 v[24:39], v[164:167], v[152:155], v[24:39]
    ds_read_b64_tr_b16 v[196:197], v219 offset:53440
    ds_read_b64_tr_b16 v[198:199], v219 offset:54592
    ds_read_b64_tr_b16 v[200:201], v219 offset:53472
    v_mfma_f32_32x32x16_bf16 v[88:103], v[164:167], v[156:159], v[88:103]
    ds_read_b64_tr_b16 v[202:203], v219 offset:54624
    ds_read_b64_tr_b16 v[204:205], v223 offset:53376
    ds_read_b64_tr_b16 v[206:207], v223 offset:54528
    v_mfma_f32_32x32x16_bf16 v[40:55], v[168:171], v[152:155], v[40:55]
    v_add_u32 v208, 106752, v208
    v_add_u32 v209, 106752, v209
    v_add_u32 v210, 106752, v210
    v_add_u32 v211, 106752, v211
    v_mfma_f32_32x32x16_bf16 v[104:119], v[168:171], v[156:159], v[104:119]
    v_add_u32 v212, 106752, v212
    v_add_u32 v213, 106752, v213
    v_add_u32 v214, 106752, v214
    v_mfma_f32_32x32x16_bf16 v[56:71], v[172:175], v[152:155], v[56:71]
    v_add_u32 v215, 106752, v215
    v_add_u32 v216, 106752, v216
    v_add_u32 v217, 106752, v217
    v_mfma_f32_32x32x16_bf16 v[120:135], v[172:175], v[156:159], v[120:135]
    v_add_u32 v218, 106752, v218
    v_add_u32 v219, 106752, v219
    v_add_u32 v220, 106752, v220
    v_mfma_f32_32x32x16_bf16 v[136:151], v[176:179], v[152:155], v[136:151]
    v_add_u32 v221, 106752, v221
    v_add_u32 v222, 106752, v222
    v_add_u32 v223, 106752, v223
    s_waitcnt lgkmcnt(0)
    s_barrier
    v_mfma_f32_32x32x16_bf16 v[8:23], v[188:191], v[180:183], v[8:23]
    ds_read_b128 v[152:155], v208 offset:0
    ds_read_b64_tr_b16 v[160:161], v216 offset:0
    ds_read_b64_tr_b16 v[162:163], v216 offset:1152
    v_mfma_f32_32x32x16_bf16 v[72:87], v[188:191], v[184:187], v[72:87]
    ds_read_b128 v[156:159], v212 offset:0
    ds_read_b64_tr_b16 v[164:165], v216 offset:32
    ds_read_b64_tr_b16 v[166:167], v216 offset:1184
    v_mfma_f32_32x32x16_bf16 v[24:39], v[192:195], v[180:183], v[24:39]
    ds_read_b64_tr_b16 v[168:169], v216 offset:64
    ds_read_b64_tr_b16 v[170:171], v216 offset:1216
    ds_read_b64_tr_b16 v[172:173], v216 offset:96
    v_mfma_f32_32x32x16_bf16 v[88:103], v[192:195], v[184:187], v[88:103]
    ds_read_b64_tr_b16 v[174:175], v216 offset:1248
    ds_read_b64_tr_b16 v[176:177], v220 offset:0
    ds_read_b64_tr_b16 v[178:179], v220 offset:1152
    v_mfma_f32_32x32x16_bf16 v[40:55], v[196:199], v[180:183], v[40:55]
    v_mfma_f32_32x32x16_bf16 v[104:119], v[196:199], v[184:187], v[104:119]
    v_mfma_f32_32x32x16_bf16 v[56:71], v[200:203], v[180:183], v[56:71]
    v_mfma_f32_32x32x16_bf16 v[120:135], v[200:203], v[184:187], v[120:135]
    v_mfma_f32_32x32x16_bf16 v[136:151], v[204:207], v[180:183], v[136:151]
    s_waitcnt lgkmcnt(0)
    v_mfma_f32_32x32x16_bf16 v[8:23], v[160:163], v[152:155], v[8:23]
    ds_read_b128 v[180:183], v209 offset:0
    v_lshlrev_b32 v2, 16, v168
    ds_read_b64_tr_b16 v[188:189], v217 offset:0
    v_and_b32 v3, s86, v168
    ds_read_b64_tr_b16 v[190:191], v217 offset:1152
    v_lshlrev_b32 v6, 16, v172
    v_mfma_f32_32x32x16_bf16 v[72:87], v[160:163], v[156:159], v[72:87]
    ds_read_b128 v[184:187], v213 offset:0
    v_and_b32 v7, s86, v172
    ds_read_b64_tr_b16 v[192:193], v217 offset:32
    v_add_f32 v244, v244, v2
    ds_read_b64_tr_b16 v[194:195], v217 offset:1184
    v_add_f32 v245, v245, v3
    v_mfma_f32_16x16x32_bf16 v[224:227], v[160:163], v[232:235], v[224:227]
    ds_read_b64_tr_b16 v[196:197], v217 offset:64
    v_add_f32 v246, v246, v6
    ds_read_b64_tr_b16 v[198:199], v217 offset:1216
    v_add_f32 v247, v247, v7
    ds_read_b64_tr_b16 v[200:201], v217 offset:96
    v_mfma_f32_32x32x16_bf16 v[24:39], v[164:167], v[152:155], v[24:39]
    v_lshlrev_b32 v2, 16, v176
    ds_read_b64_tr_b16 v[202:203], v217 offset:1248
    v_and_b32 v3, s86, v176
    ds_read_b64_tr_b16 v[204:205], v221 offset:0
    v_lshlrev_b32 v6, 16, v169
    ds_read_b64_tr_b16 v[206:207], v221 offset:1152
    v_mfma_f32_16x16x32_bf16 v[228:231], v[164:167], v[232:235], v[228:231]
    v_and_b32 v7, s86, v169
    v_add_f32 v248, v248, v2
    v_add_f32 v249, v249, v3
    v_add_f32 v244, v244, v6
    v_add_f32 v245, v245, v7
    v_mfma_f32_32x32x16_bf16 v[88:103], v[164:167], v[156:159], v[88:103]
    v_lshlrev_b32 v2, 16, v173
    v_and_b32 v3, s86, v173
    v_lshlrev_b32 v6, 16, v177
    v_and_b32 v7, s86, v177
    v_add_f32 v246, v246, v2
    v_add_f32 v247, v247, v3
    v_mfma_f32_32x32x16_bf16 v[40:55], v[168:171], v[152:155], v[40:55]
    v_add_f32 v248, v248, v6
    v_add_f32 v249, v249, v7
    v_lshlrev_b32 v2, 16, v170
    v_and_b32 v3, s86, v170
    v_lshlrev_b32 v6, 16, v174
    v_mfma_f32_32x32x16_bf16 v[104:119], v[168:171], v[156:159], v[104:119]
    v_and_b32 v7, s86, v174
    v_add_f32 v244, v244, v2
    v_add_f32 v245, v245, v3
    v_add_f32 v246, v246, v6
    v_add_f32 v247, v247, v7
    v_mfma_f32_32x32x16_bf16 v[56:71], v[172:175], v[152:155], v[56:71]
    v_lshlrev_b32 v2, 16, v178
    v_and_b32 v3, s86, v178
    v_lshlrev_b32 v6, 16, v171
    v_and_b32 v7, s86, v171
    v_add_f32 v248, v248, v2
    v_add_f32 v249, v249, v3
    v_mfma_f32_32x32x16_bf16 v[120:135], v[172:175], v[156:159], v[120:135]
    v_add_f32 v244, v244, v6
    v_add_f32 v245, v245, v7
    v_lshlrev_b32 v2, 16, v175
    v_and_b32 v3, s86, v175
    v_lshlrev_b32 v6, 16, v179
    v_mfma_f32_32x32x16_bf16 v[136:151], v[176:179], v[152:155], v[136:151]
    v_and_b32 v7, s86, v179
    v_add_f32 v246, v246, v2
    v_add_f32 v247, v247, v3
    v_add_f32 v248, v248, v6
    v_add_f32 v249, v249, v7
    s_waitcnt lgkmcnt(0)
    v_mfma_f32_32x32x16_bf16 v[8:23], v[188:191], v[180:183], v[8:23]
    ds_read_b128 v[152:155], v210 offset:0
    v_lshlrev_b32 v2, 16, v196
    ds_read_b64_tr_b16 v[160:161], v218 offset:0
    v_and_b32 v3, s86, v196
    v_mfma_f32_32x32x16_bf16 v[72:87], v[188:191], v[184:187], v[72:87]
    ds_read_b64_tr_b16 v[162:163], v218 offset:1152
    v_lshlrev_b32 v6, 16, v200
    ds_read_b128 v[156:159], v214 offset:0
    v_and_b32 v7, s86, v200
    v_mfma_f32_16x16x32_bf16 v[224:227], v[188:191], v[232:235], v[224:227]
    ds_read_b64_tr_b16 v[164:165], v218 offset:32
    v_add_f32 v244, v244, v2
    ds_read_b64_tr_b16 v[166:167], v218 offset:1184
    v_add_f32 v245, v245, v3
    v_mfma_f32_32x32x16_bf16 v[24:39], v[192:195], v[180:183], v[24:39]
    ds_read_b64_tr_b16 v[168:169], v218 offset:64
    v_add_f32 v246, v246, v6
    ds_read_b64_tr_b16 v[170:171], v218 offset:1216
    v_add_f32 v247, v247, v7
    v_mfma_f32_16x16x32_bf16 v[228:231], v[192:195], v[232:235], v[228:231]
    ds_read_b64_tr_b16 v[172:173], v218 offset:96
    ds_read_b64_tr_b16 v[174:175], v218 offset:1248
    ds_read_b64_tr_b16 v[176:177], v222 offset:0
    ds_read_b64_tr_b16 v[178:179], v222 offset:1152
    v_mfma_f32_32x32x16_bf16 v[88:103], v[192:195], v[184:187], v[88:103]
    v_lshlrev_b32 v2, 16, v197
    v_and_b32 v3, s86, v197
    v_lshlrev_b32 v6, 16, v201
    v_and_b32 v7, s86, v201
    v_mfma_f32_32x32x16_bf16 v[40:55], v[196:199], v[180:183], v[40:55]
    v_add_f32 v244, v244, v2
    v_add_f32 v245, v245, v3
    v_add_f32 v246, v246, v6
    v_add_f32 v247, v247, v7
    v_mfma_f32_32x32x16_bf16 v[104:119], v[196:199], v[184:187], v[104:119]
    v_lshlrev_b32 v2, 16, v198
    v_and_b32 v3, s86, v198
    v_lshlrev_b32 v6, 16, v202
    v_and_b32 v7, s86, v202
    v_mfma_f32_32x32x16_bf16 v[56:71], v[200:203], v[180:183], v[56:71]
    v_add_f32 v244, v244, v2
    v_add_f32 v245, v245, v3
    v_add_f32 v246, v246, v6
    v_add_f32 v247, v247, v7
    v_mfma_f32_32x32x16_bf16 v[120:135], v[200:203], v[184:187], v[120:135]
    v_lshlrev_b32 v2, 16, v199
    v_and_b32 v3, s86, v199
    v_lshlrev_b32 v6, 16, v203
    v_and_b32 v7, s86, v203
    v_mfma_f32_32x32x16_bf16 v[136:151], v[204:207], v[180:183], v[136:151]
    v_add_f32 v244, v244, v2
    v_add_f32 v245, v245, v3
    v_add_f32 v246, v246, v6
    v_add_f32 v247, v247, v7
    s_waitcnt lgkmcnt(0)
    v_mfma_f32_32x32x16_bf16 v[8:23], v[160:163], v[152:155], v[8:23]
    ds_read_b128 v[180:183], v211 offset:0
    ds_read_b64_tr_b16 v[188:189], v219 offset:0
    ds_read_b64_tr_b16 v[190:191], v219 offset:1152
    v_mfma_f32_32x32x16_bf16 v[72:87], v[160:163], v[156:159], v[72:87]
    ds_read_b128 v[184:187], v215 offset:0
    ds_read_b64_tr_b16 v[192:193], v219 offset:32
    ds_read_b64_tr_b16 v[194:195], v219 offset:1184
    v_mfma_f32_32x32x16_bf16 v[24:39], v[164:167], v[152:155], v[24:39]
    ds_read_b64_tr_b16 v[196:197], v219 offset:64
    ds_read_b64_tr_b16 v[198:199], v219 offset:1216
    ds_read_b64_tr_b16 v[200:201], v219 offset:96
    v_mfma_f32_32x32x16_bf16 v[88:103], v[164:167], v[156:159], v[88:103]
    ds_read_b64_tr_b16 v[202:203], v219 offset:1248
    ds_read_b64_tr_b16 v[204:205], v223 offset:0
    ds_read_b64_tr_b16 v[206:207], v223 offset:1152
    v_mfma_f32_32x32x16_bf16 v[40:55], v[168:171], v[152:155], v[40:55]
    v_add_u32 v208, 4294860544, v208
    v_add_u32 v209, 4294860544, v209
    v_add_u32 v210, 4294860544, v210
    v_add_u32 v211, 4294860544, v211
    v_mfma_f32_32x32x16_bf16 v[104:119], v[168:171], v[156:159], v[104:119]
    v_add_u32 v212, 4294860544, v212
    v_add_u32 v213, 4294860544, v213
    v_add_u32 v214, 4294860544, v214
    v_mfma_f32_32x32x16_bf16 v[56:71], v[172:175], v[152:155], v[56:71]
    v_add_u32 v215, 4294860544, v215
    v_add_u32 v216, 4294860544, v216
    v_add_u32 v217, 4294860544, v217
    v_mfma_f32_32x32x16_bf16 v[120:135], v[172:175], v[156:159], v[120:135]
    v_add_u32 v218, 4294860544, v218
    v_add_u32 v219, 4294860544, v219
    v_add_u32 v220, 4294860544, v220
    v_mfma_f32_32x32x16_bf16 v[136:151], v[176:179], v[152:155], v[136:151]
    v_add_u32 v221, 4294860544, v221
    v_add_u32 v222, 4294860544, v222
    v_add_u32 v223, 4294860544, v223
    s_waitcnt lgkmcnt(0)
    s_barrier
    v_mfma_f32_32x32x16_bf16 v[8:23], v[188:191], v[180:183], v[8:23]
    ds_read_b128 v[152:155], v208 offset:0
    ds_read_b64_tr_b16 v[160:161], v216 offset:0
    ds_read_b64_tr_b16 v[162:163], v216 offset:1152
    v_mfma_f32_32x32x16_bf16 v[72:87], v[188:191], v[184:187], v[72:87]
    ds_read_b128 v[156:159], v212 offset:0
    ds_read_b64_tr_b16 v[164:165], v216 offset:32
    ds_read_b64_tr_b16 v[166:167], v216 offset:1184
    v_mfma_f32_32x32x16_bf16 v[24:39], v[192:195], v[180:183], v[24:39]
    ds_read_b64_tr_b16 v[168:169], v216 offset:64
    ds_read_b64_tr_b16 v[170:171], v216 offset:1216
    ds_read_b64_tr_b16 v[172:173], v216 offset:96
    v_mfma_f32_32x32x16_bf16 v[88:103], v[192:195], v[184:187], v[88:103]
    ds_read_b64_tr_b16 v[174:175], v216 offset:1248
    ds_read_b64_tr_b16 v[176:177], v220 offset:0
    ds_read_b64_tr_b16 v[178:179], v220 offset:1152
    v_mfma_f32_32x32x16_bf16 v[40:55], v[196:199], v[180:183], v[40:55]
    v_mfma_f32_32x32x16_bf16 v[104:119], v[196:199], v[184:187], v[104:119]
    v_mfma_f32_32x32x16_bf16 v[56:71], v[200:203], v[180:183], v[56:71]
    v_mfma_f32_32x32x16_bf16 v[120:135], v[200:203], v[184:187], v[120:135]
    v_mfma_f32_32x32x16_bf16 v[136:151], v[204:207], v[180:183], v[136:151]
    s_waitcnt lgkmcnt(0)
    v_mfma_f32_32x32x16_bf16 v[8:23], v[160:163], v[152:155], v[8:23]
    ds_read_b128 v[180:183], v209 offset:0
    v_lshlrev_b32 v2, 16, v168
    ds_read_b64_tr_b16 v[188:189], v217 offset:0
    v_and_b32 v3, s86, v168
    ds_read_b64_tr_b16 v[190:191], v217 offset:1152
    v_lshlrev_b32 v6, 16, v172
    v_mfma_f32_32x32x16_bf16 v[72:87], v[160:163], v[156:159], v[72:87]
    ds_read_b128 v[184:187], v213 offset:0
    v_and_b32 v7, s86, v172
    ds_read_b64_tr_b16 v[192:193], v217 offset:32
    v_add_f32 v244, v244, v2
    ds_read_b64_tr_b16 v[194:195], v217 offset:1184
    v_add_f32 v245, v245, v3
    v_mfma_f32_16x16x32_bf16 v[224:227], v[160:163], v[232:235], v[224:227]
    ds_read_b64_tr_b16 v[196:197], v217 offset:64
    v_add_f32 v246, v246, v6
    ds_read_b64_tr_b16 v[198:199], v217 offset:1216
    v_add_f32 v247, v247, v7
    ds_read_b64_tr_b16 v[200:201], v217 offset:96
    v_mfma_f32_32x32x16_bf16 v[24:39], v[164:167], v[152:155], v[24:39]
    v_lshlrev_b32 v2, 16, v176
    ds_read_b64_tr_b16 v[202:203], v217 offset:1248
    v_and_b32 v3, s86, v176
    ds_read_b64_tr_b16 v[204:205], v221 offset:0
    v_lshlrev_b32 v6, 16, v169
    ds_read_b64_tr_b16 v[206:207], v221 offset:1152
    v_mfma_f32_16x16x32_bf16 v[228:231], v[164:167], v[232:235], v[228:231]
    v_and_b32 v7, s86, v169
    v_add_f32 v248, v248, v2
    v_add_f32 v249, v249, v3
    v_add_f32 v244, v244, v6
    v_add_f32 v245, v245, v7
    v_mfma_f32_32x32x16_bf16 v[88:103], v[164:167], v[156:159], v[88:103]
    v_lshlrev_b32 v2, 16, v173
    v_and_b32 v3, s86, v173
    v_lshlrev_b32 v6, 16, v177
    v_and_b32 v7, s86, v177
    v_add_f32 v246, v246, v2
    v_add_f32 v247, v247, v3
    v_mfma_f32_32x32x16_bf16 v[40:55], v[168:171], v[152:155], v[40:55]
    v_add_f32 v248, v248, v6
    v_add_f32 v249, v249, v7
    v_lshlrev_b32 v2, 16, v170
    v_and_b32 v3, s86, v170
    v_lshlrev_b32 v6, 16, v174
    v_mfma_f32_32x32x16_bf16 v[104:119], v[168:171], v[156:159], v[104:119]
    v_and_b32 v7, s86, v174
    v_add_f32 v244, v244, v2
    v_add_f32 v245, v245, v3
    v_add_f32 v246, v246, v6
    v_add_f32 v247, v247, v7
    v_mfma_f32_32x32x16_bf16 v[56:71], v[172:175], v[152:155], v[56:71]
    v_lshlrev_b32 v2, 16, v178
    v_and_b32 v3, s86, v178
    v_lshlrev_b32 v6, 16, v171
    v_and_b32 v7, s86, v171
    v_add_f32 v248, v248, v2
    v_add_f32 v249, v249, v3
    v_mfma_f32_32x32x16_bf16 v[120:135], v[172:175], v[156:159], v[120:135]
    v_add_f32 v244, v244, v6
    v_add_f32 v245, v245, v7
    v_lshlrev_b32 v2, 16, v175
    v_and_b32 v3, s86, v175
    v_lshlrev_b32 v6, 16, v179
    v_mfma_f32_32x32x16_bf16 v[136:151], v[176:179], v[152:155], v[136:151]
    v_and_b32 v7, s86, v179
    v_add_f32 v246, v246, v2
    v_add_f32 v247, v247, v3
    v_add_f32 v248, v248, v6
    v_add_f32 v249, v249, v7
    s_waitcnt lgkmcnt(0)
    v_mfma_f32_32x32x16_bf16 v[8:23], v[188:191], v[180:183], v[8:23]
    ds_read_b128 v[152:155], v210 offset:0
    v_lshlrev_b32 v2, 16, v196
    ds_read_b64_tr_b16 v[160:161], v218 offset:0
    v_and_b32 v3, s86, v196
    v_mfma_f32_32x32x16_bf16 v[72:87], v[188:191], v[184:187], v[72:87]
    ds_read_b64_tr_b16 v[162:163], v218 offset:1152
    v_lshlrev_b32 v6, 16, v200
    ds_read_b128 v[156:159], v214 offset:0
    v_and_b32 v7, s86, v200
    v_mfma_f32_16x16x32_bf16 v[224:227], v[188:191], v[232:235], v[224:227]
    ds_read_b64_tr_b16 v[164:165], v218 offset:32
    v_add_f32 v244, v244, v2
    ds_read_b64_tr_b16 v[166:167], v218 offset:1184
    v_add_f32 v245, v245, v3
    v_mfma_f32_32x32x16_bf16 v[24:39], v[192:195], v[180:183], v[24:39]
    ds_read_b64_tr_b16 v[168:169], v218 offset:64
    v_add_f32 v246, v246, v6
    ds_read_b64_tr_b16 v[170:171], v218 offset:1216
    v_add_f32 v247, v247, v7
    v_mfma_f32_16x16x32_bf16 v[228:231], v[192:195], v[232:235], v[228:231]
    ds_read_b64_tr_b16 v[172:173], v218 offset:96
    ds_read_b64_tr_b16 v[174:175], v218 offset:1248
    ds_read_b64_tr_b16 v[176:177], v222 offset:0
    ds_read_b64_tr_b16 v[178:179], v222 offset:1152
    v_mfma_f32_32x32x16_bf16 v[88:103], v[192:195], v[184:187], v[88:103]
    v_lshlrev_b32 v2, 16, v197
    v_and_b32 v3, s86, v197
    v_lshlrev_b32 v6, 16, v201
    v_and_b32 v7, s86, v201
    v_mfma_f32_32x32x16_bf16 v[40:55], v[196:199], v[180:183], v[40:55]
    v_add_f32 v244, v244, v2
    v_add_f32 v245, v245, v3
    v_add_f32 v246, v246, v6
    v_add_f32 v247, v247, v7
    v_mfma_f32_32x32x16_bf16 v[104:119], v[196:199], v[184:187], v[104:119]
    v_lshlrev_b32 v2, 16, v198
    v_and_b32 v3, s86, v198
    v_lshlrev_b32 v6, 16, v202
    v_and_b32 v7, s86, v202
    v_mfma_f32_32x32x16_bf16 v[56:71], v[200:203], v[180:183], v[56:71]
    v_add_f32 v244, v244, v2
    v_add_f32 v245, v245, v3
    v_add_f32 v246, v246, v6
    v_add_f32 v247, v247, v7
    v_mfma_f32_32x32x16_bf16 v[120:135], v[200:203], v[184:187], v[120:135]
    v_lshlrev_b32 v2, 16, v199
    v_and_b32 v3, s86, v199
    v_lshlrev_b32 v6, 16, v203
    v_and_b32 v7, s86, v203
    v_mfma_f32_32x32x16_bf16 v[136:151], v[204:207], v[180:183], v[136:151]
    v_add_f32 v244, v244, v2
    v_add_f32 v245, v245, v3
    v_add_f32 v246, v246, v6
    v_add_f32 v247, v247, v7
    s_waitcnt lgkmcnt(0)
    v_mfma_f32_32x32x16_bf16 v[8:23], v[160:163], v[152:155], v[8:23]
    ds_read_b128 v[180:183], v211 offset:0
    ds_read_b64_tr_b16 v[188:189], v219 offset:0
    ds_read_b64_tr_b16 v[190:191], v219 offset:1152
    v_mfma_f32_32x32x16_bf16 v[72:87], v[160:163], v[156:159], v[72:87]
    ds_read_b128 v[184:187], v215 offset:0
    ds_read_b64_tr_b16 v[192:193], v219 offset:32
    ds_read_b64_tr_b16 v[194:195], v219 offset:1184
    v_mfma_f32_32x32x16_bf16 v[24:39], v[164:167], v[152:155], v[24:39]
    ds_read_b64_tr_b16 v[196:197], v219 offset:64
    ds_read_b64_tr_b16 v[198:199], v219 offset:1216
    ds_read_b64_tr_b16 v[200:201], v219 offset:96
    v_mfma_f32_32x32x16_bf16 v[88:103], v[164:167], v[156:159], v[88:103]
    ds_read_b64_tr_b16 v[202:203], v219 offset:1248
    ds_read_b64_tr_b16 v[204:205], v223 offset:0
    ds_read_b64_tr_b16 v[206:207], v223 offset:1152
    v_mfma_f32_32x32x16_bf16 v[40:55], v[168:171], v[152:155], v[40:55]
    v_mfma_f32_32x32x16_bf16 v[104:119], v[168:171], v[156:159], v[104:119]
    v_mfma_f32_32x32x16_bf16 v[56:71], v[172:175], v[152:155], v[56:71]
    v_mfma_f32_32x32x16_bf16 v[120:135], v[172:175], v[156:159], v[120:135]
    v_mfma_f32_32x32x16_bf16 v[136:151], v[176:179], v[152:155], v[136:151]
    s_waitcnt lgkmcnt(0)
    s_barrier
    v_mfma_f32_32x32x16_bf16 v[8:23], v[188:191], v[180:183], v[8:23]
    ds_read_b128 v[152:155], v208 offset:53376
    ds_read_b64_tr_b16 v[160:161], v216 offset:53376
    ds_read_b64_tr_b16 v[162:163], v216 offset:54528
    v_mfma_f32_32x32x16_bf16 v[72:87], v[188:191], v[184:187], v[72:87]
    ds_read_b128 v[156:159], v212 offset:53376
    ds_read_b64_tr_b16 v[164:165], v216 offset:53408
    ds_read_b64_tr_b16 v[166:167], v216 offset:54560
    v_mfma_f32_32x32x16_bf16 v[24:39], v[192:195], v[180:183], v[24:39]
    ds_read_b64_tr_b16 v[168:169], v216 offset:53440
    ds_read_b64_tr_b16 v[170:171], v216 offset:54592
    ds_read_b64_tr_b16 v[172:173], v216 offset:53472
    v_mfma_f32_32x32x16_bf16 v[88:103], v[192:195], v[184:187], v[88:103]
    ds_read_b64_tr_b16 v[174:175], v216 offset:54624
    ds_read_b64_tr_b16 v[176:177], v220 offset:53376
    ds_read_b64_tr_b16 v[178:179], v220 offset:54528
    v_mfma_f32_32x32x16_bf16 v[40:55], v[196:199], v[180:183], v[40:55]
    v_mfma_f32_32x32x16_bf16 v[104:119], v[196:199], v[184:187], v[104:119]
    v_mfma_f32_32x32x16_bf16 v[56:71], v[200:203], v[180:183], v[56:71]
    v_mfma_f32_32x32x16_bf16 v[120:135], v[200:203], v[184:187], v[120:135]
    v_mfma_f32_32x32x16_bf16 v[136:151], v[204:207], v[180:183], v[136:151]
    s_waitcnt lgkmcnt(0)
    v_mfma_f32_32x32x16_bf16 v[8:23], v[160:163], v[152:155], v[8:23]
    ds_read_b128 v[180:183], v209 offset:53376
    v_lshlrev_b32 v2, 16, v168
    ds_read_b64_tr_b16 v[188:189], v217 offset:53376
    v_and_b32 v3, s86, v168
    ds_read_b64_tr_b16 v[190:191], v217 offset:54528
    v_lshlrev_b32 v6, 16, v172
    v_mfma_f32_32x32x16_bf16 v[72:87], v[160:163], v[156:159], v[72:87]
    ds_read_b128 v[184:187], v213 offset:53376
    v_and_b32 v7, s86, v172
    ds_read_b64_tr_b16 v[192:193], v217 offset:53408
    v_add_f32 v244, v244, v2
    ds_read_b64_tr_b16 v[194:195], v217 offset:54560
    v_add_f32 v245, v245, v3
    v_mfma_f32_16x16x32_bf16 v[224:227], v[160:163], v[232:235], v[224:227]
    ds_read_b64_tr_b16 v[196:197], v217 offset:53440
    v_add_f32 v246, v246, v6
    ds_read_b64_tr_b16 v[198:199], v217 offset:54592
    v_add_f32 v247, v247, v7
    ds_read_b64_tr_b16 v[200:201], v217 offset:53472
    v_mfma_f32_32x32x16_bf16 v[24:39], v[164:167], v[152:155], v[24:39]
    v_lshlrev_b32 v2, 16, v176
    ds_read_b64_tr_b16 v[202:203], v217 offset:54624
    v_and_b32 v3, s86, v176
    ds_read_b64_tr_b16 v[204:205], v221 offset:53376
    v_lshlrev_b32 v6, 16, v169
    ds_read_b64_tr_b16 v[206:207], v221 offset:54528
    v_mfma_f32_16x16x32_bf16 v[228:231], v[164:167], v[232:235], v[228:231]
    v_and_b32 v7, s86, v169
    v_add_f32 v248, v248, v2
    v_add_f32 v249, v249, v3
    v_add_f32 v244, v244, v6
    v_add_f32 v245, v245, v7
    v_mfma_f32_32x32x16_bf16 v[88:103], v[164:167], v[156:159], v[88:103]
    v_lshlrev_b32 v2, 16, v173
    v_and_b32 v3, s86, v173
    v_lshlrev_b32 v6, 16, v177
    v_and_b32 v7, s86, v177
    v_add_f32 v246, v246, v2
    v_add_f32 v247, v247, v3
    v_mfma_f32_32x32x16_bf16 v[40:55], v[168:171], v[152:155], v[40:55]
    v_add_f32 v248, v248, v6
    v_add_f32 v249, v249, v7
    v_lshlrev_b32 v2, 16, v170
    v_and_b32 v3, s86, v170
    v_lshlrev_b32 v6, 16, v174
    v_mfma_f32_32x32x16_bf16 v[104:119], v[168:171], v[156:159], v[104:119]
    v_and_b32 v7, s86, v174
    v_add_f32 v244, v244, v2
    v_add_f32 v245, v245, v3
    v_add_f32 v246, v246, v6
    v_add_f32 v247, v247, v7
    v_mfma_f32_32x32x16_bf16 v[56:71], v[172:175], v[152:155], v[56:71]
    v_lshlrev_b32 v2, 16, v178
    v_and_b32 v3, s86, v178
    v_lshlrev_b32 v6, 16, v171
    v_and_b32 v7, s86, v171
    v_add_f32 v248, v248, v2
    v_add_f32 v249, v249, v3
    v_mfma_f32_32x32x16_bf16 v[120:135], v[172:175], v[156:159], v[120:135]
    v_add_f32 v244, v244, v6
    v_add_f32 v245, v245, v7
    v_lshlrev_b32 v2, 16, v175
    v_and_b32 v3, s86, v175
    v_lshlrev_b32 v6, 16, v179
    v_mfma_f32_32x32x16_bf16 v[136:151], v[176:179], v[152:155], v[136:151]
    v_and_b32 v7, s86, v179
    v_add_f32 v246, v246, v2
    v_add_f32 v247, v247, v3
    v_add_f32 v248, v248, v6
    v_add_f32 v249, v249, v7
    s_waitcnt lgkmcnt(0)
    v_mfma_f32_32x32x16_bf16 v[8:23], v[188:191], v[180:183], v[8:23]
    ds_read_b128 v[152:155], v210 offset:53376
    v_lshlrev_b32 v2, 16, v196
    ds_read_b64_tr_b16 v[160:161], v218 offset:53376
    v_and_b32 v3, s86, v196
    v_mfma_f32_32x32x16_bf16 v[72:87], v[188:191], v[184:187], v[72:87]
    ds_read_b64_tr_b16 v[162:163], v218 offset:54528
    v_lshlrev_b32 v6, 16, v200
    ds_read_b128 v[156:159], v214 offset:53376
    v_and_b32 v7, s86, v200
    v_mfma_f32_16x16x32_bf16 v[224:227], v[188:191], v[232:235], v[224:227]
    ds_read_b64_tr_b16 v[164:165], v218 offset:53408
    v_add_f32 v244, v244, v2
    ds_read_b64_tr_b16 v[166:167], v218 offset:54560
    v_add_f32 v245, v245, v3
    v_mfma_f32_32x32x16_bf16 v[24:39], v[192:195], v[180:183], v[24:39]
    ds_read_b64_tr_b16 v[168:169], v218 offset:53440
    v_add_f32 v246, v246, v6
    ds_read_b64_tr_b16 v[170:171], v218 offset:54592
    v_add_f32 v247, v247, v7
    v_mfma_f32_16x16x32_bf16 v[228:231], v[192:195], v[232:235], v[228:231]
    ds_read_b64_tr_b16 v[172:173], v218 offset:53472
    ds_read_b64_tr_b16 v[174:175], v218 offset:54624
    ds_read_b64_tr_b16 v[176:177], v222 offset:53376
    ds_read_b64_tr_b16 v[178:179], v222 offset:54528
    v_mfma_f32_32x32x16_bf16 v[88:103], v[192:195], v[184:187], v[88:103]
    v_lshlrev_b32 v2, 16, v197
    v_and_b32 v3, s86, v197
    v_lshlrev_b32 v6, 16, v201
    v_and_b32 v7, s86, v201
    v_mfma_f32_32x32x16_bf16 v[40:55], v[196:199], v[180:183], v[40:55]
    v_add_f32 v244, v244, v2
    v_add_f32 v245, v245, v3
    v_add_f32 v246, v246, v6
    v_add_f32 v247, v247, v7
    v_mfma_f32_32x32x16_bf16 v[104:119], v[196:199], v[184:187], v[104:119]
    v_lshlrev_b32 v2, 16, v198
    v_and_b32 v3, s86, v198
    v_lshlrev_b32 v6, 16, v202
    v_and_b32 v7, s86, v202
    v_mfma_f32_32x32x16_bf16 v[56:71], v[200:203], v[180:183], v[56:71]
    v_add_f32 v244, v244, v2
    v_add_f32 v245, v245, v3
    v_add_f32 v246, v246, v6
    v_add_f32 v247, v247, v7
    v_mfma_f32_32x32x16_bf16 v[120:135], v[200:203], v[184:187], v[120:135]
    v_lshlrev_b32 v2, 16, v199
    v_and_b32 v3, s86, v199
    v_lshlrev_b32 v6, 16, v203
    v_and_b32 v7, s86, v203
    v_mfma_f32_32x32x16_bf16 v[136:151], v[204:207], v[180:183], v[136:151]
    v_add_f32 v244, v244, v2
    v_add_f32 v245, v245, v3
    v_add_f32 v246, v246, v6
    v_add_f32 v247, v247, v7
    s_waitcnt lgkmcnt(0)
    v_mfma_f32_32x32x16_bf16 v[8:23], v[160:163], v[152:155], v[8:23]
    ds_read_b128 v[180:183], v211 offset:53376
    ds_read_b64_tr_b16 v[188:189], v219 offset:53376
    ds_read_b64_tr_b16 v[190:191], v219 offset:54528
    v_mfma_f32_32x32x16_bf16 v[72:87], v[160:163], v[156:159], v[72:87]
    ds_read_b128 v[184:187], v215 offset:53376
    ds_read_b64_tr_b16 v[192:193], v219 offset:53408
    ds_read_b64_tr_b16 v[194:195], v219 offset:54560
    v_mfma_f32_32x32x16_bf16 v[24:39], v[164:167], v[152:155], v[24:39]
    ds_read_b64_tr_b16 v[196:197], v219 offset:53440
    ds_read_b64_tr_b16 v[198:199], v219 offset:54592
    ds_read_b64_tr_b16 v[200:201], v219 offset:53472
    v_mfma_f32_32x32x16_bf16 v[88:103], v[164:167], v[156:159], v[88:103]
    ds_read_b64_tr_b16 v[202:203], v219 offset:54624
    ds_read_b64_tr_b16 v[204:205], v223 offset:53376
    ds_read_b64_tr_b16 v[206:207], v223 offset:54528
    v_mfma_f32_32x32x16_bf16 v[40:55], v[168:171], v[152:155], v[40:55]
    v_add_u32 v208, 106752, v208
    v_add_u32 v209, 106752, v209
    v_add_u32 v210, 106752, v210
    v_add_u32 v211, 106752, v211
    v_mfma_f32_32x32x16_bf16 v[104:119], v[168:171], v[156:159], v[104:119]
    v_add_u32 v212, 106752, v212
    v_add_u32 v213, 106752, v213
    v_add_u32 v214, 106752, v214
    v_mfma_f32_32x32x16_bf16 v[56:71], v[172:175], v[152:155], v[56:71]
    v_add_u32 v215, 106752, v215
    v_add_u32 v216, 106752, v216
    v_add_u32 v217, 106752, v217
    v_mfma_f32_32x32x16_bf16 v[120:135], v[172:175], v[156:159], v[120:135]
    v_add_u32 v218, 106752, v218
    v_add_u32 v219, 106752, v219
    v_add_u32 v220, 106752, v220
    v_mfma_f32_32x32x16_bf16 v[136:151], v[176:179], v[152:155], v[136:151]
    v_add_u32 v221, 106752, v221
    v_add_u32 v222, 106752, v222
    v_add_u32 v223, 106752, v223
    s_waitcnt lgkmcnt(0)
    s_barrier
    v_mfma_f32_32x32x16_bf16 v[8:23], v[188:191], v[180:183], v[8:23]
    ds_read_b128 v[152:155], v208 offset:0
    ds_read_b64_tr_b16 v[160:161], v216 offset:0
    ds_read_b64_tr_b16 v[162:163], v216 offset:1152
    v_mfma_f32_32x32x16_bf16 v[72:87], v[188:191], v[184:187], v[72:87]
    ds_read_b128 v[156:159], v212 offset:0
    ds_read_b64_tr_b16 v[164:165], v216 offset:32
    ds_read_b64_tr_b16 v[166:167], v216 offset:1184
    v_mfma_f32_32x32x16_bf16 v[24:39], v[192:195], v[180:183], v[24:39]
    ds_read_b64_tr_b16 v[168:169], v216 offset:64
    ds_read_b64_tr_b16 v[170:171], v216 offset:1216
    ds_read_b64_tr_b16 v[172:173], v216 offset:96
    v_mfma_f32_32x32x16_bf16 v[88:103], v[192:195], v[184:187], v[88:103]
    ds_read_b64_tr_b16 v[174:175], v216 offset:1248
    ds_read_b64_tr_b16 v[176:177], v220 offset:0
    ds_read_b64_tr_b16 v[178:179], v220 offset:1152
    v_mfma_f32_32x32x16_bf16 v[40:55], v[196:199], v[180:183], v[40:55]
    v_mfma_f32_32x32x16_bf16 v[104:119], v[196:199], v[184:187], v[104:119]
    v_mfma_f32_32x32x16_bf16 v[56:71], v[200:203], v[180:183], v[56:71]
    v_mfma_f32_32x32x16_bf16 v[120:135], v[200:203], v[184:187], v[120:135]
    v_mfma_f32_32x32x16_bf16 v[136:151], v[204:207], v[180:183], v[136:151]
    s_waitcnt lgkmcnt(0)
    v_mfma_f32_32x32x16_bf16 v[8:23], v[160:163], v[152:155], v[8:23]
    ds_read_b128 v[180:183], v209 offset:0
    v_lshlrev_b32 v2, 16, v168
    ds_read_b64_tr_b16 v[188:189], v217 offset:0
    v_and_b32 v3, s86, v168
    ds_read_b64_tr_b16 v[190:191], v217 offset:1152
    v_lshlrev_b32 v6, 16, v172
    v_mfma_f32_32x32x16_bf16 v[72:87], v[160:163], v[156:159], v[72:87]
    ds_read_b128 v[184:187], v213 offset:0
    v_and_b32 v7, s86, v172
    ds_read_b64_tr_b16 v[192:193], v217 offset:32
    v_add_f32 v244, v244, v2
    ds_read_b64_tr_b16 v[194:195], v217 offset:1184
    v_add_f32 v245, v245, v3
    v_mfma_f32_16x16x32_bf16 v[224:227], v[160:163], v[232:235], v[224:227]
    ds_read_b64_tr_b16 v[196:197], v217 offset:64
    v_add_f32 v246, v246, v6
    ds_read_b64_tr_b16 v[198:199], v217 offset:1216
    v_add_f32 v247, v247, v7
    ds_read_b64_tr_b16 v[200:201], v217 offset:96
    v_mfma_f32_32x32x16_bf16 v[24:39], v[164:167], v[152:155], v[24:39]
    v_lshlrev_b32 v2, 16, v176
    ds_read_b64_tr_b16 v[202:203], v217 offset:1248
    v_and_b32 v3, s86, v176
    ds_read_b64_tr_b16 v[204:205], v221 offset:0
    v_lshlrev_b32 v6, 16, v169
    ds_read_b64_tr_b16 v[206:207], v221 offset:1152
    v_mfma_f32_16x16x32_bf16 v[228:231], v[164:167], v[232:235], v[228:231]
    v_and_b32 v7, s86, v169
    v_add_f32 v248, v248, v2
    v_add_f32 v249, v249, v3
    v_add_f32 v244, v244, v6
    v_add_f32 v245, v245, v7
    v_mfma_f32_32x32x16_bf16 v[88:103], v[164:167], v[156:159], v[88:103]
    v_lshlrev_b32 v2, 16, v173
    v_and_b32 v3, s86, v173
    v_lshlrev_b32 v6, 16, v177
    v_and_b32 v7, s86, v177
    v_add_f32 v246, v246, v2
    v_add_f32 v247, v247, v3
    v_mfma_f32_32x32x16_bf16 v[40:55], v[168:171], v[152:155], v[40:55]
    v_add_f32 v248, v248, v6
    v_add_f32 v249, v249, v7
    v_lshlrev_b32 v2, 16, v170
    v_and_b32 v3, s86, v170
    v_lshlrev_b32 v6, 16, v174
    v_mfma_f32_32x32x16_bf16 v[104:119], v[168:171], v[156:159], v[104:119]
    v_and_b32 v7, s86, v174
    v_add_f32 v244, v244, v2
    v_add_f32 v245, v245, v3
    v_add_f32 v246, v246, v6
    v_add_f32 v247, v247, v7
    v_mfma_f32_32x32x16_bf16 v[56:71], v[172:175], v[152:155], v[56:71]
    v_lshlrev_b32 v2, 16, v178
    v_and_b32 v3, s86, v178
    v_lshlrev_b32 v6, 16, v171
    v_and_b32 v7, s86, v171
    v_add_f32 v248, v248, v2
    v_add_f32 v249, v249, v3
    v_mfma_f32_32x32x16_bf16 v[120:135], v[172:175], v[156:159], v[120:135]
    v_add_f32 v244, v244, v6
    v_add_f32 v245, v245, v7
    v_lshlrev_b32 v2, 16, v175
    v_and_b32 v3, s86, v175
    v_lshlrev_b32 v6, 16, v179
    v_mfma_f32_32x32x16_bf16 v[136:151], v[176:179], v[152:155], v[136:151]
    v_and_b32 v7, s86, v179
    v_add_f32 v246, v246, v2
    v_add_f32 v247, v247, v3
    v_add_f32 v248, v248, v6
    v_add_f32 v249, v249, v7
    s_waitcnt lgkmcnt(0)
    v_mfma_f32_32x32x16_bf16 v[8:23], v[188:191], v[180:183], v[8:23]
    ds_read_b128 v[152:155], v210 offset:0
    v_lshlrev_b32 v2, 16, v196
    ds_read_b64_tr_b16 v[160:161], v218 offset:0
    v_and_b32 v3, s86, v196
    v_mfma_f32_32x32x16_bf16 v[72:87], v[188:191], v[184:187], v[72:87]
    ds_read_b64_tr_b16 v[162:163], v218 offset:1152
    v_lshlrev_b32 v6, 16, v200
    ds_read_b128 v[156:159], v214 offset:0
    v_and_b32 v7, s86, v200
    v_mfma_f32_16x16x32_bf16 v[224:227], v[188:191], v[232:235], v[224:227]
    ds_read_b64_tr_b16 v[164:165], v218 offset:32
    v_add_f32 v244, v244, v2
    ds_read_b64_tr_b16 v[166:167], v218 offset:1184
    v_add_f32 v245, v245, v3
    v_mfma_f32_32x32x16_bf16 v[24:39], v[192:195], v[180:183], v[24:39]
    ds_read_b64_tr_b16 v[168:169], v218 offset:64
    v_add_f32 v246, v246, v6
    ds_read_b64_tr_b16 v[170:171], v218 offset:1216
    v_add_f32 v247, v247, v7
    v_mfma_f32_16x16x32_bf16 v[228:231], v[192:195], v[232:235], v[228:231]
    ds_read_b64_tr_b16 v[172:173], v218 offset:96
    ds_read_b64_tr_b16 v[174:175], v218 offset:1248
    ds_read_b64_tr_b16 v[176:177], v222 offset:0
    ds_read_b64_tr_b16 v[178:179], v222 offset:1152
    v_mfma_f32_32x32x16_bf16 v[88:103], v[192:195], v[184:187], v[88:103]
    v_lshlrev_b32 v2, 16, v197
    v_and_b32 v3, s86, v197
    v_lshlrev_b32 v6, 16, v201
    v_and_b32 v7, s86, v201
    v_mfma_f32_32x32x16_bf16 v[40:55], v[196:199], v[180:183], v[40:55]
    v_add_f32 v244, v244, v2
    v_add_f32 v245, v245, v3
    v_add_f32 v246, v246, v6
    v_add_f32 v247, v247, v7
    v_mfma_f32_32x32x16_bf16 v[104:119], v[196:199], v[184:187], v[104:119]
    v_lshlrev_b32 v2, 16, v198
    v_and_b32 v3, s86, v198
    v_lshlrev_b32 v6, 16, v202
    v_and_b32 v7, s86, v202
    v_mfma_f32_32x32x16_bf16 v[56:71], v[200:203], v[180:183], v[56:71]
    v_add_f32 v244, v244, v2
    v_add_f32 v245, v245, v3
    v_add_f32 v246, v246, v6
    v_add_f32 v247, v247, v7
    v_mfma_f32_32x32x16_bf16 v[120:135], v[200:203], v[184:187], v[120:135]
    v_lshlrev_b32 v2, 16, v199
    v_and_b32 v3, s86, v199
    v_lshlrev_b32 v6, 16, v203
    v_and_b32 v7, s86, v203
    v_mfma_f32_32x32x16_bf16 v[136:151], v[204:207], v[180:183], v[136:151]
    v_add_f32 v244, v244, v2
    v_add_f32 v245, v245, v3
    v_add_f32 v246, v246, v6
    v_add_f32 v247, v247, v7
    s_waitcnt lgkmcnt(0)
    v_mfma_f32_32x32x16_bf16 v[8:23], v[160:163], v[152:155], v[8:23]
    ds_read_b128 v[180:183], v211 offset:0
    ds_read_b64_tr_b16 v[188:189], v219 offset:0
    ds_read_b64_tr_b16 v[190:191], v219 offset:1152
    v_mfma_f32_32x32x16_bf16 v[72:87], v[160:163], v[156:159], v[72:87]
    ds_read_b128 v[184:187], v215 offset:0
    ds_read_b64_tr_b16 v[192:193], v219 offset:32
    ds_read_b64_tr_b16 v[194:195], v219 offset:1184
    v_mfma_f32_32x32x16_bf16 v[24:39], v[164:167], v[152:155], v[24:39]
    ds_read_b64_tr_b16 v[196:197], v219 offset:64
    ds_read_b64_tr_b16 v[198:199], v219 offset:1216
    ds_read_b64_tr_b16 v[200:201], v219 offset:96
    v_mfma_f32_32x32x16_bf16 v[88:103], v[164:167], v[156:159], v[88:103]
    ds_read_b64_tr_b16 v[202:203], v219 offset:1248
    ds_read_b64_tr_b16 v[204:205], v223 offset:0
    ds_read_b64_tr_b16 v[206:207], v223 offset:1152
    v_mfma_f32_32x32x16_bf16 v[40:55], v[168:171], v[152:155], v[40:55]
    v_add_u32 v208, 4294860544, v208
    v_add_u32 v209, 4294860544, v209
    v_add_u32 v210, 4294860544, v210
    v_add_u32 v211, 4294860544, v211
    v_mfma_f32_32x32x16_bf16 v[104:119], v[168:171], v[156:159], v[104:119]
    v_add_u32 v212, 4294860544, v212
    v_add_u32 v213, 4294860544, v213
    v_add_u32 v214, 4294860544, v214
    v_mfma_f32_32x32x16_bf16 v[56:71], v[172:175], v[152:155], v[56:71]
    v_add_u32 v215, 4294860544, v215
    v_add_u32 v216, 4294860544, v216
    v_add_u32 v217, 4294860544, v217
    v_mfma_f32_32x32x16_bf16 v[120:135], v[172:175], v[156:159], v[120:135]
    v_add_u32 v218, 4294860544, v218
    v_add_u32 v219, 4294860544, v219
    v_add_u32 v220, 4294860544, v220
    v_mfma_f32_32x32x16_bf16 v[136:151], v[176:179], v[152:155], v[136:151]
    v_add_u32 v221, 4294860544, v221
    v_add_u32 v222, 4294860544, v222
    v_add_u32 v223, 4294860544, v223
    s_waitcnt lgkmcnt(0)
    s_barrier
    v_mfma_f32_32x32x16_bf16 v[8:23], v[188:191], v[180:183], v[8:23]
    ds_read_b128 v[152:155], v208 offset:0
    ds_read_b64_tr_b16 v[160:161], v216 offset:0
    ds_read_b64_tr_b16 v[162:163], v216 offset:1152
    v_mfma_f32_32x32x16_bf16 v[72:87], v[188:191], v[184:187], v[72:87]
    ds_read_b128 v[156:159], v212 offset:0
    ds_read_b64_tr_b16 v[164:165], v216 offset:32
    ds_read_b64_tr_b16 v[166:167], v216 offset:1184
    v_mfma_f32_32x32x16_bf16 v[24:39], v[192:195], v[180:183], v[24:39]
    ds_read_b64_tr_b16 v[168:169], v216 offset:64
    ds_read_b64_tr_b16 v[170:171], v216 offset:1216
    ds_read_b64_tr_b16 v[172:173], v216 offset:96
    v_mfma_f32_32x32x16_bf16 v[88:103], v[192:195], v[184:187], v[88:103]
    ds_read_b64_tr_b16 v[174:175], v216 offset:1248
    ds_read_b64_tr_b16 v[176:177], v220 offset:0
    ds_read_b64_tr_b16 v[178:179], v220 offset:1152
    v_mfma_f32_32x32x16_bf16 v[40:55], v[196:199], v[180:183], v[40:55]
    v_and_b32 v250, 31, v0
    v_lshlrev_b32 v1, 3, v250
    v_lshlrev_b32 v250, 2, v250
    s_lshl_b32 s79, s75, 11
    s_add_u32 s79, s79, 154048
    v_mfma_f32_32x32x16_bf16 v[104:119], v[196:199], v[184:187], v[104:119]
    s_lshl_b32 s78, s74, 7
    v_and_b32 v252, 1, v0
    v_lshlrev_b32 v252, 6, v252
    v_lshrrev_b32 v6, 4, v0
    v_lshl_add_u32 v252, v6, 4, v252
    v_mfma_f32_32x32x16_bf16 v[56:71], v[200:203], v[180:183], v[56:71]
    v_add_u32 v250, s79, v250
    v_add_u32 v251, s78, v250
    s_add_u32 s78, s78, s79
    v_add_u32 v252, s78, v252
    v_mfma_f32_32x32x16_bf16 v[120:135], v[200:203], v[184:187], v[120:135]
    s_lshl_b32 s78, s75, 11
    s_sub_u32 s85, 4096, s78
    s_sub_u32 s79, s76, s74
    s_lshl_b32 s79, s79, 7
    s_add_u32 s81, s85, s79
    v_mfma_f32_32x32x16_bf16 v[136:151], v[204:207], v[180:183], v[136:151]
    v_add_u32 v253, s85, v250
    v_add_u32 v254, s81, v251
    buffer_load_dword v5, v4, s[64:67], 0 offen sc1
    s_waitcnt lgkmcnt(0)
    v_mfma_f32_32x32x16_bf16 v[8:23], v[160:163], v[152:155], v[8:23]
    ds_read_b128 v[180:183], v209 offset:0
    v_lshlrev_b32 v2, 16, v168
    ds_read_b64_tr_b16 v[188:189], v217 offset:0
    v_and_b32 v3, s86, v168
    ds_read_b64_tr_b16 v[190:191], v217 offset:1152
    v_lshlrev_b32 v6, 16, v172
    v_mfma_f32_32x32x16_bf16 v[72:87], v[160:163], v[156:159], v[72:87]
    ds_read_b128 v[184:187], v213 offset:0
    v_and_b32 v7, s86, v172
    ds_read_b64_tr_b16 v[192:193], v217 offset:32
    v_add_f32 v244, v244, v2
    ds_read_b64_tr_b16 v[194:195], v217 offset:1184
    v_add_f32 v245, v245, v3
    v_mfma_f32_16x16x32_bf16 v[224:227], v[160:163], v[232:235], v[224:227]
    ds_read_b64_tr_b16 v[196:197], v217 offset:64
    v_add_f32 v246, v246, v6
    ds_read_b64_tr_b16 v[198:199], v217 offset:1216
    v_add_f32 v247, v247, v7
    ds_read_b64_tr_b16 v[200:201], v217 offset:96
    v_mfma_f32_32x32x16_bf16 v[24:39], v[164:167], v[152:155], v[24:39]
    v_lshlrev_b32 v2, 16, v176
    ds_read_b64_tr_b16 v[202:203], v217 offset:1248
    v_and_b32 v3, s86, v176
    ds_read_b64_tr_b16 v[204:205], v221 offset:0
    v_lshlrev_b32 v6, 16, v169
    ds_read_b64_tr_b16 v[206:207], v221 offset:1152
    v_mfma_f32_16x16x32_bf16 v[228:231], v[164:167], v[232:235], v[228:231]
    v_and_b32 v7, s86, v169
    v_add_f32 v248, v248, v2
    v_add_f32 v249, v249, v3
    v_add_f32 v244, v244, v6
    v_add_f32 v245, v245, v7
    v_mfma_f32_32x32x16_bf16 v[88:103], v[164:167], v[156:159], v[88:103]
    v_lshlrev_b32 v2, 16, v173
    v_and_b32 v3, s86, v173
    v_lshlrev_b32 v6, 16, v177
    v_and_b32 v7, s86, v177
    v_add_f32 v246, v246, v2
    v_add_f32 v247, v247, v3
    v_mfma_f32_32x32x16_bf16 v[40:55], v[168:171], v[152:155], v[40:55]
    v_add_f32 v248, v248, v6
    v_add_f32 v249, v249, v7
    v_lshlrev_b32 v2, 16, v170
    v_and_b32 v3, s86, v170
    v_lshlrev_b32 v6, 16, v174
    v_mfma_f32_32x32x16_bf16 v[104:119], v[168:171], v[156:159], v[104:119]
    v_and_b32 v7, s86, v174
    v_add_f32 v244, v244, v2
    v_add_f32 v245, v245, v3
    v_add_f32 v246, v246, v6
    v_add_f32 v247, v247, v7
    v_mfma_f32_32x32x16_bf16 v[56:71], v[172:175], v[152:155], v[56:71]
    v_lshlrev_b32 v2, 16, v178
    v_and_b32 v3, s86, v178
    v_lshlrev_b32 v6, 16, v171
    v_and_b32 v7, s86, v171
    v_add_f32 v248, v248, v2
    v_add_f32 v249, v249, v3
    v_mfma_f32_32x32x16_bf16 v[120:135], v[172:175], v[156:159], v[120:135]
    v_add_f32 v244, v244, v6
    v_add_f32 v245, v245, v7
    v_lshlrev_b32 v2, 16, v175
    v_and_b32 v3, s86, v175
    v_lshlrev_b32 v6, 16, v179
    v_mfma_f32_32x32x16_bf16 v[136:151], v[176:179], v[152:155], v[136:151]
    v_and_b32 v7, s86, v179
    v_add_f32 v246, v246, v2
    v_add_f32 v247, v247, v3
    v_add_f32 v248, v248, v6
    v_add_f32 v249, v249, v7
    s_waitcnt lgkmcnt(0)
    v_mfma_f32_32x32x16_bf16 v[8:23], v[188:191], v[180:183], v[8:23]
    ds_read_b128 v[152:155], v210 offset:0
    v_lshlrev_b32 v2, 16, v196
    ds_read_b64_tr_b16 v[160:161], v218 offset:0
    v_and_b32 v3, s86, v196
    v_mfma_f32_32x32x16_bf16 v[72:87], v[188:191], v[184:187], v[72:87]
    ds_read_b64_tr_b16 v[162:163], v218 offset:1152
    v_lshlrev_b32 v6, 16, v200
    ds_read_b128 v[156:159], v214 offset:0
    v_and_b32 v7, s86, v200
    v_mfma_f32_16x16x32_bf16 v[224:227], v[188:191], v[232:235], v[224:227]
    ds_read_b64_tr_b16 v[164:165], v218 offset:32
    v_add_f32 v244, v244, v2
    ds_read_b64_tr_b16 v[166:167], v218 offset:1184
    v_add_f32 v245, v245, v3
    v_mfma_f32_32x32x16_bf16 v[24:39], v[192:195], v[180:183], v[24:39]
    ds_read_b64_tr_b16 v[168:169], v218 offset:64
    v_add_f32 v246, v246, v6
    ds_read_b64_tr_b16 v[170:171], v218 offset:1216
    v_add_f32 v247, v247, v7
    v_mfma_f32_16x16x32_bf16 v[228:231], v[192:195], v[232:235], v[228:231]
    ds_read_b64_tr_b16 v[172:173], v218 offset:96
    ds_read_b64_tr_b16 v[174:175], v218 offset:1248
    ds_read_b64_tr_b16 v[176:177], v222 offset:0
    ds_read_b64_tr_b16 v[178:179], v222 offset:1152
    v_mfma_f32_32x32x16_bf16 v[88:103], v[192:195], v[184:187], v[88:103]
    v_lshlrev_b32 v2, 16, v197
    v_and_b32 v3, s86, v197
    v_lshlrev_b32 v6, 16, v201
    v_and_b32 v7, s86, v201
    v_mfma_f32_32x32x16_bf16 v[40:55], v[196:199], v[180:183], v[40:55]
    v_add_f32 v244, v244, v2
    v_add_f32 v245, v245, v3
    v_add_f32 v246, v246, v6
    v_add_f32 v247, v247, v7
    v_mfma_f32_32x32x16_bf16 v[104:119], v[196:199], v[184:187], v[104:119]
    v_lshlrev_b32 v2, 16, v198
    v_and_b32 v3, s86, v198
    v_lshlrev_b32 v6, 16, v202
    v_and_b32 v7, s86, v202
    v_mfma_f32_32x32x16_bf16 v[56:71], v[200:203], v[180:183], v[56:71]
    v_add_f32 v244, v244, v2
    v_add_f32 v245, v245, v3
    v_add_f32 v246, v246, v6
    v_add_f32 v247, v247, v7
    v_mfma_f32_32x32x16_bf16 v[120:135], v[200:203], v[184:187], v[120:135]
    v_lshlrev_b32 v2, 16, v199
    v_and_b32 v3, s86, v199
    v_lshlrev_b32 v6, 16, v203
    v_and_b32 v7, s86, v203
    v_mfma_f32_32x32x16_bf16 v[136:151], v[204:207], v[180:183], v[136:151]
    v_add_f32 v244, v244, v2
    v_add_f32 v245, v245, v3
    v_add_f32 v246, v246, v6
    v_add_f32 v247, v247, v7
    s_waitcnt lgkmcnt(0)
    v_mfma_f32_32x32x16_bf16 v[8:23], v[160:163], v[152:155], v[8:23]
    ds_read_b128 v[180:183], v211 offset:0
    ds_read_b64_tr_b16 v[188:189], v219 offset:0
    ds_read_b64_tr_b16 v[190:191], v219 offset:1152
    v_mfma_f32_32x32x16_bf16 v[72:87], v[160:163], v[156:159], v[72:87]
    ds_read_b128 v[184:187], v215 offset:0
    ds_read_b64_tr_b16 v[192:193], v219 offset:32
    ds_read_b64_tr_b16 v[194:195], v219 offset:1184
    v_mfma_f32_32x32x16_bf16 v[24:39], v[164:167], v[152:155], v[24:39]
    ds_read_b64_tr_b16 v[196:197], v219 offset:64
    ds_read_b64_tr_b16 v[198:199], v219 offset:1216
    ds_read_b64_tr_b16 v[200:201], v219 offset:96
    v_mfma_f32_32x32x16_bf16 v[88:103], v[164:167], v[156:159], v[88:103]
    ds_read_b64_tr_b16 v[202:203], v219 offset:1248
    ds_read_b64_tr_b16 v[204:205], v223 offset:0
    ds_read_b64_tr_b16 v[206:207], v223 offset:1152
    v_mfma_f32_32x32x16_bf16 v[40:55], v[168:171], v[152:155], v[40:55]
    v_mfma_f32_32x32x16_bf16 v[104:119], v[168:171], v[156:159], v[104:119]
    v_mfma_f32_32x32x16_bf16 v[56:71], v[172:175], v[152:155], v[56:71]
    v_mfma_f32_32x32x16_bf16 v[120:135], v[172:175], v[156:159], v[120:135]
    v_mfma_f32_32x32x16_bf16 v[136:151], v[176:179], v[152:155], v[136:151]
    s_waitcnt lgkmcnt(0)
    s_barrier
    v_mfma_f32_32x32x16_bf16 v[8:23], v[188:191], v[180:183], v[8:23]
    ds_read_b128 v[152:155], v208 offset:53376
    ds_read_b64_tr_b16 v[160:161], v216 offset:53376
    ds_read_b64_tr_b16 v[162:163], v216 offset:54528
    v_mfma_f32_32x32x16_bf16 v[72:87], v[188:191], v[184:187], v[72:87]
    ds_read_b128 v[156:159], v212 offset:53376
    ds_read_b64_tr_b16 v[164:165], v216 offset:53408
    ds_read_b64_tr_b16 v[166:167], v216 offset:54560
    v_mfma_f32_32x32x16_bf16 v[24:39], v[192:195], v[180:183], v[24:39]
    ds_read_b64_tr_b16 v[168:169], v216 offset:53440
    ds_read_b64_tr_b16 v[170:171], v216 offset:54592
    ds_read_b64_tr_b16 v[172:173], v216 offset:53472
    v_mfma_f32_32x32x16_bf16 v[88:103], v[192:195], v[184:187], v[88:103]
    ds_read_b64_tr_b16 v[174:175], v216 offset:54624
    ds_read_b64_tr_b16 v[176:177], v220 offset:53376
    ds_read_b64_tr_b16 v[178:179], v220 offset:54528
    v_mfma_f32_32x32x16_bf16 v[40:55], v[196:199], v[180:183], v[40:55]
    s_waitcnt vmcnt(0)
    v_cmp_gt_u32 vcc, 16, v5
    s_nop 0
    s_and_b32 s78, vcc_lo, 0xffff
    s_cbranch_scc1 k1_ffn_c_cw
k1_ffn_c_cok:
    s_lshl_b32 s78, s72, 2
    s_add_u32 s78, s78, s83
    s_lshl_b32 s78, s78, 8
    s_add_u32 s78, s78, 65536
    buffer_load_dwordx2 v[236:237], v1, s[56:59], s78 offen sc1
    s_lshl_b32 s78, s72, 2
    s_add_u32 s78, s78, s84
    s_lshl_b32 s78, s78, 8
    s_add_u32 s78, s78, 65536
    buffer_load_dwordx2 v[240:241], v1, s[56:59], s78 offen sc1
    v_mfma_f32_32x32x16_bf16 v[104:119], v[196:199], v[184:187], v[104:119]
    v_mfma_f32_32x32x16_bf16 v[56:71], v[200:203], v[180:183], v[56:71]
    v_mfma_f32_32x32x16_bf16 v[120:135], v[200:203], v[184:187], v[120:135]
    v_mfma_f32_32x32x16_bf16 v[136:151], v[204:207], v[180:183], v[136:151]
    s_waitcnt lgkmcnt(0)
    v_mfma_f32_32x32x16_bf16 v[8:23], v[160:163], v[152:155], v[8:23]
    ds_read_b128 v[180:183], v209 offset:53376
    v_lshlrev_b32 v2, 16, v168
    ds_read_b64_tr_b16 v[188:189], v217 offset:53376
    v_and_b32 v3, s86, v168
    ds_read_b64_tr_b16 v[190:191], v217 offset:54528
    v_lshlrev_b32 v6, 16, v172
    v_mfma_f32_32x32x16_bf16 v[72:87], v[160:163], v[156:159], v[72:87]
    ds_read_b128 v[184:187], v213 offset:53376
    v_and_b32 v7, s86, v172
    ds_read_b64_tr_b16 v[192:193], v217 offset:53408
    v_add_f32 v244, v244, v2
    ds_read_b64_tr_b16 v[194:195], v217 offset:54560
    v_add_f32 v245, v245, v3
    v_mfma_f32_16x16x32_bf16 v[224:227], v[160:163], v[232:235], v[224:227]
    ds_read_b64_tr_b16 v[196:197], v217 offset:53440
    v_add_f32 v246, v246, v6
    ds_read_b64_tr_b16 v[198:199], v217 offset:54592
    v_add_f32 v247, v247, v7
    ds_read_b64_tr_b16 v[200:201], v217 offset:53472
    v_mfma_f32_32x32x16_bf16 v[24:39], v[164:167], v[152:155], v[24:39]
    v_lshlrev_b32 v2, 16, v176
    ds_read_b64_tr_b16 v[202:203], v217 offset:54624
    v_and_b32 v3, s86, v176
    ds_read_b64_tr_b16 v[204:205], v221 offset:53376
    v_lshlrev_b32 v6, 16, v169
    ds_read_b64_tr_b16 v[206:207], v221 offset:54528
    v_mfma_f32_16x16x32_bf16 v[228:231], v[164:167], v[232:235], v[228:231]
    v_and_b32 v7, s86, v169
    v_add_f32 v248, v248, v2
    v_add_f32 v249, v249, v3
    v_add_f32 v244, v244, v6
    v_add_f32 v245, v245, v7
    v_mfma_f32_32x32x16_bf16 v[88:103], v[164:167], v[156:159], v[88:103]
    v_lshlrev_b32 v2, 16, v173
    v_and_b32 v3, s86, v173
    v_lshlrev_b32 v6, 16, v177
    v_and_b32 v7, s86, v177
    v_add_f32 v246, v246, v2
    v_add_f32 v247, v247, v3
    v_mfma_f32_32x32x16_bf16 v[40:55], v[168:171], v[152:155], v[40:55]
    v_add_f32 v248, v248, v6
    v_add_f32 v249, v249, v7
    v_lshlrev_b32 v2, 16, v170
    v_and_b32 v3, s86, v170
    v_lshlrev_b32 v6, 16, v174
    v_mfma_f32_32x32x16_bf16 v[104:119], v[168:171], v[156:159], v[104:119]
    v_and_b32 v7, s86, v174
    v_add_f32 v244, v244, v2
    v_add_f32 v245, v245, v3
    v_add_f32 v246, v246, v6
    v_add_f32 v247, v247, v7
    v_mfma_f32_32x32x16_bf16 v[56:71], v[172:175], v[152:155], v[56:71]
    v_lshlrev_b32 v2, 16, v178
    v_and_b32 v3, s86, v178
    v_lshlrev_b32 v6, 16, v171
    v_and_b32 v7, s86, v171
    v_add_f32 v248, v248, v2
    v_add_f32 v249, v249, v3
    v_mfma_f32_32x32x16_bf16 v[120:135], v[172:175], v[156:159], v[120:135]
    v_add_f32 v244, v244, v6
    v_add_f32 v245, v245, v7
    v_lshlrev_b32 v2, 16, v175
    v_and_b32 v3, s86, v175
    v_lshlrev_b32 v6, 16, v179
    v_mfma_f32_32x32x16_bf16 v[136:151], v[176:179], v[152:155], v[136:151]
    v_and_b32 v7, s86, v179
    v_add_f32 v246, v246, v2
    v_add_f32 v247, v247, v3
    v_add_f32 v248, v248, v6
    v_add_f32 v249, v249, v7
    s_waitcnt lgkmcnt(0)
    v_mfma_f32_32x32x16_bf16 v[8:23], v[188:191], v[180:183], v[8:23]
    ds_read_b128 v[152:155], v210 offset:53376
    v_lshlrev_b32 v2, 16, v196
    ds_read_b64_tr_b16 v[160:161], v218 offset:53376
    v_and_b32 v3, s86, v196
    v_mfma_f32_32x32x16_bf16 v[72:87], v[188:191], v[184:187], v[72:87]
    ds_read_b64_tr_b16 v[162:163], v218 offset:54528
    v_lshlrev_b32 v6, 16, v200
    ds_read_b128 v[156:159], v214 offset:53376
    v_and_b32 v7, s86, v200
    v_mfma_f32_16x16x32_bf16 v[224:227], v[188:191], v[232:235], v[224:227]
    ds_read_b64_tr_b16 v[164:165], v218 offset:53408
    v_add_f32 v244, v244, v2
    ds_read_b64_tr_b16 v[166:167], v218 offset:54560
    v_add_f32 v245, v245, v3
    v_mfma_f32_32x32x16_bf16 v[24:39], v[192:195], v[180:183], v[24:39]
    ds_read_b64_tr_b16 v[168:169], v218 offset:53440
    v_add_f32 v246, v246, v6
    ds_read_b64_tr_b16 v[170:171], v218 offset:54592
    v_add_f32 v247, v247, v7
    v_mfma_f32_16x16x32_bf16 v[228:231], v[192:195], v[232:235], v[228:231]
    ds_read_b64_tr_b16 v[172:173], v218 offset:53472
    ds_read_b64_tr_b16 v[174:175], v218 offset:54624
    ds_read_b64_tr_b16 v[176:177], v222 offset:53376
    ds_read_b64_tr_b16 v[178:179], v222 offset:54528
    v_mfma_f32_32x32x16_bf16 v[88:103], v[192:195], v[184:187], v[88:103]
    v_lshlrev_b32 v2, 16, v197
    v_and_b32 v3, s86, v197
    v_lshlrev_b32 v6, 16, v201
    v_and_b32 v7, s86, v201
    v_mfma_f32_32x32x16_bf16 v[40:55], v[196:199], v[180:183], v[40:55]
    v_add_f32 v244, v244, v2
    v_add_f32 v245, v245, v3
    v_add_f32 v246, v246, v6
    v_add_f32 v247, v247, v7
    v_mfma_f32_32x32x16_bf16 v[104:119], v[196:199], v[184:187], v[104:119]
    v_lshlrev_b32 v2, 16, v198
    v_and_b32 v3, s86, v198
    v_lshlrev_b32 v6, 16, v202
    v_and_b32 v7, s86, v202
    v_mfma_f32_32x32x16_bf16 v[56:71], v[200:203], v[180:183], v[56:71]
    v_add_f32 v244, v244, v2
    v_add_f32 v245, v245, v3
    v_add_f32 v246, v246, v6
    v_add_f32 v247, v247, v7
    v_mfma_f32_32x32x16_bf16 v[120:135], v[200:203], v[184:187], v[120:135]
    v_lshlrev_b32 v2, 16, v199
    v_and_b32 v3, s86, v199
    v_lshlrev_b32 v6, 16, v203
    v_and_b32 v7, s86, v203
    v_mfma_f32_32x32x16_bf16 v[136:151], v[204:207], v[180:183], v[136:151]
    v_add_f32 v244, v244, v2
    v_add_f32 v245, v245, v3
    v_add_f32 v246, v246, v6
    v_add_f32 v247, v247, v7
    s_waitcnt lgkmcnt(0)
    v_mfma_f32_32x32x16_bf16 v[8:23], v[160:163], v[152:155], v[8:23]
    ds_read_b128 v[180:183], v211 offset:53376
    ds_read_b64_tr_b16 v[188:189], v219 offset:53376
    ds_read_b64_tr_b16 v[190:191], v219 offset:54528
    ds_read_b128 v[184:187], v215 offset:53376
    ds_read_b64_tr_b16 v[192:193], v219 offset:53408
    ds_read_b64_tr_b16 v[194:195], v219 offset:54560
    ds_read_b64_tr_b16 v[196:197], v219 offset:53440
    ds_read_b64_tr_b16 v[198:199], v219 offset:54592
    v_mfma_f32_32x32x16_bf16 v[72:87], v[160:163], v[156:159], v[72:87]
    ds_read_b64_tr_b16 v[200:201], v219 offset:53472
    ds_read_b64_tr_b16 v[202:203], v219 offset:54624
    ds_read_b64_tr_b16 v[204:205], v223 offset:53376
    ds_read_b64_tr_b16 v[206:207], v223 offset:54528
    v_add_f32 v244, v244, v245
    v_add_f32 v246, v246, v247
    v_add_f32 v248, v248, v249
    v_mfma_f32_32x32x16_bf16 v[24:39], v[164:167], v[152:155], v[24:39]
    v_mov_b32 v245, v244
    v_mov_b32 v247, v246
    v_mov_b32 v249, v248
    v_permlane32_swap_b32 v244, v245
    v_permlane32_swap_b32 v246, v247
    v_permlane32_swap_b32 v248, v249
    v_add_f32 v244, v244, v245
    v_mfma_f32_32x32x16_bf16 v[88:103], v[164:167], v[156:159], v[88:103]
    v_add_f32 v246, v246, v247
    v_add_f32 v248, v248, v249
    ds_write_b128 v252, v[224:227] offset:0
    ds_write_b128 v252, v[228:231] offset:512
    ds_write_b32 v251, v244 offset:1024
    ds_write_b32 v251, v246 offset:1536
    ds_write_b32 v254, v248 offset:0
    s_waitcnt lgkmcnt(0)
    s_barrier
    ds_read_b32 v224, v250 offset:0
    ds_read_b32 v225, v250 offset:128
    ds_read_b32 v228, v250 offset:512
    ds_read_b32 v229, v250 offset:640
    ds_read_b32 v216, v250 offset:1024
    ds_read_b32 v217, v250 offset:1152
    ds_read_b32 v220, v250 offset:1536
    ds_read_b32 v221, v250 offset:1664
    ds_read_b32 v232, v253 offset:0
    ds_read_b32 v233, v253 offset:128
    ds_read_b32 v234, v253 offset:256
    ds_read_b32 v235, v253 offset:384
    s_waitcnt vmcnt(0)
    s_mov_b32 vcc_lo, -1
    s_mov_b32 vcc_hi, 0
    v_mfma_f32_32x32x16_bf16 v[40:55], v[168:171], v[152:155], v[40:55]
    v_cvt_pk_bf16_f32 v208, v236, v236
    v_cvt_pk_bf16_f32 v212, v240, v240
    v_rsq_f32 v239, v237
    v_rsq_f32 v243, v241
    v_mfma_f32_32x32x16_bf16 v[104:119], v[168:171], v[156:159], v[104:119]
    v_and_b32 v210, s86, v208
    v_and_b32 v214, s86, v212
    v_sub_f32 v210, v236, v210
    v_sub_f32 v214, v240, v214
    v_mfma_f32_32x32x16_bf16 v[56:71], v[172:175], v[152:155], v[56:71]
    v_cvt_pk_bf16_f32 v209, v210, 0
    v_cvt_pk_bf16_f32 v213, v214, 0
    v_cndmask_b32 v208, 0, v208, vcc
    v_cndmask_b32 v212, 0, v212, vcc
    v_mfma_f32_32x32x16_bf16 v[120:135], v[172:175], v[156:159], v[120:135]
    v_cndmask_b32 v209, 0, v209, vcc
    v_cndmask_b32 v213, 0, v213, vcc
    v_mov_b32 v210, 0
    v_mov_b32 v214, 0
    v_mfma_f32_32x32x16_bf16 v[136:151], v[176:179], v[152:155], v[136:151]
    v_mov_b32 v211, 0
    v_mov_b32 v215, 0
    v_mul_f32 v238, 0xbfb8aa3b, v239
    v_mul_f32 v242, 0xbfb8aa3b, v243
    s_waitcnt lgkmcnt(0)
    v_mfma_f32_32x32x16_bf16 v[8:23], v[188:191], v[180:183], v[8:23]
    v_add_f32 v224, v224, v225
    v_add_f32 v228, v228, v229
    v_add_f32 v216, v216, v217
    v_add_f32 v220, v220, v221
    v_add_f32 v232, v232, v233
    v_cvt_pk_bf16_f32 v225, v224, v224
    v_cvt_pk_bf16_f32 v229, v228, v228
    v_cvt_pk_bf16_f32 v217, v216, v216
    v_cvt_pk_bf16_f32 v221, v220, v220
    v_add_f32 v234, v234, v235
    v_and_b32 v225, s86, v225
    v_mfma_f32_32x32x16_bf16 v[72:87], v[188:191], v[184:187], v[72:87]
    v_and_b32 v229, s86, v229
    v_and_b32 v217, s86, v217
    v_and_b32 v221, s86, v221
    v_add_f32 v232, v232, v234
    v_sub_f32 v225, v224, v225
    v_sub_f32 v229, v228, v229
    v_sub_f32 v217, v216, v217
    v_sub_f32 v221, v220, v221
    v_cvt_pk_bf16_f32 v233, v232, v232
    v_cvt_pk_bf16_f32 v224, v224, v225
    v_mfma_f32_32x32x16_bf16 v[24:39], v[192:195], v[180:183], v[24:39]
    v_cvt_pk_bf16_f32 v228, v228, v229
    v_cvt_pk_bf16_f32 v216, v216, v217
    v_cvt_pk_bf16_f32 v220, v220, v221
    v_and_b32 v233, s86, v233
    v_mov_b32 v225, v224
    v_mov_b32 v229, v228
    v_mov_b32 v217, v216
    v_mov_b32 v221, v220
    v_sub_f32 v233, v232, v233
    v_mov_b32 v226, 0
    v_mov_b32 v230, 0
    v_mfma_f32_32x32x16_bf16 v[88:103], v[192:195], v[184:187], v[88:103]
    v_mov_b32 v218, 0
    v_mov_b32 v222, 0
    v_cvt_pk_bf16_f32 v232, v232, v233
    v_mov_b32 v227, 0
    v_mov_b32 v231, 0
    v_mov_b32 v219, 0
    v_mov_b32 v223, 0
    v_mov_b32 v233, v232
    v_mov_b32 v234, 0
    v_mov_b32 v235, 0
    v_mfma_f32_32x32x16_bf16 v[8:23], v[224:227], v[208:211], v[8:23]
    v_mfma_f32_32x32x16_bf16 v[72:87], v[224:227], v[212:215], v[72:87]
    v_mfma_f32_32x32x16_bf16 v[24:39], v[228:231], v[208:211], v[24:39]
    v_mfma_f32_32x32x16_bf16 v[88:103], v[228:231], v[212:215], v[88:103]
    s_nop 8
    v_mul_f32 v152, v8, v238
    v_mul_f32 v153, v9, v238
    v_mul_f32 v154, v10, v238
    v_mul_f32 v155, v11, v238
    v_mul_f32 v156, v12, v238
    v_mul_f32 v157, v13, v238
    v_mul_f32 v158, v14, v238
    v_mul_f32 v159, v15, v238
    v_exp_f32 v152, v152
    v_exp_f32 v153, v153
    v_exp_f32 v154, v154
    v_exp_f32 v155, v155
    v_exp_f32 v156, v156
    v_exp_f32 v157, v157
    v_exp_f32 v158, v158
    v_exp_f32 v159, v159
    v_mul_f32 v8, v8, v16
    v_mul_f32 v9, v9, v17
    v_mul_f32 v10, v10, v18
    v_mul_f32 v11, v11, v19
    v_mul_f32 v12, v12, v20
    v_mul_f32 v13, v13, v21
    v_mul_f32 v14, v14, v22
    v_mul_f32 v15, v15, v23
    v_fma_f32 v152, v152, v237, v237
    v_fma_f32 v153, v153, v237, v237
    v_fma_f32 v154, v154, v237, v237
    v_fma_f32 v155, v155, v237, v237
    v_fma_f32 v156, v156, v237, v237
    v_fma_f32 v157, v157, v237, v237
    v_fma_f32 v158, v158, v237, v237
    v_fma_f32 v159, v159, v237, v237
    v_rcp_f32 v152, v152
    v_rcp_f32 v153, v153
    v_rcp_f32 v154, v154
    v_rcp_f32 v155, v155
    v_rcp_f32 v156, v156
    v_rcp_f32 v157, v157
    v_rcp_f32 v158, v158
    v_rcp_f32 v159, v159
    v_mul_f32 v8, v8, v152
    v_mul_f32 v9, v9, v153
    v_mul_f32 v10, v10, v154
    v_mul_f32 v11, v11, v155
    v_mul_f32 v12, v12, v156
    v_mul_f32 v13, v13, v157
    v_mul_f32 v14, v14, v158
    v_mul_f32 v15, v15, v159
    v_cvt_pk_bf16_f32 v16, v8, v9
    v_cvt_pk_bf16_f32 v17, v10, v11
    v_cvt_pk_bf16_f32 v18, v12, v13
    v_cvt_pk_bf16_f32 v19, v14, v15
    buffer_store_dwordx4 v[16:19], v4, s[40:43], s88 offen offset:0 sc1
    v_mfma_f32_32x32x16_bf16 v[40:55], v[196:199], v[180:183], v[40:55]
    v_mul_f32 v160, v72, v242
    v_mul_f32 v161, v73, v242
    v_mul_f32 v162, v74, v242
    v_mul_f32 v163, v75, v242
    v_mul_f32 v164, v76, v242
    v_mul_f32 v165, v77, v242
    v_mul_f32 v166, v78, v242
    v_mul_f32 v167, v79, v242
    v_exp_f32 v160, v160
    v_exp_f32 v161, v161
    v_exp_f32 v162, v162
    v_exp_f32 v163, v163
    v_exp_f32 v164, v164
    v_exp_f32 v165, v165
    v_exp_f32 v166, v166
    v_exp_f32 v167, v167
    v_mul_f32 v72, v72, v80
    v_mul_f32 v73, v73, v81
    v_mul_f32 v74, v74, v82
    v_mul_f32 v75, v75, v83
    v_mul_f32 v76, v76, v84
    v_mul_f32 v77, v77, v85
    v_mul_f32 v78, v78, v86
    v_mul_f32 v79, v79, v87
    v_mfma_f32_32x32x16_bf16 v[40:55], v[216:219], v[208:211], v[40:55]
    v_fma_f32 v160, v160, v241, v241
    v_fma_f32 v161, v161, v241, v241
    v_fma_f32 v162, v162, v241, v241
    v_fma_f32 v163, v163, v241, v241
    v_fma_f32 v164, v164, v241, v241
    v_fma_f32 v165, v165, v241, v241
    v_fma_f32 v166, v166, v241, v241
    v_fma_f32 v167, v167, v241, v241
    v_rcp_f32 v160, v160
    v_rcp_f32 v161, v161
    v_rcp_f32 v162, v162
    v_rcp_f32 v163, v163
    v_rcp_f32 v164, v164
    v_rcp_f32 v165, v165
    v_rcp_f32 v166, v166
    v_rcp_f32 v167, v167
    v_mul_f32 v72, v72, v160
    v_mul_f32 v73, v73, v161
    v_mul_f32 v74, v74, v162
    v_mul_f32 v75, v75, v163
    v_mul_f32 v76, v76, v164
    v_mul_f32 v77, v77, v165
    v_mul_f32 v78, v78, v166
    v_mul_f32 v79, v79, v167
    v_cvt_pk_bf16_f32 v80, v72, v73
    v_cvt_pk_bf16_f32 v81, v74, v75
    v_cvt_pk_bf16_f32 v82, v76, v77
    v_cvt_pk_bf16_f32 v83, v78, v79
    buffer_store_dwordx4 v[80:83], v4, s[44:47], s88 offen offset:0 sc1
    v_mfma_f32_32x32x16_bf16 v[104:119], v[196:199], v[184:187], v[104:119]
    v_mul_f32 v152, v24, v238
    v_mul_f32 v153, v25, v238
    v_mul_f32 v154, v26, v238
    v_mul_f32 v155, v27, v238
    v_mul_f32 v156, v28, v238
    v_mul_f32 v157, v29, v238
    v_mul_f32 v158, v30, v238
    v_mul_f32 v159, v31, v238
    v_exp_f32 v152, v152
    v_exp_f32 v153, v153
    v_exp_f32 v154, v154
    v_exp_f32 v155, v155
    v_exp_f32 v156, v156
    v_exp_f32 v157, v157
    v_exp_f32 v158, v158
    v_exp_f32 v159, v159
    v_mul_f32 v24, v24, v32
    v_mul_f32 v25, v25, v33
    v_mul_f32 v26, v26, v34
    v_mul_f32 v27, v27, v35
    v_mul_f32 v28, v28, v36
    v_mul_f32 v29, v29, v37
    v_mul_f32 v30, v30, v38
    v_mul_f32 v31, v31, v39
    v_mfma_f32_32x32x16_bf16 v[104:119], v[216:219], v[212:215], v[104:119]
    v_fma_f32 v152, v152, v237, v237
    v_fma_f32 v153, v153, v237, v237
    v_fma_f32 v154, v154, v237, v237
    v_fma_f32 v155, v155, v237, v237
    v_fma_f32 v156, v156, v237, v237
    v_fma_f32 v157, v157, v237, v237
    v_fma_f32 v158, v158, v237, v237
    v_fma_f32 v159, v159, v237, v237
    v_rcp_f32 v152, v152
    v_rcp_f32 v153, v153
    v_rcp_f32 v154, v154
    v_rcp_f32 v155, v155
    v_rcp_f32 v156, v156
    v_rcp_f32 v157, v157
    v_rcp_f32 v158, v158
    v_rcp_f32 v159, v159
    v_mul_f32 v24, v24, v152
    v_mul_f32 v25, v25, v153
    v_mul_f32 v26, v26, v154
    v_mul_f32 v27, v27, v155
    v_mul_f32 v28, v28, v156
    v_mul_f32 v29, v29, v157
    v_mul_f32 v30, v30, v158
    v_mul_f32 v31, v31, v159
    v_cvt_pk_bf16_f32 v32, v24, v25
    v_cvt_pk_bf16_f32 v33, v26, v27
    v_cvt_pk_bf16_f32 v34, v28, v29
    v_cvt_pk_bf16_f32 v35, v30, v31
    buffer_store_dwordx4 v[32:35], v4, s[40:43], s88 offen offset:1024 sc1
    v_mfma_f32_32x32x16_bf16 v[56:71], v[200:203], v[180:183], v[56:71]
    v_mul_f32 v160, v88, v242
    v_mul_f32 v161, v89, v242
    v_mul_f32 v162, v90, v242
    v_mul_f32 v163, v91, v242
    v_mul_f32 v164, v92, v242
    v_mul_f32 v165, v93, v242
    v_mul_f32 v166, v94, v242
    v_mul_f32 v167, v95, v242
    v_exp_f32 v160, v160
    v_exp_f32 v161, v161
    v_exp_f32 v162, v162
    v_exp_f32 v163, v163
    v_exp_f32 v164, v164
    v_exp_f32 v165, v165
    v_exp_f32 v166, v166
    v_exp_f32 v167, v167
    v_mul_f32 v88, v88, v96
    v_mul_f32 v89, v89, v97
    v_mul_f32 v90, v90, v98
    v_mul_f32 v91, v91, v99
    v_mul_f32 v92, v92, v100
    v_mul_f32 v93, v93, v101
    v_mul_f32 v94, v94, v102
    v_mul_f32 v95, v95, v103
    v_mfma_f32_32x32x16_bf16 v[56:71], v[220:223], v[208:211], v[56:71]
    v_fma_f32 v160, v160, v241, v241
    v_fma_f32 v161, v161, v241, v241
    v_fma_f32 v162, v162, v241, v241
    v_fma_f32 v163, v163, v241, v241
    v_fma_f32 v164, v164, v241, v241
    v_fma_f32 v165, v165, v241, v241
    v_fma_f32 v166, v166, v241, v241
    v_fma_f32 v167, v167, v241, v241
    v_rcp_f32 v160, v160
    v_rcp_f32 v161, v161
    v_rcp_f32 v162, v162
    v_rcp_f32 v163, v163
    v_rcp_f32 v164, v164
    v_rcp_f32 v165, v165
    v_rcp_f32 v166, v166
    v_rcp_f32 v167, v167
    v_mul_f32 v88, v88, v160
    v_mul_f32 v89, v89, v161
    v_mul_f32 v90, v90, v162
    v_mul_f32 v91, v91, v163
    v_mul_f32 v92, v92, v164
    v_mul_f32 v93, v93, v165
    v_mul_f32 v94, v94, v166
    v_mul_f32 v95, v95, v167
    v_cvt_pk_bf16_f32 v96, v88, v89
    v_cvt_pk_bf16_f32 v97, v90, v91
    v_cvt_pk_bf16_f32 v98, v92, v93
    v_cvt_pk_bf16_f32 v99, v94, v95
    buffer_store_dwordx4 v[96:99], v4, s[44:47], s88 offen offset:1024 sc1
    v_mfma_f32_32x32x16_bf16 v[120:135], v[200:203], v[184:187], v[120:135]
    v_mul_f32 v152, v40, v238
    v_mul_f32 v153, v41, v238
    v_mul_f32 v154, v42, v238
    v_mul_f32 v155, v43, v238
    v_mul_f32 v156, v44, v238
    v_mul_f32 v157, v45, v238
    v_mul_f32 v158, v46, v238
    v_mul_f32 v159, v47, v238
    v_exp_f32 v152, v152
    v_exp_f32 v153, v153
    v_exp_f32 v154, v154
    v_exp_f32 v155, v155
    v_exp_f32 v156, v156
    v_exp_f32 v157, v157
    v_exp_f32 v158, v158
    v_exp_f32 v159, v159
    v_mul_f32 v40, v40, v48
    v_mul_f32 v41, v41, v49
    v_mul_f32 v42, v42, v50
    v_mul_f32 v43, v43, v51
    v_mul_f32 v44, v44, v52
    v_mul_f32 v45, v45, v53
    v_mul_f32 v46, v46, v54
    v_mul_f32 v47, v47, v55
    v_mfma_f32_32x32x16_bf16 v[120:135], v[220:223], v[212:215], v[120:135]
    v_fma_f32 v152, v152, v237, v237
    v_fma_f32 v153, v153, v237, v237
    v_fma_f32 v154, v154, v237, v237
    v_fma_f32 v155, v155, v237, v237
    v_fma_f32 v156, v156, v237, v237
    v_fma_f32 v157, v157, v237, v237
    v_fma_f32 v158, v158, v237, v237
    v_fma_f32 v159, v159, v237, v237
    v_rcp_f32 v152, v152
    v_rcp_f32 v153, v153
    v_rcp_f32 v154, v154
    v_rcp_f32 v155, v155
    v_rcp_f32 v156, v156
    v_rcp_f32 v157, v157
    v_rcp_f32 v158, v158
    v_rcp_f32 v159, v159
    v_mul_f32 v40, v40, v152
    v_mul_f32 v41, v41, v153
    v_mul_f32 v42, v42, v154
    v_mul_f32 v43, v43, v155
    v_mul_f32 v44, v44, v156
    v_mul_f32 v45, v45, v157
    v_mul_f32 v46, v46, v158
    v_mul_f32 v47, v47, v159
    v_cvt_pk_bf16_f32 v48, v40, v41
    v_cvt_pk_bf16_f32 v49, v42, v43
    v_cvt_pk_bf16_f32 v50, v44, v45
    v_cvt_pk_bf16_f32 v51, v46, v47
    buffer_store_dwordx4 v[48:51], v4, s[40:43], s88 offen offset:2048 sc1
    v_mfma_f32_32x32x16_bf16 v[136:151], v[204:207], v[180:183], v[136:151]
    v_mul_f32 v160, v104, v242
    v_mul_f32 v161, v105, v242
    v_mul_f32 v162, v106, v242
    v_mul_f32 v163, v107, v242
    v_mul_f32 v164, v108, v242
    v_mul_f32 v165, v109, v242
    v_mul_f32 v166, v110, v242
    v_mul_f32 v167, v111, v242
    v_exp_f32 v160, v160
    v_exp_f32 v161, v161
    v_exp_f32 v162, v162
    v_exp_f32 v163, v163
    v_exp_f32 v164, v164
    v_exp_f32 v165, v165
    v_exp_f32 v166, v166
    v_exp_f32 v167, v167
    v_mul_f32 v104, v104, v112
    v_mul_f32 v105, v105, v113
    v_mul_f32 v106, v106, v114
    v_mul_f32 v107, v107, v115
    v_mul_f32 v108, v108, v116
    v_mul_f32 v109, v109, v117
    v_mul_f32 v110, v110, v118
    v_mul_f32 v111, v111, v119
    v_mfma_f32_32x32x16_bf16 v[136:151], v[232:235], v[208:211], v[136:151]
    v_fma_f32 v160, v160, v241, v241
    v_fma_f32 v161, v161, v241, v241
    v_fma_f32 v162, v162, v241, v241
    v_fma_f32 v163, v163, v241, v241
    v_fma_f32 v164, v164, v241, v241
    v_fma_f32 v165, v165, v241, v241
    v_fma_f32 v166, v166, v241, v241
    v_fma_f32 v167, v167, v241, v241
    v_rcp_f32 v160, v160
    v_rcp_f32 v161, v161
    v_rcp_f32 v162, v162
    v_rcp_f32 v163, v163
    v_rcp_f32 v164, v164
    v_rcp_f32 v165, v165
    v_rcp_f32 v166, v166
    v_rcp_f32 v167, v167
    v_mul_f32 v104, v104, v160
    v_mul_f32 v105, v105, v161
    v_mul_f32 v106, v106, v162
    v_mul_f32 v107, v107, v163
    v_mul_f32 v108, v108, v164
    v_mul_f32 v109, v109, v165
    v_mul_f32 v110, v110, v166
    v_mul_f32 v111, v111, v167
    v_cvt_pk_bf16_f32 v112, v104, v105
    v_cvt_pk_bf16_f32 v113, v106, v107
    v_cvt_pk_bf16_f32 v114, v108, v109
    v_cvt_pk_bf16_f32 v115, v110, v111
    buffer_store_dwordx4 v[112:115], v4, s[44:47], s88 offen offset:2048 sc1
    v_mul_f32 v152, v56, v238
    v_mul_f32 v153, v57, v238
    v_mul_f32 v154, v58, v238
    v_mul_f32 v155, v59, v238
    v_mul_f32 v156, v60, v238
    v_mul_f32 v157, v61, v238
    v_mul_f32 v158, v62, v238
    v_mul_f32 v159, v63, v238
    v_exp_f32 v152, v152
    v_exp_f32 v153, v153
    v_exp_f32 v154, v154
    v_exp_f32 v155, v155
    v_exp_f32 v156, v156
    v_exp_f32 v157, v157
    v_exp_f32 v158, v158
    v_exp_f32 v159, v159
    v_mul_f32 v56, v56, v64
    v_mul_f32 v57, v57, v65
    v_mul_f32 v58, v58, v66
    v_mul_f32 v59, v59, v67
    v_mul_f32 v60, v60, v68
    v_mul_f32 v61, v61, v69
    v_mul_f32 v62, v62, v70
    v_mul_f32 v63, v63, v71
    v_fma_f32 v152, v152, v237, v237
    v_fma_f32 v153, v153, v237, v237
    v_fma_f32 v154, v154, v237, v237
    v_fma_f32 v155, v155, v237, v237
    v_fma_f32 v156, v156, v237, v237
    v_fma_f32 v157, v157, v237, v237
    v_fma_f32 v158, v158, v237, v237
    v_fma_f32 v159, v159, v237, v237
    v_rcp_f32 v152, v152
    v_rcp_f32 v153, v153
    v_rcp_f32 v154, v154
    v_rcp_f32 v155, v155
    v_rcp_f32 v156, v156
    v_rcp_f32 v157, v157
    v_rcp_f32 v158, v158
    v_rcp_f32 v159, v159
    v_mul_f32 v56, v56, v152
    v_mul_f32 v57, v57, v153
    v_mul_f32 v58, v58, v154
    v_mul_f32 v59, v59, v155
    v_mul_f32 v60, v60, v156
    v_mul_f32 v61, v61, v157
    v_mul_f32 v62, v62, v158
    v_mul_f32 v63, v63, v159
    v_cvt_pk_bf16_f32 v64, v56, v57
    v_cvt_pk_bf16_f32 v65, v58, v59
    v_cvt_pk_bf16_f32 v66, v60, v61
    v_cvt_pk_bf16_f32 v67, v62, v63
    buffer_store_dwordx4 v[64:67], v4, s[40:43], s88 offen offset:3072 sc1
    v_mul_f32 v160, v120, v242
    v_mul_f32 v161, v121, v242
    v_mul_f32 v162, v122, v242
    v_mul_f32 v163, v123, v242
    v_mul_f32 v164, v124, v242
    v_mul_f32 v165, v125, v242
    v_mul_f32 v166, v126, v242
    v_mul_f32 v167, v127, v242
    v_exp_f32 v160, v160
    v_exp_f32 v161, v161
    v_exp_f32 v162, v162
    v_exp_f32 v163, v163
    v_exp_f32 v164, v164
    v_exp_f32 v165, v165
    v_exp_f32 v166, v166
    v_exp_f32 v167, v167
    v_mul_f32 v120, v120, v128
    v_mul_f32 v121, v121, v129
    v_mul_f32 v122, v122, v130
    v_mul_f32 v123, v123, v131
    v_mul_f32 v124, v124, v132
    v_mul_f32 v125, v125, v133
    v_mul_f32 v126, v126, v134
    v_mul_f32 v127, v127, v135
    v_fma_f32 v160, v160, v241, v241
    v_fma_f32 v161, v161, v241, v241
    v_fma_f32 v162, v162, v241, v241
    v_fma_f32 v163, v163, v241, v241
    v_fma_f32 v164, v164, v241, v241
    v_fma_f32 v165, v165, v241, v241
    v_fma_f32 v166, v166, v241, v241
    v_fma_f32 v167, v167, v241, v241
    v_rcp_f32 v160, v160
    v_rcp_f32 v161, v161
    v_rcp_f32 v162, v162
    v_rcp_f32 v163, v163
    v_rcp_f32 v164, v164
    v_rcp_f32 v165, v165
    v_rcp_f32 v166, v166
    v_rcp_f32 v167, v167
    v_mul_f32 v120, v120, v160
    v_mul_f32 v121, v121, v161
    v_mul_f32 v122, v122, v162
    v_mul_f32 v123, v123, v163
    v_mul_f32 v124, v124, v164
    v_mul_f32 v125, v125, v165
    v_mul_f32 v126, v126, v166
    v_mul_f32 v127, v127, v167
    v_cvt_pk_bf16_f32 v128, v120, v121
    v_cvt_pk_bf16_f32 v129, v122, v123
    v_cvt_pk_bf16_f32 v130, v124, v125
    v_cvt_pk_bf16_f32 v131, v126, v127
    buffer_store_dwordx4 v[128:131], v4, s[44:47], s88 offen offset:3072 sc1
    v_mul_f32 v152, v136, v238
    v_mul_f32 v153, v137, v238
    v_mul_f32 v154, v138, v238
    v_mul_f32 v155, v139, v238
    v_mul_f32 v156, v140, v238
    v_mul_f32 v157, v141, v238
    v_mul_f32 v158, v142, v238
    v_mul_f32 v159, v143, v238
    v_exp_f32 v152, v152
    v_exp_f32 v153, v153
    v_exp_f32 v154, v154
    v_exp_f32 v155, v155
    v_exp_f32 v156, v156
    v_exp_f32 v157, v157
    v_exp_f32 v158, v158
    v_exp_f32 v159, v159
    v_mul_f32 v136, v136, v144
    v_mul_f32 v137, v137, v145
    v_mul_f32 v138, v138, v146
    v_mul_f32 v139, v139, v147
    v_mul_f32 v140, v140, v148
    v_mul_f32 v141, v141, v149
    v_mul_f32 v142, v142, v150
    v_mul_f32 v143, v143, v151
    v_fma_f32 v152, v152, v237, v237
    v_fma_f32 v153, v153, v237, v237
    v_fma_f32 v154, v154, v237, v237
    v_fma_f32 v155, v155, v237, v237
    v_fma_f32 v156, v156, v237, v237
    v_fma_f32 v157, v157, v237, v237
    v_fma_f32 v158, v158, v237, v237
    v_fma_f32 v159, v159, v237, v237
    v_rcp_f32 v152, v152
    v_rcp_f32 v153, v153
    v_rcp_f32 v154, v154
    v_rcp_f32 v155, v155
    v_rcp_f32 v156, v156
    v_rcp_f32 v157, v157
    v_rcp_f32 v158, v158
    v_rcp_f32 v159, v159
    v_mul_f32 v136, v136, v152
    v_mul_f32 v137, v137, v153
    v_mul_f32 v138, v138, v154
    v_mul_f32 v139, v139, v155
    v_mul_f32 v140, v140, v156
    v_mul_f32 v141, v141, v157
    v_mul_f32 v142, v142, v158
    v_mul_f32 v143, v143, v159
    v_cvt_pk_bf16_f32 v144, v136, v137
    v_cvt_pk_bf16_f32 v145, v138, v139
    v_cvt_pk_bf16_f32 v146, v140, v141
    v_cvt_pk_bf16_f32 v147, v142, v143
    buffer_store_dwordx4 v[144:147], v4, s[40:43], s89 offen offset:0 sc1
    v_mov_b32 v6, 1
    s_waitcnt vmcnt(0)
    s_mov_b64 exec, 1
    buffer_store_dword v6, off, s[56:59], s3 sc1
    s_mov_b64 exec, -1
    s_branch p2_gemm
k1_ffn_c_cw:
    s_mov_b32 s98, 0
k1_ffn_c_cl:
    s_sleep 4
    buffer_load_dword v5, v4, s[64:67], 0 offen sc1
    s_waitcnt vmcnt(0)
    v_cmp_gt_u32 vcc, 16, v5
    s_add_u32 s98, s98, 1
    s_cmp_gt_u32 s98, 0x8000
    s_cbranch_scc1 k1_ffn_c_cok
    s_and_b32 s78, vcc_lo, 0xffff
    s_cbranch_scc1 k1_ffn_c_cl
    s_branch k1_ffn_c_cok
p2_gemm:
    v_lshrrev_b32 v12, 3, v0
    v_and_b32 v13, 7, v0
    v_and_b32 v14, 2, v12
    v_lshlrev_b32 v14, 1, v14
    v_xor_b32 v14, v14, v13
    v_lshlrev_b32 v14, 4, v14
    v_lshl_add_u32 v2, v12, 10, v14
    s_lshl_b32 s78, s68, 14
    s_lshl_b32 s79, s94, 7
    s_add_u32 s78, s78, s79
    v_add_u32 v2, s78, v2
    v_add_u32 v3, 8192, v2
    v_min_u32 v213, 19, v0
    v_lshrrev_b32 v12, 1, v213
    v_mul_u32_u24 v12, 9, v12
    v_add_u32 v13, 8, v12
    v_lshrrev_b32 v12, 2, v12
    v_lshrrev_b32 v13, 2, v13
    s_lshr_b32 s78, s95, 12
    v_subrev_u32 v212, s78, v12
    v_add_u32 v14, 22, v212
    v_cmp_gt_u32 vcc, s78, v13
    s_nop 1
    v_cndmask_b32 v14, 0, v14, vcc
    v_cmp_gt_u32 vcc, s78, v12
    s_nop 1
    v_cndmask_b32 v212, v212, v14, vcc
    v_lshlrev_b32 v213, 2, v213
    s_lshl_b32 s75, s93, 8
    v_mov_b32 v214, 163776
    s_mov_b32 s74, 0
    s_lshl_b32 s78, s68, 10
    v_add_u32 v5, s78, v4
    v_lshrrev_b32 v12, 5, v0
    v_bfe_u32 v13, v0, 2, 2
    v_lshl_add_u32 v12, v12, 2, v13
    v_lshlrev_b32 v12, 7, v12
    v_and_b32 v14, 3, v0
    v_lshl_add_u32 v12, v14, 3, v12
    v_bfe_u32 v14, v0, 4, 1
    v_and_b32 v13, 2, v13
    v_or_b32 v14, v14, v13
    v_lshl_add_u32 v13, v14, 5, v12
    v_xor_b32 v14, 2, v14
    v_lshl_add_u32 v14, v14, 5, v12
    v_add_u32 v6, s97, v13
    v_add_u32 v7, s97, v14
    v_add_u32 v8, s60, v13
    v_add_u32 v9, s60, v14
    v_add_u32 v10, s61, v13
    v_add_u32 v11, s61, v14
    s_mov_b32 s76, 0
    s_lshl_b32 s79, s68, 2
    s_add_u32 s79, s79, 163776
    v_mov_b32 v215, s79
    s_mov_b32 s73, s95
    s_cmp_lt_u32 s74, 3
    s_cbranch_scc1 p2_gemm_poll0
p2_gemm_go0:
    buffer_load_dwordx4 v[84:87], v5, s[24:27], s95 offen sc1
    buffer_load_dwordx4 v[88:91], v5, s[28:31], s95 offen sc1
    s_add_u32 s95, s95, 4096
    s_cmp_eq_u32 s95, 90112
    s_cselect_b32 s95, 0, s95
    buffer_load_dwordx4 v[92:95], v5, s[24:27], s95 offen sc1
    buffer_load_dwordx4 v[96:99], v5, s[28:31], s95 offen sc1
    s_add_u32 s95, s95, 4096
    s_cmp_eq_u32 s95, 90112
    s_cselect_b32 s95, 0, s95
    buffer_load_dwordx4 v[100:103], v5, s[24:27], s95 offen sc1
    buffer_load_dwordx4 v[104:107], v5, s[28:31], s95 offen sc1
    s_add_u32 s95, s95, 4096
    s_cmp_eq_u32 s95, 90112
    s_cselect_b32 s95, 0, s95
    s_cmp_lt_u32 s74, 6
    s_cbranch_scc1 p2_gemm_poll1
p2_gemm_go1:
    buffer_load_dwordx4 v[108:111], v5, s[24:27], s95 offen sc1
    buffer_load_dwordx4 v[112:115], v5, s[28:31], s95 offen sc1
    s_add_u32 s95, s95, 4096
    s_cmp_eq_u32 s95, 90112
    s_cselect_b32 s95, 0, s95
    buffer_load_dwordx4 v[116:119], v5, s[24:27], s95 offen sc1
    buffer_load_dwordx4 v[120:123], v5, s[28:31], s95 offen sc1
    s_add_u32 s95, s95, 4096
    s_cmp_eq_u32 s95, 90112
    s_cselect_b32 s95, 0, s95
    buffer_load_dwordx4 v[124:127], v5, s[24:27], s95 offen sc1
    buffer_load_dwordx4 v[128:131], v5, s[28:31], s95 offen sc1
    s_add_u32 s95, s95, 4096
    s_cmp_eq_u32 s95, 90112
    s_cselect_b32 s95, 0, s95
    s_cmp_lt_u32 s74, 9
    s_cbranch_scc1 p2_gemm_poll2
p2_gemm_go2:
    buffer_load_dwordx4 v[132:135], v5, s[24:27], s95 offen sc1
    buffer_load_dwordx4 v[136:139], v5, s[28:31], s95 offen sc1
    s_add_u32 s95, s95, 4096
    s_cmp_eq_u32 s95, 90112
    s_cselect_b32 s95, 0, s95
    buffer_load_dwordx4 v[140:143], v5, s[24:27], s95 offen sc1
    buffer_load_dwordx4 v[144:147], v5, s[28:31], s95 offen sc1
    s_add_u32 s95, s95, 4096
    s_cmp_eq_u32 s95, 90112
    s_cselect_b32 s95, 0, s95
    buffer_load_dwordx4 v[148:151], v5, s[24:27], s95 offen sc1
    buffer_load_dwordx4 v[152:155], v5, s[28:31], s95 offen sc1
    s_add_u32 s95, s95, 4096
    s_cmp_eq_u32 s95, 90112
    s_cselect_b32 s95, 0, s95
    s_cmp_lt_u32 s74, 12
    s_cbranch_scc1 p2_gemm_poll3
p2_gemm_go3:
    buffer_load_dwordx4 v[156:159], v5, s[24:27], s95 offen sc1
    buffer_load_dwordx4 v[160:163], v5, s[28:31], s95 offen sc1
    s_add_u32 s95, s95, 4096
    s_cmp_eq_u32 s95, 90112
    s_cselect_b32 s95, 0, s95
    buffer_load_dwordx4 v[164:167], v5, s[24:27], s95 offen sc1
    buffer_load_dwordx4 v[168:171], v5, s[28:31], s95 offen sc1
    s_add_u32 s95, s95, 4096
    s_cmp_eq_u32 s95, 90112
    s_cselect_b32 s95, 0, s95
    buffer_load_dwordx4 v[172:175], v5, s[24:27], s95 offen sc1
    buffer_load_dwordx4 v[176:179], v5, s[28:31], s95 offen sc1
    s_add_u32 s95, s95, 4096
    s_cmp_eq_u32 s95, 90112
    s_cselect_b32 s95, 0, s95
    s_mov_b32 s98, 0
p2_gemm_g0_w:
    ds_read_b32 v16, v214 offset:16
    s_waitcnt lgkmcnt(0)
    v_readfirstlane_b32 s79, v16
    s_add_u32 s98, s98, 1
    s_cmp_gt_u32 s98, 0x100000
    s_cbranch_scc1 p2_gemm_g0_k
    s_cmp_lt_u32 s79, 4
    s_cbranch_scc1 p2_gemm_g0_w
p2_gemm_g0_k:
    ds_read_b64_tr_b16 v[180:181], v6 offset:0
    ds_read_b64_tr_b16 v[182:183], v6 offset:1024
    ds_read_b64_tr_b16 v[184:185], v7 offset:0
    ds_read_b64_tr_b16 v[186:187], v7 offset:1024
    ds_read_b64_tr_b16 v[188:189], v6 offset:2048
    ds_read_b64_tr_b16 v[190:191], v6 offset:3072
    ds_read_b64_tr_b16 v[192:193], v7 offset:2048
    ds_read_b64_tr_b16 v[194:195], v7 offset:3072
    s_waitcnt vmcnt(22)
    ds_read_b64_tr_b16 v[196:197], v6 offset:4096
    ds_read_b64_tr_b16 v[198:199], v6 offset:5120
    ds_read_b64_tr_b16 v[200:201], v7 offset:4096
    ds_read_b64_tr_b16 v[202:203], v7 offset:5120
    s_waitcnt lgkmcnt(8)
    v_mfma_f32_32x32x16_bf16 v[20:35], v[180:183], v[84:87], 0
    v_mfma_f32_32x32x16_bf16 v[36:51], v[184:187], v[84:87], 0
    v_mfma_f32_32x32x16_bf16 v[52:67], v[180:183], v[88:91], 0
    v_mfma_f32_32x32x16_bf16 v[68:83], v[184:187], v[88:91], 0
    s_cmp_lt_u32 s74, 15
    s_cbranch_scc1 p2_gemm_poll4
p2_gemm_go4:
    buffer_load_dwordx4 v[84:87], v5, s[24:27], s95 offen sc1
    buffer_load_dwordx4 v[88:91], v5, s[28:31], s95 offen sc1
    s_add_u32 s95, s95, 4096
    s_cmp_eq_u32 s95, 90112
    s_cselect_b32 s95, 0, s95
    s_add_u32 m0, s97, 0
    s_nop 0
    buffer_load_dwordx4 v2, s[32:35], s96 offen lds
    s_add_u32 m0, s97, 1024
    s_nop 0
    buffer_load_dwordx4 v3, s[32:35], s96 offen lds
    s_add_u32 s96, s96, 65536
    s_cmp_eq_u32 s96, 1441792
    s_cselect_b32 s96, 0, s96
    s_waitcnt vmcnt(24)
    ds_read_b64_tr_b16 v[180:181], v6 offset:6144
    ds_read_b64_tr_b16 v[182:183], v6 offset:7168
    ds_read_b64_tr_b16 v[184:185], v7 offset:6144
    ds_read_b64_tr_b16 v[186:187], v7 offset:7168
    s_waitcnt lgkmcnt(8)
    v_mfma_f32_32x32x16_bf16 v[20:35], v[188:191], v[92:95], v[20:35]
    v_mfma_f32_32x32x16_bf16 v[36:51], v[192:195], v[92:95], v[36:51]
    v_mfma_f32_32x32x16_bf16 v[52:67], v[188:191], v[96:99], v[52:67]
    v_mfma_f32_32x32x16_bf16 v[68:83], v[192:195], v[96:99], v[68:83]
    buffer_load_dwordx4 v[92:95], v5, s[24:27], s95 offen sc1
    buffer_load_dwordx4 v[96:99], v5, s[28:31], s95 offen sc1
    s_add_u32 s95, s95, 4096
    s_cmp_eq_u32 s95, 90112
    s_cselect_b32 s95, 0, s95
    s_add_u32 m0, s97, 2048
    s_nop 0
    buffer_load_dwordx4 v2, s[32:35], s96 offen lds
    s_add_u32 m0, s97, 3072
    s_nop 0
    buffer_load_dwordx4 v3, s[32:35], s96 offen lds
    s_add_u32 s96, s96, 65536
    s_cmp_eq_u32 s96, 1441792
    s_cselect_b32 s96, 0, s96
    s_waitcnt vmcnt(26)
    ds_read_b64_tr_b16 v[188:189], v8 offset:0
    ds_read_b64_tr_b16 v[190:191], v8 offset:1024
    ds_read_b64_tr_b16 v[192:193], v9 offset:0
    ds_read_b64_tr_b16 v[194:195], v9 offset:1024
    s_waitcnt lgkmcnt(8)
    v_mfma_f32_32x32x16_bf16 v[20:35], v[196:199], v[100:103], v[20:35]
    v_mfma_f32_32x32x16_bf16 v[36:51], v[200:203], v[100:103], v[36:51]
    v_mfma_f32_32x32x16_bf16 v[52:67], v[196:199], v[104:107], v[52:67]
    v_mfma_f32_32x32x16_bf16 v[68:83], v[200:203], v[104:107], v[68:83]
    buffer_load_dwordx4 v[100:103], v5, s[24:27], s95 offen sc1
    buffer_load_dwordx4 v[104:107], v5, s[28:31], s95 offen sc1
    s_add_u32 s95, s95, 4096
    s_cmp_eq_u32 s95, 90112
    s_cselect_b32 s95, 0, s95
    s_add_u32 m0, s97, 4096
    s_nop 0
    buffer_load_dwordx4 v2, s[32:35], s96 offen lds
    s_add_u32 m0, s97, 5120
    s_nop 0
    buffer_load_dwordx4 v3, s[32:35], s96 offen lds
    s_add_u32 s96, s96, 65536
    s_cmp_eq_u32 s96, 1441792
    s_cselect_b32 s96, 0, s96
    s_waitcnt vmcnt(28)
    ds_read_b64_tr_b16 v[196:197], v8 offset:2048
    ds_read_b64_tr_b16 v[198:199], v8 offset:3072
    ds_read_b64_tr_b16 v[200:201], v9 offset:2048
    ds_read_b64_tr_b16 v[202:203], v9 offset:3072
    s_waitcnt lgkmcnt(8)
    v_mfma_f32_32x32x16_bf16 v[20:35], v[180:183], v[108:111], v[20:35]
    v_mfma_f32_32x32x16_bf16 v[36:51], v[184:187], v[108:111], v[36:51]
    v_mfma_f32_32x32x16_bf16 v[52:67], v[180:183], v[112:115], v[52:67]
    v_mfma_f32_32x32x16_bf16 v[68:83], v[184:187], v[112:115], v[68:83]
    s_cmp_lt_u32 s74, 18
    s_cbranch_scc1 p2_gemm_poll5
p2_gemm_go5:
    buffer_load_dwordx4 v[108:111], v5, s[24:27], s95 offen sc1
    buffer_load_dwordx4 v[112:115], v5, s[28:31], s95 offen sc1
    s_add_u32 s95, s95, 4096
    s_cmp_eq_u32 s95, 90112
    s_cselect_b32 s95, 0, s95
    s_add_u32 m0, s97, 6144
    s_nop 0
    buffer_load_dwordx4 v2, s[32:35], s96 offen lds
    s_add_u32 m0, s97, 7168
    s_nop 0
    buffer_load_dwordx4 v3, s[32:35], s96 offen lds
    s_add_u32 s96, s96, 65536
    s_cmp_eq_u32 s96, 1441792
    s_cselect_b32 s96, 0, s96
    s_waitcnt vmcnt(30)
    ds_read_b64_tr_b16 v[180:181], v8 offset:4096
    ds_read_b64_tr_b16 v[182:183], v8 offset:5120
    ds_read_b64_tr_b16 v[184:185], v9 offset:4096
    ds_read_b64_tr_b16 v[186:187], v9 offset:5120
    s_waitcnt lgkmcnt(8)
    v_mfma_f32_32x32x16_bf16 v[20:35], v[188:191], v[116:119], v[20:35]
    v_mfma_f32_32x32x16_bf16 v[36:51], v[192:195], v[116:119], v[36:51]
    v_mfma_f32_32x32x16_bf16 v[52:67], v[188:191], v[120:123], v[52:67]
    v_mfma_f32_32x32x16_bf16 v[68:83], v[192:195], v[120:123], v[68:83]
    buffer_load_dwordx4 v[116:119], v5, s[24:27], s95 offen sc1
    buffer_load_dwordx4 v[120:123], v5, s[28:31], s95 offen sc1
    s_add_u32 s95, s95, 4096
    s_cmp_eq_u32 s95, 90112
    s_cselect_b32 s95, 0, s95
    s_add_u32 m0, s60, 0
    s_nop 0
    buffer_load_dwordx4 v2, s[32:35], s96 offen lds
    s_add_u32 m0, s60, 1024
    s_nop 0
    buffer_load_dwordx4 v3, s[32:35], s96 offen lds
    s_add_u32 s96, s96, 65536
    s_cmp_eq_u32 s96, 1441792
    s_cselect_b32 s96, 0, s96
    s_waitcnt vmcnt(32)
    ds_read_b64_tr_b16 v[188:189], v8 offset:6144
    ds_read_b64_tr_b16 v[190:191], v8 offset:7168
    ds_read_b64_tr_b16 v[192:193], v9 offset:6144
    ds_read_b64_tr_b16 v[194:195], v9 offset:7168
    s_waitcnt lgkmcnt(8)
    v_mfma_f32_32x32x16_bf16 v[20:35], v[196:199], v[124:127], v[20:35]
    v_mfma_f32_32x32x16_bf16 v[36:51], v[200:203], v[124:127], v[36:51]
    v_mfma_f32_32x32x16_bf16 v[52:67], v[196:199], v[128:131], v[52:67]
    v_mfma_f32_32x32x16_bf16 v[68:83], v[200:203], v[128:131], v[68:83]
    buffer_load_dwordx4 v[124:127], v5, s[24:27], s95 offen sc1
    buffer_load_dwordx4 v[128:131], v5, s[28:31], s95 offen sc1
    s_add_u32 s95, s95, 4096
    s_cmp_eq_u32 s95, 90112
    s_cselect_b32 s95, 0, s95
    s_add_u32 m0, s60, 2048
    s_nop 0
    buffer_load_dwordx4 v2, s[32:35], s96 offen lds
    s_add_u32 m0, s60, 3072
    s_nop 0
    buffer_load_dwordx4 v3, s[32:35], s96 offen lds
    s_add_u32 s96, s96, 65536
    s_cmp_eq_u32 s96, 1441792
    s_cselect_b32 s96, 0, s96
    s_waitcnt vmcnt(34)
    ds_read_b64_tr_b16 v[196:197], v8 offset:8192
    ds_read_b64_tr_b16 v[198:199], v8 offset:9216
    ds_read_b64_tr_b16 v[200:201], v9 offset:8192
    ds_read_b64_tr_b16 v[202:203], v9 offset:9216
    s_waitcnt lgkmcnt(8)
    v_mfma_f32_32x32x16_bf16 v[20:35], v[180:183], v[132:135], v[20:35]
    v_mfma_f32_32x32x16_bf16 v[36:51], v[184:187], v[132:135], v[36:51]
    v_mfma_f32_32x32x16_bf16 v[52:67], v[180:183], v[136:139], v[52:67]
    v_mfma_f32_32x32x16_bf16 v[68:83], v[184:187], v[136:139], v[68:83]
    s_cmp_lt_u32 s74, 21
    s_cbranch_scc1 p2_gemm_poll6
p2_gemm_go6:
    buffer_load_dwordx4 v[132:135], v5, s[24:27], s95 offen sc1
    buffer_load_dwordx4 v[136:139], v5, s[28:31], s95 offen sc1
    s_add_u32 s95, s95, 4096
    s_cmp_eq_u32 s95, 90112
    s_cselect_b32 s95, 0, s95
    s_add_u32 m0, s60, 4096
    s_nop 0
    buffer_load_dwordx4 v2, s[32:35], s96 offen lds
    s_add_u32 m0, s60, 5120
    s_nop 0
    buffer_load_dwordx4 v3, s[32:35], s96 offen lds
    s_waitcnt vmcnt(36)
    ds_read_b64_tr_b16 v[180:181], v8 offset:10240
    ds_read_b64_tr_b16 v[182:183], v8 offset:11264
    ds_read_b64_tr_b16 v[184:185], v9 offset:10240
    ds_read_b64_tr_b16 v[186:187], v9 offset:11264
    s_waitcnt lgkmcnt(8)
    v_mfma_f32_32x32x16_bf16 v[20:35], v[188:191], v[140:143], v[20:35]
    v_mfma_f32_32x32x16_bf16 v[36:51], v[192:195], v[140:143], v[36:51]
    v_mfma_f32_32x32x16_bf16 v[52:67], v[188:191], v[144:147], v[52:67]
    v_mfma_f32_32x32x16_bf16 v[68:83], v[192:195], v[144:147], v[68:83]
    buffer_load_dwordx4 v[140:143], v5, s[24:27], s95 offen sc1
    buffer_load_dwordx4 v[144:147], v5, s[28:31], s95 offen sc1
    s_add_u32 s95, s95, 4096
    s_cmp_eq_u32 s95, 90112
    s_cselect_b32 s95, 0, s95
    s_mov_b32 s96, 0
    s_add_u32 m0, s60, 6144
    s_nop 0
    buffer_load_dwordx4 v2, s[36:39], s96 offen lds
    s_add_u32 m0, s60, 7168
    s_nop 0
    buffer_load_dwordx4 v3, s[36:39], s96 offen lds
    s_waitcnt vmcnt(38)
    s_mov_b32 s98, 0
p2_gemm_g10_w:
    ds_read_b32 v16, v214 offset:12
    s_waitcnt lgkmcnt(0)
    v_readfirstlane_b32 s79, v16
    s_add_u32 s98, s98, 1
    s_cmp_gt_u32 s98, 0x100000
    s_cbranch_scc1 p2_gemm_g10_k
    s_cmp_lt_u32 s79, 4
    s_cbranch_scc1 p2_gemm_g10_w
p2_gemm_g10_k:
    ds_read_b64_tr_b16 v[188:189], v10 offset:0
    ds_read_b64_tr_b16 v[190:191], v10 offset:1024
    ds_read_b64_tr_b16 v[192:193], v11 offset:0
    ds_read_b64_tr_b16 v[194:195], v11 offset:1024
    s_waitcnt lgkmcnt(8)
    v_mfma_f32_32x32x16_bf16 v[20:35], v[196:199], v[148:151], v[20:35]
    v_mfma_f32_32x32x16_bf16 v[36:51], v[200:203], v[148:151], v[36:51]
    v_mfma_f32_32x32x16_bf16 v[52:67], v[196:199], v[152:155], v[52:67]
    v_mfma_f32_32x32x16_bf16 v[68:83], v[200:203], v[152:155], v[68:83]
    buffer_load_dwordx4 v[148:151], v5, s[24:27], s95 offen sc1
    buffer_load_dwordx4 v[152:155], v5, s[28:31], s95 offen sc1
    s_add_u32 s95, s95, 4096
    s_cmp_eq_u32 s95, 90112
    s_cselect_b32 s95, 0, s95
    s_mov_b32 s96, 65536
    s_add_u32 m0, s60, 8192
    s_nop 0
    buffer_load_dwordx4 v2, s[36:39], s96 offen lds
    s_add_u32 m0, s60, 9216
    s_nop 0
    buffer_load_dwordx4 v3, s[36:39], s96 offen lds
    s_waitcnt vmcnt(40)
    ds_read_b64_tr_b16 v[196:197], v10 offset:2048
    ds_read_b64_tr_b16 v[198:199], v10 offset:3072
    ds_read_b64_tr_b16 v[200:201], v11 offset:2048
    ds_read_b64_tr_b16 v[202:203], v11 offset:3072
    s_waitcnt lgkmcnt(8)
    v_mfma_f32_32x32x16_bf16 v[20:35], v[180:183], v[156:159], v[20:35]
    v_mfma_f32_32x32x16_bf16 v[36:51], v[184:187], v[156:159], v[36:51]
    v_mfma_f32_32x32x16_bf16 v[52:67], v[180:183], v[160:163], v[52:67]
    v_mfma_f32_32x32x16_bf16 v[68:83], v[184:187], v[160:163], v[68:83]
    s_cmp_lt_u32 s74, 22
    s_cbranch_scc1 p2_gemm_poll7
p2_gemm_go7:
    buffer_load_dwordx4 v[156:159], v5, s[24:27], s95 offen sc1
    buffer_load_dwordx4 v[160:163], v5, s[28:31], s95 offen sc1
    s_add_u32 s95, s95, 4096
    s_cmp_eq_u32 s95, 90112
    s_cselect_b32 s95, 0, s95
    s_mov_b32 s96, 131072
    s_add_u32 m0, s60, 10240
    s_nop 0
    buffer_load_dwordx4 v2, s[36:39], s96 offen lds
    s_add_u32 m0, s60, 11264
    s_nop 0
    buffer_load_dwordx4 v3, s[36:39], s96 offen lds
    s_waitcnt vmcnt(42)
    ds_read_b64_tr_b16 v[180:181], v10 offset:4096
    ds_read_b64_tr_b16 v[182:183], v10 offset:5120
    ds_read_b64_tr_b16 v[184:185], v11 offset:4096
    ds_read_b64_tr_b16 v[186:187], v11 offset:5120
    s_waitcnt lgkmcnt(8)
    v_mfma_f32_32x32x16_bf16 v[20:35], v[188:191], v[164:167], v[20:35]
    v_mfma_f32_32x32x16_bf16 v[36:51], v[192:195], v[164:167], v[36:51]
    v_mfma_f32_32x32x16_bf16 v[52:67], v[188:191], v[168:171], v[52:67]
    v_mfma_f32_32x32x16_bf16 v[68:83], v[192:195], v[168:171], v[68:83]
    s_mov_b32 s96, 196608
    s_add_u32 m0, s61, 0
    s_nop 0
    buffer_load_dwordx4 v2, s[36:39], s96 offen lds
    s_add_u32 m0, s61, 1024
    s_nop 0
    buffer_load_dwordx4 v3, s[36:39], s96 offen lds
    s_waitcnt vmcnt(42)
    ds_read_b64_tr_b16 v[188:189], v10 offset:6144
    ds_read_b64_tr_b16 v[190:191], v10 offset:7168
    ds_read_b64_tr_b16 v[192:193], v11 offset:6144
    ds_read_b64_tr_b16 v[194:195], v11 offset:7168
    s_waitcnt lgkmcnt(8)
    v_mfma_f32_32x32x16_bf16 v[20:35], v[196:199], v[172:175], v[20:35]
    v_mfma_f32_32x32x16_bf16 v[36:51], v[200:203], v[172:175], v[36:51]
    v_mfma_f32_32x32x16_bf16 v[52:67], v[196:199], v[176:179], v[52:67]
    v_mfma_f32_32x32x16_bf16 v[68:83], v[200:203], v[176:179], v[68:83]
    s_mov_b32 s96, 262144
    s_add_u32 m0, s61, 2048
    s_nop 0
    buffer_load_dwordx4 v2, s[36:39], s96 offen lds
    s_add_u32 m0, s61, 3072
    s_nop 0
    buffer_load_dwordx4 v3, s[36:39], s96 offen lds
    s_waitcnt vmcnt(42)
    ds_read_b64_tr_b16 v[196:197], v10 offset:8192
    ds_read_b64_tr_b16 v[198:199], v10 offset:9216
    ds_read_b64_tr_b16 v[200:201], v11 offset:8192
    ds_read_b64_tr_b16 v[202:203], v11 offset:9216
    s_waitcnt lgkmcnt(8)
    v_mfma_f32_32x32x16_bf16 v[20:35], v[180:183], v[84:87], v[20:35]
    v_mfma_f32_32x32x16_bf16 v[36:51], v[184:187], v[84:87], v[36:51]
    v_mfma_f32_32x32x16_bf16 v[52:67], v[180:183], v[88:91], v[52:67]
    v_mfma_f32_32x32x16_bf16 v[68:83], v[184:187], v[88:91], v[68:83]
    s_mov_b32 s96, 327680
    s_add_u32 m0, s61, 4096
    s_nop 0
    buffer_load_dwordx4 v2, s[36:39], s96 offen lds
    s_add_u32 m0, s61, 5120
    s_nop 0
    buffer_load_dwordx4 v3, s[36:39], s96 offen lds
    s_waitcnt vmcnt(40)
    ds_read_b64_tr_b16 v[180:181], v6 offset:0
    ds_read_b64_tr_b16 v[182:183], v6 offset:1024
    ds_read_b64_tr_b16 v[184:185], v7 offset:0
    ds_read_b64_tr_b16 v[186:187], v7 offset:1024
    s_waitcnt lgkmcnt(8)
    v_mfma_f32_32x32x16_bf16 v[20:35], v[188:191], v[92:95], v[20:35]
    v_mfma_f32_32x32x16_bf16 v[36:51], v[192:195], v[92:95], v[36:51]
    v_mfma_f32_32x32x16_bf16 v[52:67], v[188:191], v[96:99], v[52:67]
    v_mfma_f32_32x32x16_bf16 v[68:83], v[192:195], v[96:99], v[68:83]
    s_mov_b32 s96, 393216
    s_add_u32 m0, s61, 6144
    s_nop 0
    buffer_load_dwordx4 v2, s[36:39], s96 offen lds
    s_add_u32 m0, s61, 7168
    s_nop 0
    buffer_load_dwordx4 v3, s[36:39], s96 offen lds
    s_waitcnt vmcnt(38)
    ds_read_b64_tr_b16 v[188:189], v6 offset:2048
    ds_read_b64_tr_b16 v[190:191], v6 offset:3072
    ds_read_b64_tr_b16 v[192:193], v7 offset:2048
    ds_read_b64_tr_b16 v[194:195], v7 offset:3072
    s_waitcnt lgkmcnt(8)
    v_mfma_f32_32x32x16_bf16 v[20:35], v[196:199], v[100:103], v[20:35]
    v_mfma_f32_32x32x16_bf16 v[36:51], v[200:203], v[100:103], v[36:51]
    v_mfma_f32_32x32x16_bf16 v[52:67], v[196:199], v[104:107], v[52:67]
    v_mfma_f32_32x32x16_bf16 v[68:83], v[200:203], v[104:107], v[68:83]
    s_mov_b32 s96, 458752
    s_add_u32 m0, s61, 8192
    s_nop 0
    buffer_load_dwordx4 v2, s[36:39], s96 offen lds
    s_add_u32 m0, s61, 9216
    s_nop 0
    buffer_load_dwordx4 v3, s[36:39], s96 offen lds
    s_waitcnt vmcnt(36)
    ds_read_b64_tr_b16 v[196:197], v6 offset:4096
    ds_read_b64_tr_b16 v[198:199], v6 offset:5120
    ds_read_b64_tr_b16 v[200:201], v7 offset:4096
    ds_read_b64_tr_b16 v[202:203], v7 offset:5120
    s_waitcnt lgkmcnt(8)
    v_mfma_f32_32x32x16_bf16 v[20:35], v[180:183], v[108:111], v[20:35]
    v_mfma_f32_32x32x16_bf16 v[36:51], v[184:187], v[108:111], v[36:51]
    v_mfma_f32_32x32x16_bf16 v[52:67], v[180:183], v[112:115], v[52:67]
    v_mfma_f32_32x32x16_bf16 v[68:83], v[184:187], v[112:115], v[68:83]
    s_waitcnt vmcnt(32)
    ds_read_b64_tr_b16 v[180:181], v6 offset:6144
    ds_read_b64_tr_b16 v[182:183], v6 offset:7168
    ds_read_b64_tr_b16 v[184:185], v7 offset:6144
    ds_read_b64_tr_b16 v[186:187], v7 offset:7168
    s_waitcnt lgkmcnt(8)
    v_mfma_f32_32x32x16_bf16 v[20:35], v[188:191], v[116:119], v[20:35]
    v_mfma_f32_32x32x16_bf16 v[36:51], v[192:195], v[116:119], v[36:51]
    v_mfma_f32_32x32x16_bf16 v[52:67], v[188:191], v[120:123], v[52:67]
    v_mfma_f32_32x32x16_bf16 v[68:83], v[192:195], v[120:123], v[68:83]
    s_waitcnt vmcnt(28)
    ds_read_b64_tr_b16 v[188:189], v8 offset:0
    ds_read_b64_tr_b16 v[190:191], v8 offset:1024
    ds_read_b64_tr_b16 v[192:193], v9 offset:0
    ds_read_b64_tr_b16 v[194:195], v9 offset:1024
    s_waitcnt lgkmcnt(8)
    v_mfma_f32_32x32x16_bf16 v[20:35], v[196:199], v[124:127], v[20:35]
    v_mfma_f32_32x32x16_bf16 v[36:51], v[200:203], v[124:127], v[36:51]
    v_mfma_f32_32x32x16_bf16 v[52:67], v[196:199], v[128:131], v[52:67]
    v_mfma_f32_32x32x16_bf16 v[68:83], v[200:203], v[128:131], v[68:83]
    s_mov_b32 s99, 0
    buffer_load_dwordx4 v[164:167], v5, s[48:51], s99 offen sc1
    buffer_load_dwordx4 v[168:171], v5, s[52:55], s99 offen sc1
    s_mov_b32 s99, 4096
    buffer_load_dwordx4 v[172:175], v5, s[48:51], s99 offen sc1
    buffer_load_dwordx4 v[176:179], v5, s[52:55], s99 offen sc1
    s_mov_b32 s99, 8192
    buffer_load_dwordx4 v[84:87], v5, s[48:51], s99 offen sc1
    buffer_load_dwordx4 v[88:91], v5, s[52:55], s99 offen sc1
    s_mov_b32 s99, 12288
    buffer_load_dwordx4 v[92:95], v5, s[48:51], s99 offen sc1
    buffer_load_dwordx4 v[96:99], v5, s[52:55], s99 offen sc1
    s_mov_b32 s99, 16384
    buffer_load_dwordx4 v[100:103], v5, s[48:51], s99 offen sc1
    buffer_load_dwordx4 v[104:107], v5, s[52:55], s99 offen sc1
    s_mov_b32 s99, 20480
    buffer_load_dwordx4 v[108:111], v5, s[48:51], s99 offen sc1
    buffer_load_dwordx4 v[112:115], v5, s[52:55], s99 offen sc1
    s_mov_b32 s99, 24576
    buffer_load_dwordx4 v[116:119], v5, s[48:51], s99 offen sc1
    buffer_load_dwordx4 v[120:123], v5, s[52:55], s99 offen sc1
    s_mov_b32 s99, 28672
    buffer_load_dwordx4 v[124:127], v5, s[48:51], s99 offen sc1
    buffer_load_dwordx4 v[128:131], v5, s[52:55], s99 offen sc1
    s_waitcnt vmcnt(40)
    ds_read_b64_tr_b16 v[196:197], v8 offset:2048
    ds_read_b64_tr_b16 v[198:199], v8 offset:3072
    ds_read_b64_tr_b16 v[200:201], v9 offset:2048
    ds_read_b64_tr_b16 v[202:203], v9 offset:3072
    s_waitcnt lgkmcnt(8)
    v_mfma_f32_32x32x16_bf16 v[20:35], v[180:183], v[132:135], v[20:35]
    v_mfma_f32_32x32x16_bf16 v[36:51], v[184:187], v[132:135], v[36:51]
    v_mfma_f32_32x32x16_bf16 v[52:67], v[180:183], v[136:139], v[52:67]
    v_mfma_f32_32x32x16_bf16 v[68:83], v[184:187], v[136:139], v[68:83]
    s_waitcnt vmcnt(36)
    ds_read_b64_tr_b16 v[180:181], v8 offset:4096
    ds_read_b64_tr_b16 v[182:183], v8 offset:5120
    ds_read_b64_tr_b16 v[184:185], v9 offset:4096
    ds_read_b64_tr_b16 v[186:187], v9 offset:5120
    s_waitcnt lgkmcnt(8)
    v_mfma_f32_32x32x16_bf16 v[20:35], v[188:191], v[140:143], v[20:35]
    v_mfma_f32_32x32x16_bf16 v[36:51], v[192:195], v[140:143], v[36:51]
    v_mfma_f32_32x32x16_bf16 v[52:67], v[188:191], v[144:147], v[52:67]
    v_mfma_f32_32x32x16_bf16 v[68:83], v[192:195], v[144:147], v[68:83]
    s_waitcnt vmcnt(32)
    ds_read_b64_tr_b16 v[188:189], v8 offset:6144
    ds_read_b64_tr_b16 v[190:191], v8 offset:7168
    ds_read_b64_tr_b16 v[192:193], v9 offset:6144
    ds_read_b64_tr_b16 v[194:195], v9 offset:7168
    s_waitcnt lgkmcnt(8)
    v_mfma_f32_32x32x16_bf16 v[20:35], v[196:199], v[148:151], v[20:35]
    v_mfma_f32_32x32x16_bf16 v[36:51], v[200:203], v[148:151], v[36:51]
    v_mfma_f32_32x32x16_bf16 v[52:67], v[196:199], v[152:155], v[52:67]
    v_mfma_f32_32x32x16_bf16 v[68:83], v[200:203], v[152:155], v[68:83]
    s_lshl_b32 s78, s93, 16
    s_add_u32 s40, s4, s78
    s_addc_u32 s41, s5, 0
    s_and_b32 s41, s41, 0xffff
    s_mov_b32 s42, 65536
    s_mov_b32 s43, 0x20000
    s_add_u32 s44, s18, s78
    s_addc_u32 s45, s19, 0
    s_and_b32 s45, s45, 0xffff
    s_mov_b32 s46, 65536
    s_mov_b32 s47, 0x20000
    s_lshl_b32 s78, s68, 6
    v_add_u32 v1, s78, v0
    v_lshrrev_b32 v12, 3, v1
    v_and_b32 v13, 7, v1
    v_lshlrev_b32 v14, 10, v12
    v_lshl_add_u32 v14, v13, 4, v14
    s_lshl_b32 s78, s94, 7
    v_add_u32 v14, s78, v14
    v_add_u32 v15, 32768, v14
    buffer_load_dwordx4 v[204:207], v14, s[40:43], 0 offen
    buffer_load_dwordx4 v[208:211], v15, s[40:43], 0 offen
    s_waitcnt vmcnt(30)
    ds_read_b64_tr_b16 v[196:197], v8 offset:8192
    ds_read_b64_tr_b16 v[198:199], v8 offset:9216
    ds_read_b64_tr_b16 v[200:201], v9 offset:8192
    ds_read_b64_tr_b16 v[202:203], v9 offset:9216
    s_waitcnt lgkmcnt(8)
    v_mfma_f32_32x32x16_bf16 v[20:35], v[180:183], v[156:159], v[20:35]
    v_mfma_f32_32x32x16_bf16 v[36:51], v[184:187], v[156:159], v[36:51]
    s_waitcnt vmcnt(16)
    v_mfma_f32_32x32x16_bf16 v[52:67], v[180:183], v[160:163], v[52:67]
    v_max3_u32 v16, v164, v165, v166
    v_max3_u32 v17, v167, v168, v169
    v_max3_u32 v16, v170, v171, v16
    v_mfma_f32_32x32x16_bf16 v[68:83], v[184:187], v[160:163], v[68:83]
    v_max_u32 v16, v16, v17
    v_cmp_eq_u32 vcc, -1, v16
    s_cbranch_vccnz p2_gemm_retry22
p2_gemm_back22:
    ds_read_b64_tr_b16 v[180:181], v8 offset:10240
    ds_read_b64_tr_b16 v[182:183], v8 offset:11264
    ds_read_b64_tr_b16 v[184:185], v9 offset:10240
    ds_read_b64_tr_b16 v[186:187], v9 offset:11264
    s_waitcnt lgkmcnt(8)
    v_mfma_f32_32x32x16_bf16 v[20:35], v[188:191], v[164:167], v[20:35]
    v_mfma_f32_32x32x16_bf16 v[36:51], v[192:195], v[164:167], v[36:51]
    s_waitcnt vmcnt(14)
    v_mfma_f32_32x32x16_bf16 v[52:67], v[188:191], v[168:171], v[52:67]
    v_max3_u32 v16, v172, v173, v174
    v_max3_u32 v17, v175, v176, v177
    v_max3_u32 v16, v178, v179, v16
    v_mfma_f32_32x32x16_bf16 v[68:83], v[192:195], v[168:171], v[68:83]
    v_max_u32 v16, v16, v17
    v_cmp_eq_u32 vcc, -1, v16
    s_cbranch_vccnz p2_gemm_retry23
p2_gemm_back23:
    ds_read_b64_tr_b16 v[188:189], v10 offset:0
    ds_read_b64_tr_b16 v[190:191], v10 offset:1024
    ds_read_b64_tr_b16 v[192:193], v11 offset:0
    ds_read_b64_tr_b16 v[194:195], v11 offset:1024
    s_waitcnt lgkmcnt(8)
    v_mfma_f32_32x32x16_bf16 v[20:35], v[196:199], v[172:175], v[20:35]
    v_mfma_f32_32x32x16_bf16 v[36:51], v[200:203], v[172:175], v[36:51]
    s_waitcnt vmcnt(12)
    v_mfma_f32_32x32x16_bf16 v[52:67], v[196:199], v[176:179], v[52:67]
    v_max3_u32 v16, v84, v85, v86
    v_max3_u32 v17, v87, v88, v89
    v_max3_u32 v16, v90, v91, v16
    v_mfma_f32_32x32x16_bf16 v[68:83], v[200:203], v[176:179], v[68:83]
    v_max_u32 v16, v16, v17
    v_cmp_eq_u32 vcc, -1, v16
    s_cbranch_vccnz p2_gemm_retry24
p2_gemm_back24:
    ds_read_b64_tr_b16 v[196:197], v10 offset:2048
    ds_read_b64_tr_b16 v[198:199], v10 offset:3072
    ds_read_b64_tr_b16 v[200:201], v11 offset:2048
    ds_read_b64_tr_b16 v[202:203], v11 offset:3072
    s_waitcnt lgkmcnt(8)
    v_mfma_f32_32x32x16_bf16 v[20:35], v[180:183], v[84:87], v[20:35]
    v_mfma_f32_32x32x16_bf16 v[36:51], v[184:187], v[84:87], v[36:51]
    s_waitcnt vmcnt(10)
    v_mfma_f32_32x32x16_bf16 v[52:67], v[180:183], v[88:91], v[52:67]
    v_max3_u32 v16, v92, v93, v94
    v_max3_u32 v17, v95, v96, v97
    v_max3_u32 v16, v98, v99, v16
    v_mfma_f32_32x32x16_bf16 v[68:83], v[184:187], v[88:91], v[68:83]
    v_max_u32 v16, v16, v17
    v_cmp_eq_u32 vcc, -1, v16
    s_cbranch_vccnz p2_gemm_retry25
p2_gemm_back25:
    ds_read_b64_tr_b16 v[180:181], v10 offset:4096
    ds_read_b64_tr_b16 v[182:183], v10 offset:5120
    ds_read_b64_tr_b16 v[184:185], v11 offset:4096
    ds_read_b64_tr_b16 v[186:187], v11 offset:5120
    s_waitcnt lgkmcnt(8)
    v_mfma_f32_32x32x16_bf16 v[20:35], v[188:191], v[92:95], v[20:35]
    v_mfma_f32_32x32x16_bf16 v[36:51], v[192:195], v[92:95], v[36:51]
    s_waitcnt vmcnt(8)
    v_mfma_f32_32x32x16_bf16 v[52:67], v[188:191], v[96:99], v[52:67]
    v_max3_u32 v16, v100, v101, v102
    v_max3_u32 v17, v103, v104, v105
    v_max3_u32 v16, v106, v107, v16
    v_mfma_f32_32x32x16_bf16 v[68:83], v[192:195], v[96:99], v[68:83]
    v_max_u32 v16, v16, v17
    v_cmp_eq_u32 vcc, -1, v16
    s_cbranch_vccnz p2_gemm_retry26
p2_gemm_back26:
    ds_read_b64_tr_b16 v[188:189], v10 offset:6144
    ds_read_b64_tr_b16 v[190:191], v10 offset:7168
    ds_read_b64_tr_b16 v[192:193], v11 offset:6144
    ds_read_b64_tr_b16 v[194:195], v11 offset:7168
    s_waitcnt lgkmcnt(8)
    v_mfma_f32_32x32x16_bf16 v[20:35], v[196:199], v[100:103], v[20:35]
    v_mfma_f32_32x32x16_bf16 v[36:51], v[200:203], v[100:103], v[36:51]
    s_waitcnt vmcnt(6)
    v_mfma_f32_32x32x16_bf16 v[52:67], v[196:199], v[104:107], v[52:67]
    v_max3_u32 v16, v108, v109, v110
    v_max3_u32 v17, v111, v112, v113
    v_max3_u32 v16, v114, v115, v16
    v_mfma_f32_32x32x16_bf16 v[68:83], v[200:203], v[104:107], v[68:83]
    v_max_u32 v16, v16, v17
    v_cmp_eq_u32 vcc, -1, v16
    s_cbranch_vccnz p2_gemm_retry27
p2_gemm_back27:
    ds_read_b64_tr_b16 v[196:197], v10 offset:8192
    ds_read_b64_tr_b16 v[198:199], v10 offset:9216
    ds_read_b64_tr_b16 v[200:201], v11 offset:8192
    ds_read_b64_tr_b16 v[202:203], v11 offset:9216
    s_waitcnt lgkmcnt(8)
    v_mfma_f32_32x32x16_bf16 v[20:35], v[180:183], v[108:111], v[20:35]
    v_mfma_f32_32x32x16_bf16 v[36:51], v[184:187], v[108:111], v[36:51]
    s_waitcnt vmcnt(4)
    v_mfma_f32_32x32x16_bf16 v[52:67], v[180:183], v[112:115], v[52:67]
    v_max3_u32 v16, v116, v117, v118
    v_max3_u32 v17, v119, v120, v121
    v_max3_u32 v16, v122, v123, v16
    v_mfma_f32_32x32x16_bf16 v[68:83], v[184:187], v[112:115], v[68:83]
    v_max_u32 v16, v16, v17
    v_cmp_eq_u32 vcc, -1, v16
    s_cbranch_vccnz p2_gemm_retry28
p2_gemm_back28:
    s_waitcnt lgkmcnt(4)
    v_mfma_f32_32x32x16_bf16 v[20:35], v[188:191], v[116:119], v[20:35]
    v_mfma_f32_32x32x16_bf16 v[36:51], v[192:195], v[116:119], v[36:51]
    s_waitcnt vmcnt(2)
    v_mfma_f32_32x32x16_bf16 v[52:67], v[188:191], v[120:123], v[52:67]
    v_max3_u32 v16, v124, v125, v126
    v_max3_u32 v17, v127, v128, v129
    v_max3_u32 v16, v130, v131, v16
    v_mfma_f32_32x32x16_bf16 v[68:83], v[192:195], v[120:123], v[68:83]
    v_max_u32 v16, v16, v17
    v_cmp_eq_u32 vcc, -1, v16
    s_cbranch_vccnz p2_gemm_retry29
p2_gemm_back29:
    s_waitcnt lgkmcnt(0)
    v_mfma_f32_32x32x16_bf16 v[20:35], v[196:199], v[124:127], v[20:35]
    v_mfma_f32_32x32x16_bf16 v[36:51], v[200:203], v[124:127], v[36:51]
    v_mfma_f32_32x32x16_bf16 v[52:67], v[196:199], v[128:131], v[52:67]
    v_mfma_f32_32x32x16_bf16 v[68:83], v[200:203], v[128:131], v[68:83]
    v_and_b32 v6, 31, v0
    v_mul_u32_u24 v6, 272, v6
    v_lshrrev_b32 v7, 5, v0
    v_lshl_add_u32 v6, v7, 4, v6
    v_add_u32 v7, s61, v6
    v_add_u32 v6, s60, v6
    v_mul_u32_u24 v8, 272, v12
    v_lshl_add_u32 v8, v13, 5, v8
    v_add_u32 v5, 53376, v8
    ds_write_b128 v6, v[20:23] offset:0
    ds_write_b128 v6, v[24:27] offset:32
    ds_write_b128 v6, v[28:31] offset:64
    ds_write_b128 v6, v[32:35] offset:96
    ds_write_b128 v6, v[36:39] offset:128
    ds_write_b128 v6, v[40:43] offset:160
    ds_write_b128 v6, v[44:47] offset:192
    ds_write_b128 v6, v[48:51] offset:224
    ds_write_b128 v7, v[52:55] offset:0
    ds_write_b128 v7, v[56:59] offset:32
    ds_write_b128 v7, v[60:63] offset:64
    ds_write_b128 v7, v[64:67] offset:96
    ds_write_b128 v7, v[68:71] offset:128
    ds_write_b128 v7, v[72:75] offset:160
    ds_write_b128 v7, v[76:79] offset:192
    ds_write_b128 v7, v[80:83] offset:224
    s_waitcnt lgkmcnt(0)
    s_barrier
    ds_read_b128 v[20:23], v8 offset:0
    ds_read_b128 v[24:27], v8 offset:16
    ds_read_b128 v[28:31], v8 offset:12288
    ds_read_b128 v[32:35], v8 offset:12304
    ds_read_b128 v[36:39], v8 offset:24576
    ds_read_b128 v[40:43], v8 offset:24592
    ds_read_b128 v[44:47], v8 offset:36864
    ds_read_b128 v[48:51], v8 offset:36880
    ds_read_b128 v[52:55], v5 offset:0
    ds_read_b128 v[56:59], v5 offset:16
    ds_read_b128 v[60:63], v5 offset:10240
    ds_read_b128 v[64:67], v5 offset:10256
    ds_read_b128 v[68:71], v5 offset:20480
    ds_read_b128 v[72:75], v5 offset:20496
    ds_read_b128 v[76:79], v5 offset:30720
    ds_read_b128 v[80:83], v5 offset:30736
    s_waitcnt vmcnt(0)
    s_waitcnt lgkmcnt(8)
    v_add_f32 v20, v20, v28
    v_add_f32 v36, v36, v44
    v_add_f32 v21, v21, v29
    v_add_f32 v37, v37, v45
    v_add_f32 v22, v22, v30
    v_add_f32 v38, v38, v46
    v_add_f32 v23, v23, v31
    v_add_f32 v39, v39, v47
    v_add_f32 v24, v24, v32
    v_add_f32 v40, v40, v48
    v_add_f32 v25, v25, v33
    v_add_f32 v41, v41, v49
    v_add_f32 v26, v26, v34
    v_add_f32 v42, v42, v50
    v_add_f32 v27, v27, v35
    v_add_f32 v43, v43, v51
    v_lshlrev_b32 v28, 16, v204
    v_and_b32 v29, 0xffff0000, v204
    v_lshlrev_b32 v30, 16, v205
    v_and_b32 v31, 0xffff0000, v205
    v_lshlrev_b32 v32, 16, v206
    v_and_b32 v33, 0xffff0000, v206
    v_lshlrev_b32 v34, 16, v207
    v_and_b32 v35, 0xffff0000, v207
    v_add_f32 v20, v20, v36
    v_add_f32 v21, v21, v37
    v_add_f32 v22, v22, v38
    v_add_f32 v23, v23, v39
    v_add_f32 v24, v24, v40
    v_add_f32 v25, v25, v41
    v_add_f32 v26, v26, v42
    v_add_f32 v27, v27, v43
    v_add_f32 v20, v20, v28
    v_add_f32 v21, v21, v29
    v_add_f32 v22, v22, v30
    v_add_f32 v23, v23, v31
    v_add_f32 v24, v24, v32
    v_add_f32 v25, v25, v33
    v_add_f32 v26, v26, v34
    v_add_f32 v27, v27, v35
    v_cvt_pk_bf16_f32 v36, v20, v21
    v_cvt_pk_bf16_f32 v37, v22, v23
    v_cvt_pk_bf16_f32 v38, v24, v25
    v_cvt_pk_bf16_f32 v39, v26, v27
    buffer_store_dwordx4 v[36:39], v14, s[44:47], 0 offen
    s_waitcnt lgkmcnt(0)
    v_add_f32 v52, v52, v60
    v_add_f32 v68, v68, v76
    v_add_f32 v53, v53, v61
    v_add_f32 v69, v69, v77
    v_add_f32 v54, v54, v62
    v_add_f32 v70, v70, v78
    v_add_f32 v55, v55, v63
    v_add_f32 v71, v71, v79
    v_add_f32 v56, v56, v64
    v_add_f32 v72, v72, v80
    v_add_f32 v57, v57, v65
    v_add_f32 v73, v73, v81
    v_add_f32 v58, v58, v66
    v_add_f32 v74, v74, v82
    v_add_f32 v59, v59, v67
    v_add_f32 v75, v75, v83
    v_lshlrev_b32 v60, 16, v208
    v_and_b32 v61, 0xffff0000, v208
    v_lshlrev_b32 v62, 16, v209
    v_and_b32 v63, 0xffff0000, v209
    v_lshlrev_b32 v64, 16, v210
    v_and_b32 v65, 0xffff0000, v210
    v_lshlrev_b32 v66, 16, v211
    v_and_b32 v67, 0xffff0000, v211
    v_add_f32 v52, v52, v68
    v_add_f32 v53, v53, v69
    v_add_f32 v54, v54, v70
    v_add_f32 v55, v55, v71
    v_add_f32 v56, v56, v72
    v_add_f32 v57, v57, v73
    v_add_f32 v58, v58, v74
    v_add_f32 v59, v59, v75
    v_add_f32 v52, v52, v60
    v_add_f32 v53, v53, v61
    v_add_f32 v54, v54, v62
    v_add_f32 v55, v55, v63
    v_add_f32 v56, v56, v64
    v_add_f32 v57, v57, v65
    v_add_f32 v58, v58, v66
    v_add_f32 v59, v59, v67
    v_cvt_pk_bf16_f32 v68, v52, v53
    v_cvt_pk_bf16_f32 v69, v54, v55
    v_cvt_pk_bf16_f32 v70, v56, v57
    v_cvt_pk_bf16_f32 v71, v58, v59
    buffer_store_dwordx4 v[68:71], v15, s[44:47], 0 offen
    s_endpgm
p2_gemm_poll0:
    s_mov_b32 s98, 0
    s_cmp_lg_u32 s68, 0
    s_cbranch_scc1 p2_gemm_lw0
p2_gemm_pr0:
    buffer_load_dword v16, v213, s[56:59], s75 offen sc1
    s_waitcnt vmcnt(0)
    v_cmp_ne_u32 vcc, 1, v16
    s_nop 1
    v_cndmask_b32 v16, 22, v212, vcc
    v_cmp_gt_u32 vcc, 3, v16
    s_nop 0
    s_cmp_eq_u64 vcc, 0
    s_cselect_b32 s74, 3, s74
    v_cmp_gt_u32 vcc, 6, v16
    s_nop 0
    s_cmp_eq_u64 vcc, 0
    s_cselect_b32 s74, 6, s74
    v_cmp_gt_u32 vcc, 9, v16
    s_nop 0
    s_cmp_eq_u64 vcc, 0
    s_cselect_b32 s74, 9, s74
    v_cmp_gt_u32 vcc, 12, v16
    s_nop 0
    s_cmp_eq_u64 vcc, 0
    s_cselect_b32 s74, 12, s74
    v_cmp_gt_u32 vcc, 15, v16
    s_nop 0
    s_cmp_eq_u64 vcc, 0
    s_cselect_b32 s74, 15, s74
    v_cmp_gt_u32 vcc, 18, v16
    s_nop 0
    s_cmp_eq_u64 vcc, 0
    s_cselect_b32 s74, 18, s74
    v_cmp_gt_u32 vcc, 21, v16
    s_nop 0
    s_cmp_eq_u64 vcc, 0
    s_cselect_b32 s74, 21, s74
    v_cmp_gt_u32 vcc, 22, v16
    s_nop 0
    s_cmp_eq_u64 vcc, 0
    s_cselect_b32 s74, 22, s74
    s_add_u32 s98, s98, 1
    s_cmp_gt_u32 s98, 0x8000
    s_cselect_b32 s74, 22, s74
    v_mov_b32 v16, s74
    ds_write_b32 v214, v16 offset:4
    s_cmp_ge_u32 s74, 3
    s_cbranch_scc1 p2_gemm_go0
    s_sleep 4
    s_branch p2_gemm_pr0
p2_gemm_lw0:
    ds_read_b32 v16, v214 offset:4
    s_waitcnt lgkmcnt(0)
    v_readfirstlane_b32 s74, v16
    s_add_u32 s98, s98, 1
    s_cmp_gt_u32 s98, 0x100000
    s_cselect_b32 s74, 22, s74
    s_cmp_ge_u32 s74, 3
    s_cbranch_scc1 p2_gemm_go0
    s_sleep 1
    s_branch p2_gemm_lw0
p2_gemm_poll1:
    s_mov_b32 s98, 0
    s_cmp_lg_u32 s68, 0
    s_cbranch_scc1 p2_gemm_lw1
p2_gemm_pr1:
    buffer_load_dword v16, v213, s[56:59], s75 offen sc1
    s_waitcnt vmcnt(0)
    v_cmp_ne_u32 vcc, 1, v16
    s_nop 1
    v_cndmask_b32 v16, 22, v212, vcc
    v_cmp_gt_u32 vcc, 6, v16
    s_nop 0
    s_cmp_eq_u64 vcc, 0
    s_cselect_b32 s74, 6, s74
    v_cmp_gt_u32 vcc, 9, v16
    s_nop 0
    s_cmp_eq_u64 vcc, 0
    s_cselect_b32 s74, 9, s74
    v_cmp_gt_u32 vcc, 12, v16
    s_nop 0
    s_cmp_eq_u64 vcc, 0
    s_cselect_b32 s74, 12, s74
    v_cmp_gt_u32 vcc, 15, v16
    s_nop 0
    s_cmp_eq_u64 vcc, 0
    s_cselect_b32 s74, 15, s74
    v_cmp_gt_u32 vcc, 18, v16
    s_nop 0
    s_cmp_eq_u64 vcc, 0
    s_cselect_b32 s74, 18, s74
    v_cmp_gt_u32 vcc, 21, v16
    s_nop 0
    s_cmp_eq_u64 vcc, 0
    s_cselect_b32 s74, 21, s74
    v_cmp_gt_u32 vcc, 22, v16
    s_nop 0
    s_cmp_eq_u64 vcc, 0
    s_cselect_b32 s74, 22, s74
    s_add_u32 s98, s98, 1
    s_cmp_gt_u32 s98, 0x8000
    s_cselect_b32 s74, 22, s74
    v_mov_b32 v16, s74
    ds_write_b32 v214, v16 offset:4
    s_cmp_ge_u32 s74, 6
    s_cbranch_scc1 p2_gemm_go1
    s_sleep 4
    s_branch p2_gemm_pr1
p2_gemm_lw1:
    ds_read_b32 v16, v214 offset:4
    s_waitcnt lgkmcnt(0)
    v_readfirstlane_b32 s74, v16
    s_add_u32 s98, s98, 1
    s_cmp_gt_u32 s98, 0x100000
    s_cselect_b32 s74, 22, s74
    s_cmp_ge_u32 s74, 6
    s_cbranch_scc1 p2_gemm_go1
    s_sleep 1
    s_branch p2_gemm_lw1
p2_gemm_poll2:
    s_mov_b32 s98, 0
    s_cmp_lg_u32 s68, 0
    s_cbranch_scc1 p2_gemm_lw2
p2_gemm_pr2:
    buffer_load_dword v16, v213, s[56:59], s75 offen sc1
    s_waitcnt vmcnt(0)
    v_cmp_ne_u32 vcc, 1, v16
    s_nop 1
    v_cndmask_b32 v16, 22, v212, vcc
    v_cmp_gt_u32 vcc, 9, v16
    s_nop 0
    s_cmp_eq_u64 vcc, 0
    s_cselect_b32 s74, 9, s74
    v_cmp_gt_u32 vcc, 12, v16
    s_nop 0
    s_cmp_eq_u64 vcc, 0
    s_cselect_b32 s74, 12, s74
    v_cmp_gt_u32 vcc, 15, v16
    s_nop 0
    s_cmp_eq_u64 vcc, 0
    s_cselect_b32 s74, 15, s74
    v_cmp_gt_u32 vcc, 18, v16
    s_nop 0
    s_cmp_eq_u64 vcc, 0
    s_cselect_b32 s74, 18, s74
    v_cmp_gt_u32 vcc, 21, v16
    s_nop 0
    s_cmp_eq_u64 vcc, 0
    s_cselect_b32 s74, 21, s74
    v_cmp_gt_u32 vcc, 22, v16
    s_nop 0
    s_cmp_eq_u64 vcc, 0
    s_cselect_b32 s74, 22, s74
    s_add_u32 s98, s98, 1
    s_cmp_gt_u32 s98, 0x8000
    s_cselect_b32 s74, 22, s74
    v_mov_b32 v16, s74
    ds_write_b32 v214, v16 offset:4
    s_cmp_ge_u32 s74, 9
    s_cbranch_scc1 p2_gemm_go2
    s_sleep 4
    s_branch p2_gemm_pr2
p2_gemm_lw2:
    ds_read_b32 v16, v214 offset:4
    s_waitcnt lgkmcnt(0)
    v_readfirstlane_b32 s74, v16
    s_add_u32 s98, s98, 1
    s_cmp_gt_u32 s98, 0x100000
    s_cselect_b32 s74, 22, s74
    s_cmp_ge_u32 s74, 9
    s_cbranch_scc1 p2_gemm_go2
    s_sleep 1
    s_branch p2_gemm_lw2
p2_gemm_poll3:
    s_mov_b32 s98, 0
    s_cmp_lg_u32 s68, 0
    s_cbranch_scc1 p2_gemm_lw3
p2_gemm_pr3:
    buffer_load_dword v16, v213, s[56:59], s75 offen sc1
    s_waitcnt vmcnt(0)
    v_cmp_ne_u32 vcc, 1, v16
    s_nop 1
    v_cndmask_b32 v16, 22, v212, vcc
    v_cmp_gt_u32 vcc, 12, v16
    s_nop 0
    s_cmp_eq_u64 vcc, 0
    s_cselect_b32 s74, 12, s74
    v_cmp_gt_u32 vcc, 15, v16
    s_nop 0
    s_cmp_eq_u64 vcc, 0
    s_cselect_b32 s74, 15, s74
    v_cmp_gt_u32 vcc, 18, v16
    s_nop 0
    s_cmp_eq_u64 vcc, 0
    s_cselect_b32 s74, 18, s74
    v_cmp_gt_u32 vcc, 21, v16
    s_nop 0
    s_cmp_eq_u64 vcc, 0
    s_cselect_b32 s74, 21, s74
    v_cmp_gt_u32 vcc, 22, v16
    s_nop 0
    s_cmp_eq_u64 vcc, 0
    s_cselect_b32 s74, 22, s74
    s_add_u32 s98, s98, 1
    s_cmp_gt_u32 s98, 0x8000
    s_cselect_b32 s74, 22, s74
    v_mov_b32 v16, s74
    ds_write_b32 v214, v16 offset:4
    s_cmp_ge_u32 s74, 12
    s_cbranch_scc1 p2_gemm_go3
    s_sleep 4
    s_branch p2_gemm_pr3
p2_gemm_lw3:
    ds_read_b32 v16, v214 offset:4
    s_waitcnt lgkmcnt(0)
    v_readfirstlane_b32 s74, v16
    s_add_u32 s98, s98, 1
    s_cmp_gt_u32 s98, 0x100000
    s_cselect_b32 s74, 22, s74
    s_cmp_ge_u32 s74, 12
    s_cbranch_scc1 p2_gemm_go3
    s_sleep 1
    s_branch p2_gemm_lw3
p2_gemm_poll4:
    s_mov_b32 s98, 0
    s_cmp_lg_u32 s68, 0
    s_cbranch_scc1 p2_gemm_lw4
p2_gemm_pr4:
    buffer_load_dword v16, v213, s[56:59], s75 offen sc1
    s_waitcnt vmcnt(0)
    v_cmp_ne_u32 vcc, 1, v16
    s_nop 1
    v_cndmask_b32 v16, 22, v212, vcc
    v_cmp_gt_u32 vcc, 15, v16
    s_nop 0
    s_cmp_eq_u64 vcc, 0
    s_cselect_b32 s74, 15, s74
    v_cmp_gt_u32 vcc, 18, v16
    s_nop 0
    s_cmp_eq_u64 vcc, 0
    s_cselect_b32 s74, 18, s74
    v_cmp_gt_u32 vcc, 21, v16
    s_nop 0
    s_cmp_eq_u64 vcc, 0
    s_cselect_b32 s74, 21, s74
    v_cmp_gt_u32 vcc, 22, v16
    s_nop 0
    s_cmp_eq_u64 vcc, 0
    s_cselect_b32 s74, 22, s74
    s_add_u32 s98, s98, 1
    s_cmp_gt_u32 s98, 0x8000
    s_cselect_b32 s74, 22, s74
    v_mov_b32 v16, s74
    ds_write_b32 v214, v16 offset:4
    s_cmp_ge_u32 s74, 15
    s_cbranch_scc1 p2_gemm_go4
    s_sleep 4
    s_branch p2_gemm_pr4
p2_gemm_lw4:
    ds_read_b32 v16, v214 offset:4
    s_waitcnt lgkmcnt(0)
    v_readfirstlane_b32 s74, v16
    s_add_u32 s98, s98, 1
    s_cmp_gt_u32 s98, 0x100000
    s_cselect_b32 s74, 22, s74
    s_cmp_ge_u32 s74, 15
    s_cbranch_scc1 p2_gemm_go4
    s_sleep 1
    s_branch p2_gemm_lw4
p2_gemm_poll5:
    s_mov_b32 s98, 0
    s_cmp_lg_u32 s68, 0
    s_cbranch_scc1 p2_gemm_lw5
p2_gemm_pr5:
    buffer_load_dword v16, v213, s[56:59], s75 offen sc1
    s_waitcnt vmcnt(0)
    v_cmp_ne_u32 vcc, 1, v16
    s_nop 1
    v_cndmask_b32 v16, 22, v212, vcc
    v_cmp_gt_u32 vcc, 18, v16
    s_nop 0
    s_cmp_eq_u64 vcc, 0
    s_cselect_b32 s74, 18, s74
    v_cmp_gt_u32 vcc, 21, v16
    s_nop 0
    s_cmp_eq_u64 vcc, 0
    s_cselect_b32 s74, 21, s74
    v_cmp_gt_u32 vcc, 22, v16
    s_nop 0
    s_cmp_eq_u64 vcc, 0
    s_cselect_b32 s74, 22, s74
    s_add_u32 s98, s98, 1
    s_cmp_gt_u32 s98, 0x8000
    s_cselect_b32 s74, 22, s74
    v_mov_b32 v16, s74
    ds_write_b32 v214, v16 offset:4
    s_cmp_ge_u32 s74, 18
    s_cbranch_scc1 p2_gemm_go5
    s_sleep 4
    s_branch p2_gemm_pr5
p2_gemm_lw5:
    ds_read_b32 v16, v214 offset:4
    s_waitcnt lgkmcnt(0)
    v_readfirstlane_b32 s74, v16
    s_add_u32 s98, s98, 1
    s_cmp_gt_u32 s98, 0x100000
    s_cselect_b32 s74, 22, s74
    s_cmp_ge_u32 s74, 18
    s_cbranch_scc1 p2_gemm_go5
    s_sleep 1
    s_branch p2_gemm_lw5
p2_gemm_poll6:
    s_mov_b32 s98, 0
    s_cmp_lg_u32 s68, 0
    s_cbranch_scc1 p2_gemm_lw6
p2_gemm_pr6:
    buffer_load_dword v16, v213, s[56:59], s75 offen sc1
    s_waitcnt vmcnt(0)
    v_cmp_ne_u32 vcc, 1, v16
    s_nop 1
    v_cndmask_b32 v16, 22, v212, vcc
    v_cmp_gt_u32 vcc, 21, v16
    s_nop 0
    s_cmp_eq_u64 vcc, 0
    s_cselect_b32 s74, 21, s74
    v_cmp_gt_u32 vcc, 22, v16
    s_nop 0
    s_cmp_eq_u64 vcc, 0
    s_cselect_b32 s74, 22, s74
    s_add_u32 s98, s98, 1
    s_cmp_gt_u32 s98, 0x8000
    s_cselect_b32 s74, 22, s74
    v_mov_b32 v16, s74
    ds_write_b32 v214, v16 offset:4
    s_cmp_ge_u32 s74, 21
    s_cbranch_scc1 p2_gemm_go6
    s_sleep 4
    s_branch p2_gemm_pr6
p2_gemm_lw6:
    ds_read_b32 v16, v214 offset:4
    s_waitcnt lgkmcnt(0)
    v_readfirstlane_b32 s74, v16
    s_add_u32 s98, s98, 1
    s_cmp_gt_u32 s98, 0x100000
    s_cselect_b32 s74, 22, s74
    s_cmp_ge_u32 s74, 21
    s_cbranch_scc1 p2_gemm_go6
    s_sleep 1
    s_branch p2_gemm_lw6
p2_gemm_poll7:
    s_mov_b32 s98, 0
    s_cmp_lg_u32 s68, 0
    s_cbranch_scc1 p2_gemm_lw7
p2_gemm_pr7:
    buffer_load_dword v16, v213, s[56:59], s75 offen sc1
    s_waitcnt vmcnt(0)
    v_cmp_ne_u32 vcc, 1, v16
    s_nop 1
    v_cndmask_b32 v16, 22, v212, vcc
    v_cmp_gt_u32 vcc, 22, v16
    s_nop 0
    s_cmp_eq_u64 vcc, 0
    s_cselect_b32 s74, 22, s74
    s_add_u32 s98, s98, 1
    s_cmp_gt_u32 s98, 0x8000
    s_cselect_b32 s74, 22, s74
    v_mov_b32 v16, s74
    ds_write_b32 v214, v16 offset:4
    s_cmp_ge_u32 s74, 22
    s_cbranch_scc1 p2_gemm_go7
    s_sleep 4
    s_branch p2_gemm_pr7
p2_gemm_lw7:
    ds_read_b32 v16, v214 offset:4
    s_waitcnt lgkmcnt(0)
    v_readfirstlane_b32 s74, v16
    s_add_u32 s98, s98, 1
    s_cmp_gt_u32 s98, 0x100000
    s_cselect_b32 s74, 22, s74
    s_cmp_ge_u32 s74, 22
    s_cbranch_scc1 p2_gemm_go7
    s_sleep 1
    s_branch p2_gemm_lw7
p2_gemm_retry22:
    s_mov_b32 s98, 0
p2_gemm_rl22:
    s_sleep 2
    s_mov_b32 s79, 0
    buffer_load_dwordx4 v[164:167], v5, s[48:51], s79 offen sc1
    buffer_load_dwordx4 v[168:171], v5, s[52:55], s79 offen sc1
    s_mov_b32 s79, 4096
    buffer_load_dwordx4 v[172:175], v5, s[48:51], s79 offen sc1
    buffer_load_dwordx4 v[176:179], v5, s[52:55], s79 offen sc1
    s_mov_b32 s79, 8192
    buffer_load_dwordx4 v[84:87], v5, s[48:51], s79 offen sc1
    buffer_load_dwordx4 v[88:91], v5, s[52:55], s79 offen sc1
    s_mov_b32 s79, 12288
    buffer_load_dwordx4 v[92:95], v5, s[48:51], s79 offen sc1
    buffer_load_dwordx4 v[96:99], v5, s[52:55], s79 offen sc1
    s_mov_b32 s79, 16384
    buffer_load_dwordx4 v[100:103], v5, s[48:51], s79 offen sc1
    buffer_load_dwordx4 v[104:107], v5, s[52:55], s79 offen sc1
    s_mov_b32 s79, 20480
    buffer_load_dwordx4 v[108:111], v5, s[48:51], s79 offen sc1
    buffer_load_dwordx4 v[112:115], v5, s[52:55], s79 offen sc1
    s_mov_b32 s79, 24576
    buffer_load_dwordx4 v[116:119], v5, s[48:51], s79 offen sc1
    buffer_load_dwordx4 v[120:123], v5, s[52:55], s79 offen sc1
    s_mov_b32 s79, 28672
    buffer_load_dwordx4 v[124:127], v5, s[48:51], s79 offen sc1
    buffer_load_dwordx4 v[128:131], v5, s[52:55], s79 offen sc1
    s_waitcnt vmcnt(0)
    v_max3_u32 v16, v164, v165, v166
    v_max3_u32 v17, v167, v168, v169
    v_max3_u32 v16, v170, v171, v16
    v_max_u32 v16, v16, v17
    v_cmp_eq_u32 vcc, -1, v16
    s_add_u32 s98, s98, 1
    s_cmp_gt_u32 s98, 0x8000
    s_cbranch_scc1 p2_gemm_back22
    s_cbranch_vccnz p2_gemm_rl22
    s_branch p2_gemm_back22
p2_gemm_retry23:
    s_mov_b32 s98, 0
p2_gemm_rl23:
    s_sleep 2
    s_mov_b32 s79, 4096
    buffer_load_dwordx4 v[172:175], v5, s[48:51], s79 offen sc1
    buffer_load_dwordx4 v[176:179], v5, s[52:55], s79 offen sc1
    s_mov_b32 s79, 8192
    buffer_load_dwordx4 v[84:87], v5, s[48:51], s79 offen sc1
    buffer_load_dwordx4 v[88:91], v5, s[52:55], s79 offen sc1
    s_mov_b32 s79, 12288
    buffer_load_dwordx4 v[92:95], v5, s[48:51], s79 offen sc1
    buffer_load_dwordx4 v[96:99], v5, s[52:55], s79 offen sc1
    s_mov_b32 s79, 16384
    buffer_load_dwordx4 v[100:103], v5, s[48:51], s79 offen sc1
    buffer_load_dwordx4 v[104:107], v5, s[52:55], s79 offen sc1
    s_mov_b32 s79, 20480
    buffer_load_dwordx4 v[108:111], v5, s[48:51], s79 offen sc1
    buffer_load_dwordx4 v[112:115], v5, s[52:55], s79 offen sc1
    s_mov_b32 s79, 24576
    buffer_load_dwordx4 v[116:119], v5, s[48:51], s79 offen sc1
    buffer_load_dwordx4 v[120:123], v5, s[52:55], s79 offen sc1
    s_mov_b32 s79, 28672
    buffer_load_dwordx4 v[124:127], v5, s[48:51], s79 offen sc1
    buffer_load_dwordx4 v[128:131], v5, s[52:55], s79 offen sc1
    s_waitcnt vmcnt(0)
    v_max3_u32 v16, v172, v173, v174
    v_max3_u32 v17, v175, v176, v177
    v_max3_u32 v16, v178, v179, v16
    v_max_u32 v16, v16, v17
    v_cmp_eq_u32 vcc, -1, v16
    s_add_u32 s98, s98, 1
    s_cmp_gt_u32 s98, 0x8000
    s_cbranch_scc1 p2_gemm_back23
    s_cbranch_vccnz p2_gemm_rl23
    s_branch p2_gemm_back23
p2_gemm_retry24:
    s_mov_b32 s98, 0
p2_gemm_rl24:
    s_sleep 2
    s_mov_b32 s79, 8192
    buffer_load_dwordx4 v[84:87], v5, s[48:51], s79 offen sc1
    buffer_load_dwordx4 v[88:91], v5, s[52:55], s79 offen sc1
    s_mov_b32 s79, 12288
    buffer_load_dwordx4 v[92:95], v5, s[48:51], s79 offen sc1
    buffer_load_dwordx4 v[96:99], v5, s[52:55], s79 offen sc1
    s_mov_b32 s79, 16384
    buffer_load_dwordx4 v[100:103], v5, s[48:51], s79 offen sc1
    buffer_load_dwordx4 v[104:107], v5, s[52:55], s79 offen sc1
    s_mov_b32 s79, 20480
    buffer_load_dwordx4 v[108:111], v5, s[48:51], s79 offen sc1
    buffer_load_dwordx4 v[112:115], v5, s[52:55], s79 offen sc1
    s_mov_b32 s79, 24576
    buffer_load_dwordx4 v[116:119], v5, s[48:51], s79 offen sc1
    buffer_load_dwordx4 v[120:123], v5, s[52:55], s79 offen sc1
    s_mov_b32 s79, 28672
    buffer_load_dwordx4 v[124:127], v5, s[48:51], s79 offen sc1
    buffer_load_dwordx4 v[128:131], v5, s[52:55], s79 offen sc1
    s_waitcnt vmcnt(0)
    v_max3_u32 v16, v84, v85, v86
    v_max3_u32 v17, v87, v88, v89
    v_max3_u32 v16, v90, v91, v16
    v_max_u32 v16, v16, v17
    v_cmp_eq_u32 vcc, -1, v16
    s_add_u32 s98, s98, 1
    s_cmp_gt_u32 s98, 0x8000
    s_cbranch_scc1 p2_gemm_back24
    s_cbranch_vccnz p2_gemm_rl24
    s_branch p2_gemm_back24
p2_gemm_retry25:
    s_mov_b32 s98, 0
p2_gemm_rl25:
    s_sleep 2
    s_mov_b32 s79, 12288
    buffer_load_dwordx4 v[92:95], v5, s[48:51], s79 offen sc1
    buffer_load_dwordx4 v[96:99], v5, s[52:55], s79 offen sc1
    s_mov_b32 s79, 16384
    buffer_load_dwordx4 v[100:103], v5, s[48:51], s79 offen sc1
    buffer_load_dwordx4 v[104:107], v5, s[52:55], s79 offen sc1
    s_mov_b32 s79, 20480
    buffer_load_dwordx4 v[108:111], v5, s[48:51], s79 offen sc1
    buffer_load_dwordx4 v[112:115], v5, s[52:55], s79 offen sc1
    s_mov_b32 s79, 24576
    buffer_load_dwordx4 v[116:119], v5, s[48:51], s79 offen sc1
    buffer_load_dwordx4 v[120:123], v5, s[52:55], s79 offen sc1
    s_mov_b32 s79, 28672
    buffer_load_dwordx4 v[124:127], v5, s[48:51], s79 offen sc1
    buffer_load_dwordx4 v[128:131], v5, s[52:55], s79 offen sc1
    s_waitcnt vmcnt(0)
    v_max3_u32 v16, v92, v93, v94
    v_max3_u32 v17, v95, v96, v97
    v_max3_u32 v16, v98, v99, v16
    v_max_u32 v16, v16, v17
    v_cmp_eq_u32 vcc, -1, v16
    s_add_u32 s98, s98, 1
    s_cmp_gt_u32 s98, 0x8000
    s_cbranch_scc1 p2_gemm_back25
    s_cbranch_vccnz p2_gemm_rl25
    s_branch p2_gemm_back25
p2_gemm_retry26:
    s_mov_b32 s98, 0
p2_gemm_rl26:
    s_sleep 2
    s_mov_b32 s79, 16384
    buffer_load_dwordx4 v[100:103], v5, s[48:51], s79 offen sc1
    buffer_load_dwordx4 v[104:107], v5, s[52:55], s79 offen sc1
    s_mov_b32 s79, 20480
    buffer_load_dwordx4 v[108:111], v5, s[48:51], s79 offen sc1
    buffer_load_dwordx4 v[112:115], v5, s[52:55], s79 offen sc1
    s_mov_b32 s79, 24576
    buffer_load_dwordx4 v[116:119], v5, s[48:51], s79 offen sc1
    buffer_load_dwordx4 v[120:123], v5, s[52:55], s79 offen sc1
    s_mov_b32 s79, 28672
    buffer_load_dwordx4 v[124:127], v5, s[48:51], s79 offen sc1
    buffer_load_dwordx4 v[128:131], v5, s[52:55], s79 offen sc1
    s_waitcnt vmcnt(0)
    v_max3_u32 v16, v100, v101, v102
    v_max3_u32 v17, v103, v104, v105
    v_max3_u32 v16, v106, v107, v16
    v_max_u32 v16, v16, v17
    v_cmp_eq_u32 vcc, -1, v16
    s_add_u32 s98, s98, 1
    s_cmp_gt_u32 s98, 0x8000
    s_cbranch_scc1 p2_gemm_back26
    s_cbranch_vccnz p2_gemm_rl26
    s_branch p2_gemm_back26
p2_gemm_retry27:
    s_mov_b32 s98, 0
p2_gemm_rl27:
    s_sleep 2
    s_mov_b32 s79, 20480
    buffer_load_dwordx4 v[108:111], v5, s[48:51], s79 offen sc1
    buffer_load_dwordx4 v[112:115], v5, s[52:55], s79 offen sc1
    s_mov_b32 s79, 24576
    buffer_load_dwordx4 v[116:119], v5, s[48:51], s79 offen sc1
    buffer_load_dwordx4 v[120:123], v5, s[52:55], s79 offen sc1
    s_mov_b32 s79, 28672
    buffer_load_dwordx4 v[124:127], v5, s[48:51], s79 offen sc1
    buffer_load_dwordx4 v[128:131], v5, s[52:55], s79 offen sc1
    s_waitcnt vmcnt(0)
    v_max3_u32 v16, v108, v109, v110
    v_max3_u32 v17, v111, v112, v113
    v_max3_u32 v16, v114, v115, v16
    v_max_u32 v16, v16, v17
    v_cmp_eq_u32 vcc, -1, v16
    s_add_u32 s98, s98, 1
    s_cmp_gt_u32 s98, 0x8000
    s_cbranch_scc1 p2_gemm_back27
    s_cbranch_vccnz p2_gemm_rl27
    s_branch p2_gemm_back27
p2_gemm_retry28:
    s_mov_b32 s98, 0
p2_gemm_rl28:
    s_sleep 2
    s_mov_b32 s79, 24576
    buffer_load_dwordx4 v[116:119], v5, s[48:51], s79 offen sc1
    buffer_load_dwordx4 v[120:123], v5, s[52:55], s79 offen sc1
    s_mov_b32 s79, 28672
    buffer_load_dwordx4 v[124:127], v5, s[48:51], s79 offen sc1
    buffer_load_dwordx4 v[128:131], v5, s[52:55], s79 offen sc1
    s_waitcnt vmcnt(0)
    v_max3_u32 v16, v116, v117, v118
    v_max3_u32 v17, v119, v120, v121
    v_max3_u32 v16, v122, v123, v16
    v_max_u32 v16, v16, v17
    v_cmp_eq_u32 vcc, -1, v16
    s_add_u32 s98, s98, 1
    s_cmp_gt_u32 s98, 0x8000
    s_cbranch_scc1 p2_gemm_back28
    s_cbranch_vccnz p2_gemm_rl28
    s_branch p2_gemm_back28
p2_gemm_retry29:
    s_mov_b32 s98, 0
p2_gemm_rl29:
    s_sleep 2
    s_mov_b32 s79, 28672
    buffer_load_dwordx4 v[124:127], v5, s[48:51], s79 offen sc1
    buffer_load_dwordx4 v[128:131], v5, s[52:55], s79 offen sc1
    s_waitcnt vmcnt(0)
    v_max3_u32 v16, v124, v125, v126
    v_max3_u32 v17, v127, v128, v129
    v_max3_u32 v16, v130, v131, v16
    v_max_u32 v16, v16, v17
    v_cmp_eq_u32 vcc, -1, v16
    s_add_u32 s98, s98, 1
    s_cmp_gt_u32 s98, 0x8000
    s_cbranch_scc1 p2_gemm_back29
    s_cbranch_vccnz p2_gemm_rl29
    s_branch p2_gemm_back29
k1_kv:
    s_sub_u32 s78, s69, 20
    s_and_b32 s79, s78, 1
    s_lshl_b32 s72, s70, 1
    s_add_u32 s72, s72, s79
    s_lshr_b32 s78, s78, 1
    s_lshl_b32 s73, s71, 2
    s_add_u32 s73, s73, s78
    s_lshl_b32 s79, s72, 18
    s_lshl_b32 s91, s73, 7
    s_add_u32 s91, s91, 1024
    s_cmp_lt_u32 s68, 4
    s_cbranch_scc1 k1_kv_c
    s_sub_u32 s74, s68, 4
    s_lshr_b32 s62, s69, 2
    s_add_u32 s62, s62, s69
    v_lshrrev_b32 v8, 3, v0
    v_and_b32 v9, 7, v0
    s_lshl_b32 s78, s74, 3
    v_add_u32 v10, s78, v8
    v_bfe_u32 v11, v10, 1, 3
    v_xor_b32 v11, v11, v9
    v_lshlrev_b32 v11, 4, v11
    v_lshl_add_u32 v16, v10, 10, v11
    s_lshl_b32 s77, s74, 10
    v_and_b32 v11, 2, v8
    v_lshlrev_b32 v11, 1, v11
    v_xor_b32 v11, v11, v9
    v_lshlrev_b32 v11, 4, v11
    s_mov_b32 s80, 3072
    v_mad_u32_u24 v17, v10, s80, v11
    v_add_u32 v17, s91, v17
    s_waitcnt lgkmcnt(0)
    s_add_u32 s24, s4, s79
    s_addc_u32 s25, s5, 0
    s_and_b32 s25, s25, 0xffff
    s_mov_b32 s26, 262144
    s_mov_b32 s27, 0x20000
    s_mov_b32 s28, s6
    s_and_b32 s29, s7, 0xffff
    s_mov_b32 s30, 1572864
    s_mov_b32 s31, 0x20000
    s_mov_b32 s44, s4
    s_and_b32 s45, s5, 0xffff
    s_mov_b32 s46, 2097152
    s_mov_b32 s47, 0x20000
    s_lshl_b32 s85, s2, 2
    s_add_u32 s85, s85, s74
    s_lshl_b32 s78, s85, 11
    buffer_load_dwordx4 v[20:23], v4, s[44:47], s78 offen
    buffer_load_dwordx4 v[24:27], v4, s[44:47], s78 offen offset:1024
    s_and_b32 s78, s62, 0
    s_xor_b32 s78, s78, 0
    s_lshl_b32 s63, s78, 7
    s_mul_i32 s87, s78, 196608
    s_add_u32 m0, s77, 0
    s_add_u32 s78, s63, 0
    buffer_load_dwordx4 v16, s[24:27], s78 offen lds
    s_add_u32 m0, s77, 4096
    s_add_u32 s78, s63, 32768
    buffer_load_dwordx4 v16, s[24:27], s78 offen lds
    s_add_u32 m0, s77, 8192
    s_add_u32 s78, s63, 65536
    buffer_load_dwordx4 v16, s[24:27], s78 offen lds
    s_add_u32 m0, s77, 12288
    s_add_u32 s78, s63, 98304
    buffer_load_dwordx4 v16, s[24:27], s78 offen lds
    s_add_u32 m0, s77, 16384
    s_add_u32 s78, s63, 131072
    buffer_load_dwordx4 v16, s[24:27], s78 offen lds
    s_add_u32 m0, s77, 20480
    s_add_u32 s78, s63, 163840
    buffer_load_dwordx4 v16, s[24:27], s78 offen lds
    s_add_u32 m0, s77, 24576
    s_add_u32 s78, s63, 196608
    buffer_load_dwordx4 v16, s[24:27], s78 offen lds
    s_add_u32 m0, s77, 28672
    s_add_u32 s78, s63, 229376
    buffer_load_dwordx4 v16, s[24:27], s78 offen lds
    s_add_u32 m0, s77, 32768
    s_add_u32 s78, s87, 0
    buffer_load_dwordx4 v17, s[28:31], s78 offen lds
    s_add_u32 m0, s77, 36864
    s_add_u32 s78, s87, 98304
    buffer_load_dwordx4 v17, s[28:31], s78 offen lds
    s_add_u32 m0, s77, 40960
    s_add_u32 s78, s87, 1024
    buffer_load_dwordx4 v17, s[28:31], s78 offen lds
    s_add_u32 m0, s77, 45056
    s_add_u32 s78, s87, 99328
    buffer_load_dwordx4 v17, s[28:31], s78 offen lds
    s_mov_b32 s36, s8
    s_and_b32 s37, s9, 0xffff
    s_mov_b32 s38, 16384
    s_mov_b32 s39, 0x20000
    s_lshl_b32 s78, s73, 11
    s_add_u32 s78, s78, s77
    s_add_u32 m0, s77, 147456
    s_nop 0
    buffer_load_dwordx4 v4, s[36:39], s78 offen lds
    s_lshl_b32 s92, s70, 1
    s_add_u32 s92, s92, s71
    s_mov_b32 s64, s20
    s_and_b32 s65, s21, 0xffff
    s_mov_b32 s66, 256
    s_mov_b32 s67, 0x20000
    s_add_u32 s56, s22, 11534336
    s_addc_u32 s57, s23, 0
    s_and_b32 s57, s57, 0xffff
    s_mov_b32 s58, 81920
    s_mov_b32 s59, 0x20000
    s_and_b32 s93, s69, 3
    s_lshr_b32 s94, s69, 2
    s_mul_i32 s95, s94, 1
    s_mul_i32 s78, s93, 6
    s_add_u32 s95, s95, s78
    s_sub_u32 s78, s95, 22
    s_cmp_ge_u32 s95, 22
    s_cselect_b32 s95, s78, s95
    s_add_u32 s96, s95, 0
    s_sub_u32 s78, s96, 22
    s_cmp_ge_u32 s96, 22
    s_cselect_b32 s96, s78, s96
    s_lshl_b32 s95, s95, 12
    s_lshl_b32 s96, s96, 16
    s_lshl_b32 s78, s92, 2
    s_add_u32 s93, s93, s78
    s_mul_i32 s97, s74, 8192
    s_add_u32 s97, s97, 114944
    s_mul_i32 s60, s74, 12288
    s_add_u32 s60, s60, 0
    s_mul_i32 s61, s74, 10240
    s_add_u32 s61, s61, 53376
    s_add_u32 s48, s22, 9437184
    s_addc_u32 s49, s23, 0
    s_and_b32 s49, s49, 0xffff
    s_mov_b32 s50, 2097152
    s_mov_b32 s51, 0x20000
    s_lshl_b32 s78, s92, 3
    s_lshl_b32 s79, s74, 1
    s_add_u32 s78, s78, s79
    s_lshl_b32 s90, s78, 15
    s_add_u32 s91, s90, 32768
    s_lshl_b32 s89, s69, 10
    s_mov_b32 s36, s8
    s_and_b32 s37, s9, 0xffff
    s_mov_b32 s38, 16384
    s_mov_b32 s39, 0x20000
    s_mov_b32 s78, 0x10000
    s_lshr_b32 s79, s89, 1
    s_cmp_eq_u32 s74, 0
    s_cselect_b32 s78, s79, s78
    s_lshl_b32 s79, s74, 9
    s_add_u32 m0, s79, 160256
    s_cmp_lt_u32 s74, 1
    s_cselect_b32 exec_lo, -1, 1
    s_mov_b32 exec_hi, 0
    s_cselect_b32 m0, m0, 163840
    s_nop 0
    buffer_load_dwordx4 v4, s[36:39], s78 offen lds
    s_mov_b64 exec, -1
    v_mov_b32 v36, 0xffff0000
    v_mov_b32 v7, 0
    v_mov_b32 v6, 1
    v_mov_b32 v5, 163776
    v_mov_b32 v28, -1
    v_mov_b32 v29, -1
    v_mov_b32 v30, -1
    v_mov_b32 v31, -1
    ds_write_b32 v5, v7 offset:0
    ds_write_b32 v5, v7 offset:4
    ds_write_b32 v5, v7 offset:8
    ds_write_b32 v5, v7 offset:12
    ds_write_b32 v5, v7 offset:16
    ds_write_b32 v5, v7 offset:32
    ds_write_b32 v5, v7 offset:36
    ds_write_b32 v5, v7 offset:40
    ds_write_b32 v5, v7 offset:44
    ds_write_b32 v5, v7 offset:48
    ds_write_b32 v5, v7 offset:52
    ds_write_b32 v5, v7 offset:56
    ds_write_b32 v5, v7 offset:60
    s_waitcnt lgkmcnt(0)
    s_and_b32 s78, s62, 0
    s_xor_b32 s78, s78, 1
    s_lshl_b32 s63, s78, 7
    s_mul_i32 s87, s78, 196608
    s_add_u32 m0, s77, 49152
    s_add_u32 s78, s63, 0
    buffer_load_dwordx4 v16, s[24:27], s78 offen lds
    s_add_u32 m0, s77, 53248
    s_add_u32 s78, s63, 32768
    buffer_load_dwordx4 v16, s[24:27], s78 offen lds
    s_add_u32 m0, s77, 57344
    s_add_u32 s78, s63, 65536
    buffer_load_dwordx4 v16, s[24:27], s78 offen lds
    s_add_u32 m0, s77, 61440
    s_add_u32 s78, s63, 98304
    buffer_load_dwordx4 v16, s[24:27], s78 offen lds
    s_add_u32 m0, s77, 65536
    s_add_u32 s78, s63, 131072
    buffer_load_dwordx4 v16, s[24:27], s78 offen lds
    s_add_u32 m0, s77, 69632
    s_add_u32 s78, s63, 163840
    buffer_load_dwordx4 v16, s[24:27], s78 offen lds
    s_add_u32 m0, s77, 73728
    s_add_u32 s78, s63, 196608
    buffer_load_dwordx4 v16, s[24:27], s78 offen lds
    s_add_u32 m0, s77, 77824
    s_add_u32 s78, s63, 229376
    buffer_load_dwordx4 v16, s[24:27], s78 offen lds
    s_add_u32 m0, s77, 81920
    s_add_u32 s78, s87, 0
    buffer_load_dwordx4 v17, s[28:31], s78 offen lds
    s_add_u32 m0, s77, 86016
    s_add_u32 s78, s87, 98304
    buffer_load_dwordx4 v17, s[28:31], s78 offen lds
    s_add_u32 m0, s77, 90112
    s_add_u32 s78, s87, 1024
    buffer_load_dwordx4 v17, s[28:31], s78 offen lds
    s_add_u32 m0, s77, 94208
    s_add_u32 s78, s87, 99328
    buffer_load_dwordx4 v17, s[28:31], s78 offen lds
    s_waitcnt vmcnt(14)
    s_barrier
    s_waitcnt vmcnt(14)
    v_lshlrev_b32 v8, 16, v20
    v_lshlrev_b32 v10, 16, v24
    v_and_b32 v9, v36, v20
    v_and_b32 v11, v36, v24
    v_add_f32 v32, v8, v9
    v_add_f32 v34, v10, v11
    v_mul_f32 v33, v8, v8
    v_mul_f32 v35, v10, v10
    v_fmac_f32 v33, v9, v9
    v_fmac_f32 v35, v11, v11
    v_lshlrev_b32 v8, 16, v21
    v_lshlrev_b32 v10, 16, v25
    v_and_b32 v9, v36, v21
    v_and_b32 v11, v36, v25
    v_add_f32 v32, v32, v8
    v_add_f32 v34, v34, v10
    v_fmac_f32 v33, v8, v8
    v_fmac_f32 v35, v10, v10
    v_add_f32 v32, v32, v9
    v_add_f32 v34, v34, v11
    v_fmac_f32 v33, v9, v9
    v_fmac_f32 v35, v11, v11
    v_lshlrev_b32 v8, 16, v22
    v_lshlrev_b32 v10, 16, v26
    v_and_b32 v9, v36, v22
    v_and_b32 v11, v36, v26
    v_add_f32 v32, v32, v8
    v_add_f32 v34, v34, v10
    v_fmac_f32 v33, v8, v8
    v_fmac_f32 v35, v10, v10
    v_add_f32 v32, v32, v9
    v_add_f32 v34, v34, v11
    v_fmac_f32 v33, v9, v9
    v_fmac_f32 v35, v11, v11
    v_lshlrev_b32 v8, 16, v23
    v_lshlrev_b32 v10, 16, v27
    v_and_b32 v9, v36, v23
    v_and_b32 v11, v36, v27
    v_add_f32 v32, v32, v8
    v_add_f32 v34, v34, v10
    v_fmac_f32 v33, v8, v8
    v_fmac_f32 v35, v10, v10
    v_add_f32 v32, v32, v9
    v_add_f32 v34, v34, v11
    v_fmac_f32 v33, v9, v9
    v_fmac_f32 v35, v11, v11
    v_add_f32 v32, v32, v32 row_ror:8 row_mask:0xf bank_mask:0xf
    v_add_f32 v34, v34, v34 row_ror:8 row_mask:0xf bank_mask:0xf
    v_add_f32 v33, v33, v33 row_ror:8 row_mask:0xf bank_mask:0xf
    v_add_f32 v35, v35, v35 row_ror:8 row_mask:0xf bank_mask:0xf
    v_add_f32 v32, v32, v32 row_ror:4 row_mask:0xf bank_mask:0xf
    v_add_f32 v34, v34, v34 row_ror:4 row_mask:0xf bank_mask:0xf
    v_add_f32 v33, v33, v33 row_ror:4 row_mask:0xf bank_mask:0xf
    v_add_f32 v35, v35, v35 row_ror:4 row_mask:0xf bank_mask:0xf
    v_add_f32 v32, v32, v32 row_ror:2 row_mask:0xf bank_mask:0xf
    v_add_f32 v34, v34, v34 row_ror:2 row_mask:0xf bank_mask:0xf
    v_add_f32 v33, v33, v33 row_ror:2 row_mask:0xf bank_mask:0xf
    v_add_f32 v35, v35, v35 row_ror:2 row_mask:0xf bank_mask:0xf
    v_add_f32 v32, v32, v32 row_ror:1 row_mask:0xf bank_mask:0xf
    v_add_f32 v34, v34, v34 row_ror:1 row_mask:0xf bank_mask:0xf
    v_add_f32 v33, v33, v33 row_ror:1 row_mask:0xf bank_mask:0xf
    v_add_f32 v35, v35, v35 row_ror:1 row_mask:0xf bank_mask:0xf
    v_mov_b32 v8, v32
    v_mov_b32 v10, v34
    v_mov_b32 v9, v33
    v_mov_b32 v11, v35
    v_permlane16_swap_b32 v32, v8
    v_permlane16_swap_b32 v34, v10
    v_permlane16_swap_b32 v33, v9
    v_permlane16_swap_b32 v35, v11
    v_add_f32 v32, v32, v8
    v_add_f32 v34, v34, v10
    v_add_f32 v33, v33, v9
    v_add_f32 v35, v35, v11
    v_mov_b32 v8, v32
    v_mov_b32 v10, v34
    v_mov_b32 v9, v33
    v_mov_b32 v11, v35
    v_permlane32_swap_b32 v32, v8
    v_permlane32_swap_b32 v34, v10
    v_permlane32_swap_b32 v33, v9
    v_permlane32_swap_b32 v35, v11
    v_add_f32 v32, v32, v8
    v_add_f32 v34, v34, v10
    v_add_f32 v33, v33, v9
    v_add_f32 v35, v35, v11
    v_mul_f32 v32, 0xbb000000, v32
    v_mul_f32 v34, 0xbb000000, v34
    v_mul_f32 v33, 0x3b000000, v33
    v_mul_f32 v35, 0x3b000000, v35
    v_fma_f32 v33, -v32, v32, v33
    v_fma_f32 v35, -v34, v34, v35
    v_max_f32 v33, 0, v33
    v_max_f32 v35, 0, v35
    v_add_f32 v33, 0x3727c5ac, v33
    v_add_f32 v35, 0x3727c5ac, v35
    s_lshl_b32 s78, s85, 4
    s_add_u32 s78, s78, 65536
    s_mov_b64 exec, 1
    buffer_store_dwordx2 v[32:33], v7, s[56:59], s78 offen sc1
    buffer_store_dwordx2 v[34:35], v7, s[56:59], s78 offen offset:8 sc1
    s_mov_b64 exec, -1
    s_add_u32 s78, s90, s89
    buffer_store_dwordx4 v[28:31], v4, s[48:51], s78 offen sc1
    s_add_u32 s78, s91, s89
    buffer_store_dwordx4 v[28:31], v4, s[48:51], s78 offen sc1
    s_add_u32 s40, s22, 8388608
    s_addc_u32 s41, s23, 0
    s_and_b32 s41, s41, 0xffff
    s_mov_b32 s42, 1048576
    s_mov_b32 s43, 0x20000
    s_lshl_b32 s78, s72, 5
    s_lshl_b32 s80, s73, 2
    s_add_u32 s78, s78, s80
    s_add_u32 s78, s78, s74
    s_lshl_b32 s88, s78, 12
    buffer_store_dwordx4 v[28:31], v4, s[40:43], s88 offen offset:0 sc1
    buffer_store_dwordx4 v[28:31], v4, s[40:43], s88 offen offset:1024 sc1
    buffer_store_dwordx4 v[28:31], v4, s[40:43], s88 offen offset:2048 sc1
    buffer_store_dwordx4 v[28:31], v4, s[40:43], s88 offen offset:3072 sc1
    s_and_b32 s78, s62, 1
    s_xor_b32 s78, s78, 2
    s_lshl_b32 s63, s78, 7
    s_mul_i32 s87, s78, 196608
    s_add_u32 m0, s77, 98304
    s_add_u32 s78, s63, 0
    buffer_load_dwordx4 v16, s[24:27], s78 offen lds
    s_add_u32 m0, s77, 102400
    s_add_u32 s78, s63, 32768
    buffer_load_dwordx4 v16, s[24:27], s78 offen lds
    s_add_u32 m0, s77, 106496
    s_add_u32 s78, s63, 65536
    buffer_load_dwordx4 v16, s[24:27], s78 offen lds
    s_add_u32 m0, s77, 110592
    s_add_u32 s78, s63, 98304
    buffer_load_dwordx4 v16, s[24:27], s78 offen lds
    s_add_u32 m0, s77, 114688
    s_add_u32 s78, s63, 131072
    buffer_load_dwordx4 v16, s[24:27], s78 offen lds
    s_add_u32 m0, s77, 118784
    s_add_u32 s78, s63, 163840
    buffer_load_dwordx4 v16, s[24:27], s78 offen lds
    s_add_u32 m0, s77, 122880
    s_add_u32 s78, s63, 196608
    buffer_load_dwordx4 v16, s[24:27], s78 offen lds
    s_add_u32 m0, s77, 126976
    s_add_u32 s78, s63, 229376
    buffer_load_dwordx4 v16, s[24:27], s78 offen lds
    s_add_u32 m0, s77, 131072
    s_add_u32 s78, s87, 0
    buffer_load_dwordx4 v17, s[28:31], s78 offen lds
    s_add_u32 m0, s77, 135168
    s_add_u32 s78, s87, 98304
    buffer_load_dwordx4 v17, s[28:31], s78 offen lds
    s_add_u32 m0, s77, 139264
    s_add_u32 s78, s87, 1024
    buffer_load_dwordx4 v17, s[28:31], s78 offen lds
    s_add_u32 m0, s77, 143360
    s_add_u32 s78, s87, 99328
    buffer_load_dwordx4 v17, s[28:31], s78 offen lds
    s_waitcnt vmcnt(20)
    s_barrier
    s_and_b32 s78, s62, 1
    s_xor_b32 s78, s78, 3
    s_lshl_b32 s63, s78, 7
    s_mul_i32 s87, s78, 196608
    s_add_u32 m0, s77, 0
    s_add_u32 s78, s63, 0
    buffer_load_dwordx4 v16, s[24:27], s78 offen lds
    s_add_u32 m0, s77, 4096
    s_add_u32 s78, s63, 32768
    buffer_load_dwordx4 v16, s[24:27], s78 offen lds
    s_add_u32 m0, s77, 8192
    s_add_u32 s78, s63, 65536
    buffer_load_dwordx4 v16, s[24:27], s78 offen lds
    s_add_u32 m0, s77, 12288
    s_add_u32 s78, s63, 98304
    buffer_load_dwordx4 v16, s[24:27], s78 offen lds
    s_add_u32 m0, s77, 16384
    s_add_u32 s78, s63, 131072
    buffer_load_dwordx4 v16, s[24:27], s78 offen lds
    s_add_u32 m0, s77, 20480
    s_add_u32 s78, s63, 163840
    buffer_load_dwordx4 v16, s[24:27], s78 offen lds
    s_add_u32 m0, s77, 24576
    s_add_u32 s78, s63, 196608
    buffer_load_dwordx4 v16, s[24:27], s78 offen lds
    s_add_u32 m0, s77, 28672
    s_add_u32 s78, s63, 229376
    buffer_load_dwordx4 v16, s[24:27], s78 offen lds
    s_add_u32 m0, s77, 32768
    s_add_u32 s78, s87, 0
    buffer_load_dwordx4 v17, s[28:31], s78 offen lds
    s_add_u32 m0, s77, 36864
    s_add_u32 s78, s87, 98304
    buffer_load_dwordx4 v17, s[28:31], s78 offen lds
    s_add_u32 m0, s77, 40960
    s_add_u32 s78, s87, 1024
    buffer_load_dwordx4 v17, s[28:31], s78 offen lds
    s_add_u32 m0, s77, 45056
    s_add_u32 s78, s87, 99328
    buffer_load_dwordx4 v17, s[28:31], s78 offen lds
    s_waitcnt vmcnt(12)
    s_barrier
    s_lshl_b32 s78, s74, 12
    s_and_b32 s79, s2, 15
    s_lshl_b32 s79, s79, 4
    s_add_u32 s78, s78, s79
    s_mov_b64 exec, 1
    buffer_atomic_add v6, v7, s[64:67], s78 offen
    s_mov_b64 exec, -1
    s_and_b32 s78, s62, 3
    s_xor_b32 s78, s78, 4
    s_lshl_b32 s63, s78, 7
    s_mul_i32 s87, s78, 196608
    s_add_u32 m0, s77, 49152
    s_add_u32 s78, s63, 0
    buffer_load_dwordx4 v16, s[24:27], s78 offen lds
    s_add_u32 m0, s77, 53248
    s_add_u32 s78, s63, 32768
    buffer_load_dwordx4 v16, s[24:27], s78 offen lds
    s_add_u32 m0, s77, 57344
    s_add_u32 s78, s63, 65536
    buffer_load_dwordx4 v16, s[24:27], s78 offen lds
    s_add_u32 m0, s77, 61440
    s_add_u32 s78, s63, 98304
    buffer_load_dwordx4 v16, s[24:27], s78 offen lds
    s_add_u32 m0, s77, 65536
    s_add_u32 s78, s63, 131072
    buffer_load_dwordx4 v16, s[24:27], s78 offen lds
    s_add_u32 m0, s77, 69632
    s_add_u32 s78, s63, 163840
    buffer_load_dwordx4 v16, s[24:27], s78 offen lds
    s_add_u32 m0, s77, 73728
    s_add_u32 s78, s63, 196608
    buffer_load_dwordx4 v16, s[24:27], s78 offen lds
    s_add_u32 m0, s77, 77824
    s_add_u32 s78, s63, 229376
    buffer_load_dwordx4 v16, s[24:27], s78 offen lds
    s_add_u32 m0, s77, 81920
    s_add_u32 s78, s87, 0
    buffer_load_dwordx4 v17, s[28:31], s78 offen lds
    s_add_u32 m0, s77, 86016
    s_add_u32 s78, s87, 98304
    buffer_load_dwordx4 v17, s[28:31], s78 offen lds
    s_add_u32 m0, s77, 90112
    s_add_u32 s78, s87, 1024
    buffer_load_dwordx4 v17, s[28:31], s78 offen lds
    s_add_u32 m0, s77, 94208
    s_add_u32 s78, s87, 99328
    buffer_load_dwordx4 v17, s[28:31], s78 offen lds
    s_waitcnt vmcnt(13)
    s_barrier
    s_and_b32 s78, s62, 3
    s_xor_b32 s78, s78, 5
    s_lshl_b32 s63, s78, 7
    s_mul_i32 s87, s78, 196608
    s_add_u32 m0, s77, 98304
    s_add_u32 s78, s63, 0
    buffer_load_dwordx4 v16, s[24:27], s78 offen lds
    s_add_u32 m0, s77, 102400
    s_add_u32 s78, s63, 32768
    buffer_load_dwordx4 v16, s[24:27], s78 offen lds
    s_add_u32 m0, s77, 106496
    s_add_u32 s78, s63, 65536
    buffer_load_dwordx4 v16, s[24:27], s78 offen lds
    s_add_u32 m0, s77, 110592
    s_add_u32 s78, s63, 98304
    buffer_load_dwordx4 v16, s[24:27], s78 offen lds
    s_add_u32 m0, s77, 114688
    s_add_u32 s78, s63, 131072
    buffer_load_dwordx4 v16, s[24:27], s78 offen lds
    s_add_u32 m0, s77, 118784
    s_add_u32 s78, s63, 163840
    buffer_load_dwordx4 v16, s[24:27], s78 offen lds
    s_add_u32 m0, s77, 122880
    s_add_u32 s78, s63, 196608
    buffer_load_dwordx4 v16, s[24:27], s78 offen lds
    s_add_u32 m0, s77, 126976
    s_add_u32 s78, s63, 229376
    buffer_load_dwordx4 v16, s[24:27], s78 offen lds
    s_add_u32 m0, s77, 131072
    s_add_u32 s78, s87, 0
    buffer_load_dwordx4 v17, s[28:31], s78 offen lds
    s_add_u32 m0, s77, 135168
    s_add_u32 s78, s87, 98304
    buffer_load_dwordx4 v17, s[28:31], s78 offen lds
    s_add_u32 m0, s77, 139264
    s_add_u32 s78, s87, 1024
    buffer_load_dwordx4 v17, s[28:31], s78 offen lds
    s_add_u32 m0, s77, 143360
    s_add_u32 s78, s87, 99328
    buffer_load_dwordx4 v17, s[28:31], s78 offen lds
    s_waitcnt vmcnt(12)
    s_barrier
    s_and_b32 s78, s62, 3
    s_xor_b32 s78, s78, 6
    s_lshl_b32 s63, s78, 7
    s_mul_i32 s87, s78, 196608
    s_add_u32 m0, s77, 0
    s_add_u32 s78, s63, 0
    buffer_load_dwordx4 v16, s[24:27], s78 offen lds
    s_add_u32 m0, s77, 4096
    s_add_u32 s78, s63, 32768
    buffer_load_dwordx4 v16, s[24:27], s78 offen lds
    s_add_u32 m0, s77, 8192
    s_add_u32 s78, s63, 65536
    buffer_load_dwordx4 v16, s[24:27], s78 offen lds
    s_add_u32 m0, s77, 12288
    s_add_u32 s78, s63, 98304
    buffer_load_dwordx4 v16, s[24:27], s78 offen lds
    s_add_u32 m0, s77, 16384
    s_add_u32 s78, s63, 131072
    buffer_load_dwordx4 v16, s[24:27], s78 offen lds
    s_add_u32 m0, s77, 20480
    s_add_u32 s78, s63, 163840
    buffer_load_dwordx4 v16, s[24:27], s78 offen lds
    s_add_u32 m0, s77, 24576
    s_add_u32 s78, s63, 196608
    buffer_load_dwordx4 v16, s[24:27], s78 offen lds
    s_add_u32 m0, s77, 28672
    s_add_u32 s78, s63, 229376
    buffer_load_dwordx4 v16, s[24:27], s78 offen lds
    s_add_u32 m0, s77, 32768
    s_add_u32 s78, s87, 0
    buffer_load_dwordx4 v17, s[28:31], s78 offen lds
    s_add_u32 m0, s77, 36864
    s_add_u32 s78, s87, 98304
    buffer_load_dwordx4 v17, s[28:31], s78 offen lds
    s_add_u32 m0, s77, 40960
    s_add_u32 s78, s87, 1024
    buffer_load_dwordx4 v17, s[28:31], s78 offen lds
    s_add_u32 m0, s77, 45056
    s_add_u32 s78, s87, 99328
    buffer_load_dwordx4 v17, s[28:31], s78 offen lds
    s_waitcnt vmcnt(12)
    s_barrier
    s_and_b32 s78, s62, 3
    s_xor_b32 s78, s78, 7
    s_lshl_b32 s63, s78, 7
    s_mul_i32 s87, s78, 196608
    s_add_u32 m0, s77, 49152
    s_add_u32 s78, s63, 0
    buffer_load_dwordx4 v16, s[24:27], s78 offen lds
    s_add_u32 m0, s77, 53248
    s_add_u32 s78, s63, 32768
    buffer_load_dwordx4 v16, s[24:27], s78 offen lds
    s_add_u32 m0, s77, 57344
    s_add_u32 s78, s63, 65536
    buffer_load_dwordx4 v16, s[24:27], s78 offen lds
    s_add_u32 m0, s77, 61440
    s_add_u32 s78, s63, 98304
    buffer_load_dwordx4 v16, s[24:27], s78 offen lds
    s_add_u32 m0, s77, 65536
    s_add_u32 s78, s63, 131072
    buffer_load_dwordx4 v16, s[24:27], s78 offen lds
    s_add_u32 m0, s77, 69632
    s_add_u32 s78, s63, 163840
    buffer_load_dwordx4 v16, s[24:27], s78 offen lds
    s_add_u32 m0, s77, 73728
    s_add_u32 s78, s63, 196608
    buffer_load_dwordx4 v16, s[24:27], s78 offen lds
    s_add_u32 m0, s77, 77824
    s_add_u32 s78, s63, 229376
    buffer_load_dwordx4 v16, s[24:27], s78 offen lds
    s_add_u32 m0, s77, 81920
    s_add_u32 s78, s87, 0
    buffer_load_dwordx4 v17, s[28:31], s78 offen lds
    s_add_u32 m0, s77, 86016
    s_add_u32 s78, s87, 98304
    buffer_load_dwordx4 v17, s[28:31], s78 offen lds
    s_add_u32 m0, s77, 90112
    s_add_u32 s78, s87, 1024
    buffer_load_dwordx4 v17, s[28:31], s78 offen lds
    s_add_u32 m0, s77, 94208
    s_add_u32 s78, s87, 99328
    buffer_load_dwordx4 v17, s[28:31], s78 offen lds
    s_mov_b32 s32, s16
    s_and_b32 s33, s17, 0xffff
    s_mov_b32 s34, 1409024
    s_mov_b32 s35, 0x20000
    v_lshrrev_b32 v8, 3, v0
    v_and_b32 v9, 7, v0
    v_and_b32 v10, 2, v8
    v_lshlrev_b32 v10, 1, v10
    v_xor_b32 v10, v10, v9
    v_lshlrev_b32 v10, 4, v10
    v_lshl_add_u32 v2, v8, 10, v10
    s_lshl_b32 s78, s74, 14
    s_lshl_b32 s79, s94, 7
    s_add_u32 s78, s78, s79
    v_add_u32 v2, s78, v2
    v_add_u32 v3, 8192, v2
    s_waitcnt vmcnt(12)
    s_barrier
    s_add_u32 m0, s97, 0
    s_nop 0
    buffer_load_dwordx4 v2, s[32:35], s96 offen lds
    s_add_u32 m0, s97, 1024
    s_nop 0
    buffer_load_dwordx4 v3, s[32:35], s96 offen lds
    s_add_u32 s96, s96, 65536
    s_cmp_eq_u32 s96, 1441792
    s_cselect_b32 s96, 0, s96
    s_add_u32 m0, s97, 2048
    s_nop 0
    buffer_load_dwordx4 v2, s[32:35], s96 offen lds
    s_add_u32 m0, s97, 3072
    s_nop 0
    buffer_load_dwordx4 v3, s[32:35], s96 offen lds
    s_add_u32 s96, s96, 65536
    s_cmp_eq_u32 s96, 1441792
    s_cselect_b32 s96, 0, s96
    s_add_u32 m0, s97, 4096
    s_nop 0
    buffer_load_dwordx4 v2, s[32:35], s96 offen lds
    s_add_u32 m0, s97, 5120
    s_nop 0
    buffer_load_dwordx4 v3, s[32:35], s96 offen lds
    s_add_u32 s96, s96, 65536
    s_cmp_eq_u32 s96, 1441792
    s_cselect_b32 s96, 0, s96
    s_add_u32 m0, s97, 6144
    s_nop 0
    buffer_load_dwordx4 v2, s[32:35], s96 offen lds
    s_add_u32 m0, s97, 7168
    s_nop 0
    buffer_load_dwordx4 v3, s[32:35], s96 offen lds
    s_add_u32 s96, s96, 65536
    s_cmp_eq_u32 s96, 1441792
    s_cselect_b32 s96, 0, s96
    s_waitcnt vmcnt(0)
    s_barrier
    s_add_u32 m0, s60, 0
    s_nop 0
    buffer_load_dwordx4 v2, s[32:35], s96 offen lds
    s_add_u32 m0, s60, 1024
    s_nop 0
    buffer_load_dwordx4 v3, s[32:35], s96 offen lds
    s_add_u32 s96, s96, 65536
    s_cmp_eq_u32 s96, 1441792
    s_cselect_b32 s96, 0, s96
    s_add_u32 m0, s60, 2048
    s_nop 0
    buffer_load_dwordx4 v2, s[32:35], s96 offen lds
    s_add_u32 m0, s60, 3072
    s_nop 0
    buffer_load_dwordx4 v3, s[32:35], s96 offen lds
    s_add_u32 s96, s96, 65536
    s_cmp_eq_u32 s96, 1441792
    s_cselect_b32 s96, 0, s96
    s_add_u32 m0, s60, 4096
    s_nop 0
    buffer_load_dwordx4 v2, s[32:35], s96 offen lds
    s_add_u32 m0, s60, 5120
    s_nop 0
    buffer_load_dwordx4 v3, s[32:35], s96 offen lds
    s_add_u32 s96, s96, 65536
    s_cmp_eq_u32 s96, 1441792
    s_cselect_b32 s96, 0, s96
    s_add_u32 m0, s60, 6144
    s_nop 0
    buffer_load_dwordx4 v2, s[32:35], s96 offen lds
    s_add_u32 m0, s60, 7168
    s_nop 0
    buffer_load_dwordx4 v3, s[32:35], s96 offen lds
    s_add_u32 s96, s96, 65536
    s_cmp_eq_u32 s96, 1441792
    s_cselect_b32 s96, 0, s96
    s_add_u32 m0, s60, 8192
    s_nop 0
    buffer_load_dwordx4 v2, s[32:35], s96 offen lds
    s_add_u32 m0, s60, 9216
    s_nop 0
    buffer_load_dwordx4 v3, s[32:35], s96 offen lds
    s_add_u32 s96, s96, 65536
    s_cmp_eq_u32 s96, 1441792
    s_cselect_b32 s96, 0, s96
    s_add_u32 m0, s60, 10240
    s_nop 0
    buffer_load_dwordx4 v2, s[32:35], s96 offen lds
    s_add_u32 m0, s60, 11264
    s_nop 0
    buffer_load_dwordx4 v3, s[32:35], s96 offen lds
    s_add_u32 s96, s96, 65536
    s_cmp_eq_u32 s96, 1441792
    s_cselect_b32 s96, 0, s96
    s_barrier
    s_add_u32 s24, s22, 8388608
    s_addc_u32 s25, s23, 0
    s_and_b32 s25, s25, 0xffff
    s_mov_b32 s26, 1048576
    s_mov_b32 s27, 0x20000
    s_add_u32 s28, s22, 6291456
    s_addc_u32 s29, s23, 0
    s_and_b32 s29, s29, 0xffff
    s_mov_b32 s30, 2097152
    s_mov_b32 s31, 0x20000
    s_mov_b32 s82, 1069066811
    s_waitcnt vmcnt(0)
    s_mov_b64 exec, 1
    ds_add_u32 v5, v6 offset:16
    s_mov_b64 exec, -1
    v_mov_b32 v120, 1069066811
    s_lshl_b32 s80, s92, 2
    s_add_u32 s80, s80, s74
    s_lshl_b32 s80, s80, 8
    s_lshr_b32 s78, s69, 4
    s_lshl_b32 s78, s78, 3
    s_add_u32 s80, s80, s78
    v_and_b32 v23, 1, v0
    v_lshlrev_b32 v23, 2, v23
    buffer_load_dword v22, v23, s[56:59], s80 offen offset:192 sc1
    v_and_b32 v16, 31, v0
    v_min_u32 v16, 16, v16
    v_and_b32 v17, 32, v0
    v_add_u32 v16, v16, v17
    v_lshlrev_b32 v24, 4, v16
    s_lshl_b32 s75, s74, 10
    v_mov_b32 v18, 163776
    v_mov_b32 v19, 1
    v_lshrrev_b32 v20, 5, v0
    v_bfe_u32 v21, v0, 2, 2
    v_lshl_add_u32 v25, v20, 2, v21
    v_lshlrev_b32 v25, 5, v25
    v_and_b32 v21, 3, v0
    v_lshl_add_u32 v25, v21, 3, v25
    v_add_u32 v25, 160256, v25
    ds_read_b64_tr_b16 v[40:41], v25 offset:0
    ds_read_b64_tr_b16 v[42:43], v25 offset:256
    v_bfe_u32 v21, v0, 4, 1
    v_mul_u32_u24 v26, 0x8000, v21
    v_lshl_or_b32 v26, v26, 16, v26
    s_lshl_b32 s78, s74, 9
    v_lshlrev_b32 v28, 3, v0
    v_add_u32 v28, 147712, v28
    v_add_u32 v27, s78, v28
    s_waitcnt vmcnt(0) lgkmcnt(0)
    v_xor_b32 v40, v40, v26
    v_xor_b32 v41, v41, v26
    v_xor_b32 v42, v42, v26
    v_xor_b32 v43, v43, v26
    s_mov_b32 s98, 0
k1_kv_lq_chk:
    s_waitcnt vmcnt(0)
    v_cmp_ne_u32 vcc, 1, v22
    s_cbranch_vccz k1_kv_lq_ok
    s_add_u32 s98, s98, 1
    s_cmp_gt_u32 s98, 0x8000
    s_cbranch_scc1 k1_kv_lq_ok
    s_sleep 4
    buffer_load_dword v22, v23, s[56:59], s80 offen offset:192 sc1
    s_branch k1_kv_lq_chk
k1_kv_lq_ok:
    s_add_u32 s78, s90, s89
    buffer_load_dwordx4 v[32:35], v4, s[28:31], s78 offen sc1
    s_add_u32 s78, s91, s89
    buffer_load_dwordx4 v[36:39], v4, s[28:31], s78 offen sc1
    v_and_b32 v23, 7, v0
    v_lshlrev_b32 v23, 17, v23
    v_lshrrev_b32 v16, 3, v0
    v_mov_b32 v17, s89
    v_lshl_add_u32 v23, v17, 2, v23
    s_waitcnt vmcnt(0)
    v_mfma_f32_32x32x16_bf16 v[64:79], v[40:43], v[32:35], 0
    v_mfma_f32_32x32x16_bf16 v[80:95], v[40:43], v[36:39], 0
    s_nop 10
    v_max3_f32 v112, v64, v65, v66
    v_max3_f32 v116, v80, v81, v82
    v_max3_f32 v113, v72, v73, v74
    v_max3_f32 v117, v88, v89, v90
    v_max3_f32 v114, v67, v68, v69
    v_max3_f32 v118, v83, v84, v85
    v_max3_f32 v115, v75, v76, v77
    v_max3_f32 v119, v91, v92, v93
    v_max3_f32 v112, v70, v71, v112
    v_max3_f32 v116, v86, v87, v116
    v_max3_f32 v113, v78, v79, v113
    v_max3_f32 v117, v94, v95, v117
    v_max_f32 v112, v112, v114
    v_max_f32 v116, v116, v118
    v_max_f32 v113, v113, v115
    v_max_f32 v117, v117, v119
    s_nop 0
    v_permlane32_swap_b32 v112, v113
    v_permlane32_swap_b32 v116, v117
    v_max_f32 v112, v112, v113
    v_max_f32 v116, v116, v117
    v_mul_f32 v112, v120, v112
    v_mul_f32 v116, v120, v116
    v_mov_b32 v113, v112
    v_mov_b32 v117, v116
    s_nop 0
    v_permlane32_swap_b32 v112, v113
    v_permlane32_swap_b32 v116, v117
    v_fma_f32 v64, v64, v120, -v112
    v_fma_f32 v80, v80, v120, -v116
    v_fma_f32 v65, v65, v120, -v112
    v_fma_f32 v81, v81, v120, -v116
    v_fma_f32 v66, v66, v120, -v112
    v_fma_f32 v82, v82, v120, -v116
    v_fma_f32 v67, v67, v120, -v112
    v_fma_f32 v83, v83, v120, -v116
    v_fma_f32 v68, v68, v120, -v112
    v_fma_f32 v84, v84, v120, -v116
    v_fma_f32 v69, v69, v120, -v112
    v_fma_f32 v85, v85, v120, -v116
    v_fma_f32 v70, v70, v120, -v112
    v_fma_f32 v86, v86, v120, -v116
    v_fma_f32 v71, v71, v120, -v112
    v_fma_f32 v87, v87, v120, -v116
    v_fma_f32 v72, v72, v120, -v113
    v_fma_f32 v88, v88, v120, -v117
    v_fma_f32 v73, v73, v120, -v113
    v_fma_f32 v89, v89, v120, -v117
    v_fma_f32 v74, v74, v120, -v113
    v_fma_f32 v90, v90, v120, -v117
    v_fma_f32 v75, v75, v120, -v113
    v_fma_f32 v91, v91, v120, -v117
    v_fma_f32 v76, v76, v120, -v113
    v_fma_f32 v92, v92, v120, -v117
    v_fma_f32 v77, v77, v120, -v113
    v_fma_f32 v93, v93, v120, -v117
    v_fma_f32 v78, v78, v120, -v113
    v_fma_f32 v94, v94, v120, -v117
    v_fma_f32 v79, v79, v120, -v113
    v_fma_f32 v95, v95, v120, -v117
    v_exp_f32 v64, v64
    v_exp_f32 v80, v80
    v_exp_f32 v65, v65
    v_exp_f32 v81, v81
    v_exp_f32 v66, v66
    v_exp_f32 v82, v82
    v_exp_f32 v67, v67
    v_exp_f32 v83, v83
    v_exp_f32 v68, v68
    v_exp_f32 v84, v84
    v_exp_f32 v69, v69
    v_exp_f32 v85, v85
    v_exp_f32 v70, v70
    v_exp_f32 v86, v86
    v_exp_f32 v71, v71
    v_exp_f32 v87, v87
    v_exp_f32 v72, v72
    v_exp_f32 v88, v88
    v_exp_f32 v73, v73
    v_exp_f32 v89, v89
    v_exp_f32 v74, v74
    v_exp_f32 v90, v90
    v_exp_f32 v75, v75
    v_exp_f32 v91, v91
    v_exp_f32 v76, v76
    v_exp_f32 v92, v92
    v_exp_f32 v77, v77
    v_exp_f32 v93, v93
    v_exp_f32 v78, v78
    v_exp_f32 v94, v94
    v_exp_f32 v79, v79
    v_exp_f32 v95, v95
    v_add_f32 v112, v64, v65
    v_add_f32 v116, v80, v81
    v_add_f32 v113, v72, v73
    v_add_f32 v117, v88, v89
    v_add_f32 v114, v66, v67
    v_add_f32 v118, v82, v83
    v_add_f32 v115, v74, v75
    v_add_f32 v119, v90, v91
    v_add_f32 v112, v112, v68
    v_add_f32 v116, v116, v84
    v_add_f32 v113, v113, v76
    v_add_f32 v117, v117, v92
    v_add_f32 v114, v114, v69
    v_add_f32 v118, v118, v85
    v_add_f32 v115, v115, v77
    v_add_f32 v119, v119, v93
    v_add_f32 v112, v112, v70
    v_add_f32 v116, v116, v86
    v_add_f32 v113, v113, v78
    v_add_f32 v117, v117, v94
    v_add_f32 v114, v114, v71
    v_add_f32 v118, v118, v87
    v_add_f32 v115, v115, v79
    v_add_f32 v119, v119, v95
    v_add_f32 v112, v112, v114
    v_add_f32 v116, v116, v118
    v_add_f32 v113, v113, v115
    v_add_f32 v117, v117, v119
    s_nop 0
    v_permlane32_swap_b32 v112, v113
    v_permlane32_swap_b32 v116, v117
    v_add_f32 v112, v112, v113
    v_add_f32 v116, v116, v117
    v_rcp_f32 v112, v112
    v_rcp_f32 v116, v116
    v_mov_b32 v113, v112
    v_mov_b32 v117, v116
    s_nop 0
    v_permlane32_swap_b32 v112, v113
    v_permlane32_swap_b32 v116, v117
    v_mul_f32 v64, v64, v112
    v_mul_f32 v80, v80, v116
    v_mul_f32 v65, v65, v112
    v_mul_f32 v81, v81, v116
    v_mul_f32 v66, v66, v112
    v_mul_f32 v82, v82, v116
    v_mul_f32 v67, v67, v112
    v_mul_f32 v83, v83, v116
    v_mul_f32 v68, v68, v112
    v_mul_f32 v84, v84, v116
    v_mul_f32 v69, v69, v112
    v_mul_f32 v85, v85, v116
    v_mul_f32 v70, v70, v112
    v_mul_f32 v86, v86, v116
    v_mul_f32 v71, v71, v112
    v_mul_f32 v87, v87, v116
    v_mul_f32 v72, v72, v113
    v_mul_f32 v88, v88, v117
    v_mul_f32 v73, v73, v113
    v_mul_f32 v89, v89, v117
    v_mul_f32 v74, v74, v113
    v_mul_f32 v90, v90, v117
    v_mul_f32 v75, v75, v113
    v_mul_f32 v91, v91, v117
    v_mul_f32 v76, v76, v113
    v_mul_f32 v92, v92, v117
    v_mul_f32 v77, v77, v113
    v_mul_f32 v93, v93, v117
    v_mul_f32 v78, v78, v113
    v_mul_f32 v94, v94, v117
    v_mul_f32 v79, v79, v113
    v_mul_f32 v95, v95, v117
    v_cvt_pk_bf16_f32 v96, v64, v65
    v_cvt_pk_bf16_f32 v104, v80, v81
    v_cvt_pk_bf16_f32 v97, v66, v67
    v_cvt_pk_bf16_f32 v105, v82, v83
    v_cvt_pk_bf16_f32 v98, v68, v69
    v_cvt_pk_bf16_f32 v106, v84, v85
    v_cvt_pk_bf16_f32 v99, v70, v71
    v_cvt_pk_bf16_f32 v107, v86, v87
    v_cvt_pk_bf16_f32 v100, v72, v73
    v_cvt_pk_bf16_f32 v108, v88, v89
    v_cvt_pk_bf16_f32 v101, v74, v75
    v_cvt_pk_bf16_f32 v109, v90, v91
    v_cvt_pk_bf16_f32 v102, v76, v77
    v_cvt_pk_bf16_f32 v110, v92, v93
    v_cvt_pk_bf16_f32 v103, v78, v79
    v_cvt_pk_bf16_f32 v111, v94, v95
    v_and_b32 v8, 31, v0
    v_min_u32 v8, 16, v8
    v_lshrrev_b32 v9, 5, v0
    v_mad_u32_u24 v8, v9, 17, v8
    v_lshlrev_b32 v8, 4, v8
    s_mul_i32 s78, s74, 2176
    s_add_u32 s78, s78, 53376
    v_add_u32 v8, s78, v8
    s_mov_b32 s98, 0
k1_kv_l_d_w:
    ds_read_b32 v12, v5 offset:8
    s_waitcnt lgkmcnt(0)
    v_readfirstlane_b32 s79, v12
    s_add_u32 s98, s98, 1
    s_cmp_gt_u32 s98, 0x100000
    s_cbranch_scc1 k1_kv_l_d_k
    s_sleep 1
    s_cmp_lt_u32 s79, 4
    s_cbranch_scc1 k1_kv_l_d_w
k1_kv_l_d_k:
    s_setprio 3
    ds_read_b128 v[32:35], v8 offset:0
    ds_read_b128 v[36:39], v8 offset:15360
    ds_read_b128 v[40:43], v8 offset:30720
    ds_read_b128 v[44:47], v8 offset:46080
    ds_read_b128 v[48:51], v8 offset:544
    ds_read_b128 v[52:55], v8 offset:15904
    ds_read_b128 v[56:59], v8 offset:31264
    ds_read_b128 v[60:63], v8 offset:46624
    ds_read_b128 v[64:67], v8 offset:1088
    ds_read_b128 v[68:71], v8 offset:16448
    ds_read_b128 v[72:75], v8 offset:31808
    ds_read_b128 v[76:79], v8 offset:47168
    ds_read_b128 v[80:83], v8 offset:1632
    ds_read_b128 v[84:87], v8 offset:16992
    ds_read_b128 v[88:91], v8 offset:32352
    ds_read_b128 v[92:95], v8 offset:47712
    s_waitcnt lgkmcnt(12)
    v_add_f32 v32, v32, v36
    v_add_f32 v40, v40, v44
    v_add_f32 v33, v33, v37
    v_add_f32 v41, v41, v45
    v_add_f32 v34, v34, v38
    v_add_f32 v42, v42, v46
    v_add_f32 v35, v35, v39
    v_add_f32 v43, v43, v47
    v_add_f32 v32, v32, v40
    v_add_f32 v33, v33, v41
    v_add_f32 v34, v34, v42
    v_add_f32 v35, v35, v43
    buffer_store_dwordx4 v[32:35], v4, s[40:43], s88 offen offset:0 sc1
    s_waitcnt lgkmcnt(8)
    v_add_f32 v48, v48, v52
    v_add_f32 v56, v56, v60
    v_add_f32 v49, v49, v53
    v_add_f32 v57, v57, v61
    v_add_f32 v50, v50, v54
    v_add_f32 v58, v58, v62
    v_add_f32 v51, v51, v55
    v_add_f32 v59, v59, v63
    v_add_f32 v48, v48, v56
    v_add_f32 v49, v49, v57
    v_add_f32 v50, v50, v58
    v_add_f32 v51, v51, v59
    buffer_store_dwordx4 v[48:51], v4, s[40:43], s88 offen offset:1024 sc1
    s_waitcnt lgkmcnt(4)
    v_add_f32 v64, v64, v68
    v_add_f32 v72, v72, v76
    v_add_f32 v65, v65, v69
    v_add_f32 v73, v73, v77
    v_add_f32 v66, v66, v70
    v_add_f32 v74, v74, v78
    v_add_f32 v67, v67, v71
    v_add_f32 v75, v75, v79
    v_add_f32 v64, v64, v72
    v_add_f32 v65, v65, v73
    v_add_f32 v66, v66, v74
    v_add_f32 v67, v67, v75
    buffer_store_dwordx4 v[64:67], v4, s[40:43], s88 offen offset:2048 sc1
    s_waitcnt lgkmcnt(0)
    v_add_f32 v80, v80, v84
    v_add_f32 v88, v88, v92
    v_add_f32 v81, v81, v85
    v_add_f32 v89, v89, v93
    v_add_f32 v82, v82, v86
    v_add_f32 v90, v90, v94
    v_add_f32 v83, v83, v87
    v_add_f32 v91, v91, v95
    v_add_f32 v80, v80, v88
    v_add_f32 v81, v81, v89
    v_add_f32 v82, v82, v90
    v_add_f32 v83, v83, v91
    buffer_store_dwordx4 v[80:83], v4, s[40:43], s88 offen offset:3072 sc1
    s_mov_b64 exec, 1
    ds_add_u32 v5, v6 offset:8
    s_mov_b64 exec, -1
    s_mov_b32 s98, 0
k1_kv_l_e_w:
    ds_read_b32 v12, v5 offset:8
    s_waitcnt lgkmcnt(0)
    v_readfirstlane_b32 s79, v12
    s_add_u32 s98, s98, 1
    s_cmp_gt_u32 s98, 0x100000
    s_cbranch_scc1 k1_kv_l_e_k
    s_cmp_lt_u32 s79, 8
    s_cbranch_scc1 k1_kv_l_e_w
k1_kv_l_e_k:
    s_add_u32 m0, s61, 0
    s_nop 0
    buffer_load_dwordx4 v2, s[32:35], s96 offen lds
    s_add_u32 m0, s61, 1024
    s_nop 0
    buffer_load_dwordx4 v3, s[32:35], s96 offen lds
    s_add_u32 s96, s96, 65536
    s_cmp_eq_u32 s96, 1441792
    s_cselect_b32 s96, 0, s96
    s_add_u32 m0, s61, 2048
    s_nop 0
    buffer_load_dwordx4 v2, s[32:35], s96 offen lds
    s_add_u32 m0, s61, 3072
    s_nop 0
    buffer_load_dwordx4 v3, s[32:35], s96 offen lds
    s_add_u32 s96, s96, 65536
    s_cmp_eq_u32 s96, 1441792
    s_cselect_b32 s96, 0, s96
    s_add_u32 m0, s61, 4096
    s_nop 0
    buffer_load_dwordx4 v2, s[32:35], s96 offen lds
    s_add_u32 m0, s61, 5120
    s_nop 0
    buffer_load_dwordx4 v3, s[32:35], s96 offen lds
    s_add_u32 s96, s96, 65536
    s_cmp_eq_u32 s96, 1441792
    s_cselect_b32 s96, 0, s96
    s_add_u32 m0, s61, 6144
    s_nop 0
    buffer_load_dwordx4 v2, s[32:35], s96 offen lds
    s_add_u32 m0, s61, 7168
    s_nop 0
    buffer_load_dwordx4 v3, s[32:35], s96 offen lds
    s_add_u32 s96, s96, 65536
    s_cmp_eq_u32 s96, 1441792
    s_cselect_b32 s96, 0, s96
    s_add_u32 m0, s61, 8192
    s_nop 0
    buffer_load_dwordx4 v2, s[32:35], s96 offen lds
    s_add_u32 m0, s61, 9216
    s_nop 0
    buffer_load_dwordx4 v3, s[32:35], s96 offen lds
    s_add_u32 s96, s96, 65536
    s_cmp_eq_u32 s96, 1441792
    s_cselect_b32 s96, 0, s96
    buffer_load_dword v22, v23, s[24:27], s75 offen sc1
    s_waitcnt vmcnt(0)
    s_mov_b64 exec, 1
    ds_add_u32 v18, v19 offset:12
    s_mov_b64 exec, -1
    s_setprio 3
    s_mov_b32 s98, 0
k1_kv_lp_chk:
    s_waitcnt vmcnt(0)
    v_cmp_eq_u32 vcc, -1, v22
    s_nop 0
    s_and_b32 s78, vcc_lo, 255
    s_bcnt1_i32_b32 s78, s78
    s_cmp_le_u32 s78, 2
    s_cbranch_scc1 k1_kv_lp_ok
    s_add_u32 s98, s98, 1
    s_cmp_gt_u32 s98, 0x8000
    s_cbranch_scc1 k1_kv_lp_ok
    s_sleep 6
    buffer_load_dword v22, v23, s[24:27], s75 offen sc1
    s_branch k1_kv_lp_chk
k1_kv_lp_ok:
    s_mov_b32 s98, 0
k1_kv_lk_ld:
    s_lshl_b32 s79, s89, 2
    s_add_u32 s79, s79, s75
    s_add_u32 s76, s79, 0
    buffer_load_dwordx4 v[32:35], v24, s[24:27], s76 offen sc1
    s_add_u32 s76, s79, 131072
    buffer_load_dwordx4 v[36:39], v24, s[24:27], s76 offen sc1
    s_add_u32 s76, s79, 262144
    buffer_load_dwordx4 v[40:43], v24, s[24:27], s76 offen sc1
    s_add_u32 s76, s79, 393216
    buffer_load_dwordx4 v[44:47], v24, s[24:27], s76 offen sc1
    s_add_u32 s76, s79, 524288
    buffer_load_dwordx4 v[48:51], v24, s[24:27], s76 offen sc1
    s_add_u32 s76, s79, 655360
    buffer_load_dwordx4 v[52:55], v24, s[24:27], s76 offen sc1
    s_add_u32 s76, s79, 786432
    buffer_load_dwordx4 v[56:59], v24, s[24:27], s76 offen sc1
    s_add_u32 s76, s79, 917504
    buffer_load_dwordx4 v[60:63], v24, s[24:27], s76 offen sc1
    s_waitcnt vmcnt(0)
    v_max3_u32 v20, v32, v33, v34
    v_max3_u32 v21, v35, v36, v37
    v_max3_u32 v20, v38, v39, v20
    v_max_u32 v20, v20, v21
    v_max3_u32 v22, v40, v41, v42
    v_max3_u32 v21, v43, v44, v45
    v_max3_u32 v22, v46, v47, v22
    v_max_u32 v22, v22, v21
    v_max_u32 v20, v20, v22
    v_max3_u32 v22, v48, v49, v50
    v_max3_u32 v21, v51, v52, v53
    v_max3_u32 v22, v54, v55, v22
    v_max_u32 v22, v22, v21
    v_max_u32 v20, v20, v22
    v_max3_u32 v22, v56, v57, v58
    v_max3_u32 v21, v59, v60, v61
    v_max3_u32 v22, v62, v63, v22
    v_max_u32 v22, v22, v21
    v_max_u32 v20, v20, v22
    v_cmp_eq_u32 vcc, -1, v20
    s_cbranch_vccz k1_kv_lk_ok
    s_add_u32 s98, s98, 1
    s_cmp_gt_u32 s98, 0x8000
    s_cbranch_scc1 k1_kv_lk_ok
    s_sleep 2
    s_branch k1_kv_lk_ld
k1_kv_lk_ok:
    v_add_f32 v32, v32, v48
    v_add_f32 v33, v33, v49
    v_add_f32 v34, v34, v50
    v_add_f32 v35, v35, v51
    v_add_f32 v36, v36, v52
    v_add_f32 v37, v37, v53
    v_add_f32 v38, v38, v54
    v_add_f32 v39, v39, v55
    v_add_f32 v40, v40, v56
    v_add_f32 v41, v41, v57
    v_add_f32 v42, v42, v58
    v_add_f32 v43, v43, v59
    v_add_f32 v44, v44, v60
    v_add_f32 v45, v45, v61
    v_add_f32 v46, v46, v62
    v_add_f32 v47, v47, v63
    v_add_f32 v32, v32, v40
    v_add_f32 v33, v33, v41
    v_add_f32 v34, v34, v42
    v_add_f32 v35, v35, v43
    v_add_f32 v36, v36, v44
    v_add_f32 v37, v37, v45
    v_add_f32 v38, v38, v46
    v_add_f32 v39, v39, v47
    v_add_f32 v32, v32, v36
    v_add_f32 v33, v33, v37
    v_add_f32 v34, v34, v38
    v_add_f32 v35, v35, v39
    v_cvt_pk_bf16_f32 v36, v32, v33
    v_cvt_pk_bf16_f32 v37, v34, v35
    ds_write_b64 v27, v[36:37] offset:0
    s_waitcnt lgkmcnt(0)
    s_mov_b64 exec, 1
    ds_add_u32 v18, v19 offset:0
    s_mov_b64 exec, -1
    s_mov_b32 s98, 0
k1_kv_l_pc_w:
    ds_read_b32 v20, v18 offset:0
    s_waitcnt lgkmcnt(0)
    v_readfirstlane_b32 s79, v20
    s_add_u32 s98, s98, 1
    s_cmp_gt_u32 s98, 0x100000
    s_cbranch_scc1 k1_kv_l_pc_k
    s_cmp_lt_u32 s79, 4
    s_cbranch_scc1 k1_kv_l_pc_w
k1_kv_l_pc_k:
    ds_read_b64 v[32:33], v28 offset:0
    ds_read_b64 v[34:35], v28 offset:512
    ds_read_b64 v[36:37], v28 offset:1024
    ds_read_b64 v[38:39], v28 offset:1536
    s_waitcnt lgkmcnt(0)
    v_mfma_f32_32x32x16_bf16 v[48:63], v[32:35], v[96:99], 0
    v_mfma_f32_32x32x16_bf16 v[64:79], v[32:35], v[104:107], 0
    v_mfma_f32_32x32x16_bf16 v[48:63], v[36:39], v[100:103], v[48:63]
    v_mfma_f32_32x32x16_bf16 v[64:79], v[36:39], v[108:111], v[64:79]
    s_nop 10
    v_add_f32 v56, 0x358637bd, v56
    v_rcp_f32 v56, v56
    s_add_u32 s78, s90, s89
    v_mul_f32 v48, v48, v56
    v_mul_f32 v49, v49, v56
    v_mul_f32 v50, v50, v56
    v_mul_f32 v51, v51, v56
    v_mul_f32 v52, v52, v56
    v_mul_f32 v53, v53, v56
    v_mul_f32 v54, v54, v56
    v_mul_f32 v55, v55, v56
    v_cvt_pk_bf16_f32 v60, v48, v49
    v_cvt_pk_bf16_f32 v61, v50, v51
    v_cvt_pk_bf16_f32 v62, v52, v53
    v_cvt_pk_bf16_f32 v63, v54, v55
    buffer_store_dwordx4 v[60:63], v4, s[48:51], s78 offen sc1
    v_add_f32 v72, 0x358637bd, v72
    v_rcp_f32 v72, v72
    s_add_u32 s78, s91, s89
    v_mul_f32 v64, v64, v72
    v_mul_f32 v65, v65, v72
    v_mul_f32 v66, v66, v72
    v_mul_f32 v67, v67, v72
    v_mul_f32 v68, v68, v72
    v_mul_f32 v69, v69, v72
    v_mul_f32 v70, v70, v72
    v_mul_f32 v71, v71, v72
    v_cvt_pk_bf16_f32 v76, v64, v65
    v_cvt_pk_bf16_f32 v77, v66, v67
    v_cvt_pk_bf16_f32 v78, v68, v69
    v_cvt_pk_bf16_f32 v79, v70, v71
    buffer_store_dwordx4 v[76:79], v4, s[48:51], s78 offen sc1
    s_endpgm
k1_kv_c:
    s_and_b32 s74, s68, 1
    s_lshr_b32 s75, s68, 1
    s_mov_b32 s76, s68
    s_lshl_b32 s83, s68, 1
    s_add_u32 s84, s83, 1
    v_and_b32 v1, 31, v0
    v_lshrrev_b32 v240, 5, v0
    v_bfe_u32 v241, v0, 1, 3
    v_bfe_u32 v243, v0, 2, 2
    v_lshl_add_u32 v243, v240, 3, v243
    v_and_b32 v244, 3, v0
    v_lshlrev_b32 v244, 3, v244
    v_bfe_u32 v6, v0, 4, 1
    v_and_b32 v7, 2, v243
    v_or_b32 v6, v6, v7
    v_lshl_add_u32 v244, v243, 7, v244
    v_xor_b32 v7, 2, v6
    v_lshl_add_u32 v7, v7, 5, v244
    v_lshl_add_u32 v244, v6, 5, v244
    s_mov_b32 s80, 32768
    s_add_u32 s78, s76, 0
    s_and_b32 s78, s78, 3
    s_lshl_b32 s79, s78, 1
    v_add_u32 v242, s79, v240
    v_xor_b32 v242, v242, v241
    v_lshlrev_b32 v242, 4, v242
    v_lshl_add_u32 v242, v1, 7, v242
    s_lshl_b32 s79, s83, 12
    v_add_u32 v184, s79, v242
    s_mul_i32 s78, s78, 2048
    s_add_u32 s79, s78, s80
    v_add_u32 v188, s79, v244
    v_add_u32 v192, s79, v7
    s_add_u32 s78, s76, 1
    s_and_b32 s78, s78, 3
    s_lshl_b32 s79, s78, 1
    v_add_u32 v242, s79, v240
    v_xor_b32 v242, v242, v241
    v_lshlrev_b32 v242, 4, v242
    v_lshl_add_u32 v242, v1, 7, v242
    s_lshl_b32 s79, s83, 12
    v_add_u32 v185, s79, v242
    s_mul_i32 s78, s78, 2048
    s_add_u32 s79, s78, s80
    v_add_u32 v189, s79, v244
    v_add_u32 v193, s79, v7
    s_add_u32 s78, s76, 2
    s_and_b32 s78, s78, 3
    s_lshl_b32 s79, s78, 1
    v_add_u32 v242, s79, v240
    v_xor_b32 v242, v242, v241
    v_lshlrev_b32 v242, 4, v242
    v_lshl_add_u32 v242, v1, 7, v242
    s_lshl_b32 s79, s83, 12
    v_add_u32 v186, s79, v242
    s_mul_i32 s78, s78, 2048
    s_add_u32 s79, s78, s80
    v_add_u32 v190, s79, v244
    v_add_u32 v194, s79, v7
    s_add_u32 s78, s76, 3
    s_and_b32 s78, s78, 3
    s_lshl_b32 s79, s78, 1
    v_add_u32 v242, s79, v240
    v_xor_b32 v242, v242, v241
    v_lshlrev_b32 v242, 4, v242
    v_lshl_add_u32 v242, v1, 7, v242
    s_lshl_b32 s79, s83, 12
    v_add_u32 v187, s79, v242
    s_mul_i32 s78, s78, 2048
    s_add_u32 s79, s78, s80
    v_add_u32 v191, s79, v244
    v_add_u32 v195, s79, v7
    v_lshrrev_b32 v1, 4, v0
    v_xor_b32 v1, v1, v0
    v_and_b32 v1, 1, v1
    v_add_u32 v1, -1, v1
    v_and_b32 v204, 0x3f803f80, v1
    v_and_b32 v205, 0x3f803f80, v1
    v_and_b32 v206, 0x3f803f80, v1
    v_and_b32 v207, 0x3f803f80, v1
    v_mov_b32 v196, 0
    v_mov_b32 v197, 0
    v_mov_b32 v198, 0
    v_mov_b32 v199, 0
    v_mov_b32 v200, 0
    v_mov_b32 v201, 0
    v_mov_b32 v202, 0
    v_mov_b32 v203, 0
    v_mov_b32 v236, 0
    v_mov_b32 v237, 0
    v_mov_b32 v238, 0
    v_mov_b32 v239, 0
    s_mov_b32 s86, 0xffff0000
    s_mov_b32 s82, 1069066811
    s_waitcnt lgkmcnt(0)
    s_lshl_b32 s92, s70, 1
    s_add_u32 s92, s92, s71
    s_mov_b32 s64, s20
    s_and_b32 s65, s21, 0xffff
    s_mov_b32 s66, 256
    s_mov_b32 s67, 0x20000
    s_add_u32 s56, s22, 11534336
    s_addc_u32 s57, s23, 0
    s_and_b32 s57, s57, 0xffff
    s_mov_b32 s58, 81920
    s_mov_b32 s59, 0x20000
    s_and_b32 s93, s69, 3
    s_lshr_b32 s94, s69, 2
    s_mul_i32 s95, s94, 1
    s_mul_i32 s78, s93, 6
    s_add_u32 s95, s95, s78
    s_sub_u32 s78, s95, 22
    s_cmp_ge_u32 s95, 22
    s_cselect_b32 s95, s78, s95
    s_add_u32 s96, s95, 15
    s_sub_u32 s78, s96, 22
    s_cmp_ge_u32 s96, 22
    s_cselect_b32 s96, s78, s96
    s_lshl_b32 s95, s95, 12
    s_lshl_b32 s96, s96, 16
    s_lshl_b32 s78, s92, 2
    s_add_u32 s93, s93, s78
    s_mul_i32 s97, s68, 8192
    s_add_u32 s97, s97, 114944
    s_mul_i32 s60, s68, 12288
    s_add_u32 s60, s60, 0
    s_mul_i32 s61, s68, 10240
    s_add_u32 s61, s61, 53376
    s_lshl_b32 s78, s93, 16
    s_add_u32 s78, s78, 9437184
    s_add_u32 s48, s22, s78
    s_addc_u32 s49, s23, 0
    s_and_b32 s49, s49, 0xffff
    s_mov_b32 s50, 32768
    s_mov_b32 s51, 0x20000
    s_add_u32 s78, s78, 32768
    s_add_u32 s52, s22, s78
    s_addc_u32 s53, s23, 0
    s_and_b32 s53, s53, 0xffff
    s_mov_b32 s54, 32768
    s_mov_b32 s55, 0x20000
    v_and_b32 v240, 31, v0
    v_lshrrev_b32 v241, 5, v0
    v_bfe_u32 v242, v0, 2, 2
    v_and_b32 v243, 3, v0
    v_bfe_u32 v244, v0, 4, 1
    s_mul_i32 s78, s68, 15360
    s_add_u32 s78, s78, 53376
    v_mul_u32_u24 v232, 112, v240
    v_add_u32 v232, s78, v232
    v_lshl_add_u32 v232, v241, 4, v232
    v_and_b32 v6, 1, v243
    v_lshlrev_b32 v6, 4, v6
    v_lshrrev_b32 v7, 1, v243
    v_lshl_add_u32 v6, v7, 3, v6
    v_lshl_add_u32 v7, v241, 3, v242
    v_mul_u32_u24 v7, 112, v7
    v_add_u32 v7, s78, v7
    v_lshl_add_u32 v233, v244, 5, v7
    v_add_u32 v233, v233, v6
    v_add_u32 v6, 64, v6
    v_cmp_eq_u32 vcc, 0, v244
    v_mov_b32 v234, 96
    s_nop 0
    v_cndmask_b32 v234, v234, v6, vcc
    v_add_u32 v234, v234, v7
    v_lshl_add_u32 v235, v241, 2, v242
    v_lshlrev_b32 v235, 5, v235
    v_lshl_add_u32 v235, v243, 3, v235
    v_add_u32 v235, 147456, v235
    s_mul_i32 s78, s93, 176128
    s_add_u32 s24, s22, s78
    s_addc_u32 s25, s23, 0
    s_and_b32 s25, s25, 0xffff
    s_mov_b32 s26, 88064
    s_mov_b32 s27, 0x20000
    s_add_u32 s78, s78, 88064
    s_add_u32 s28, s22, s78
    s_addc_u32 s29, s23, 0
    s_and_b32 s29, s29, 0xffff
    s_mov_b32 s30, 88064
    s_mov_b32 s31, 0x20000
    s_mov_b32 s32, s16
    s_and_b32 s33, s17, 0xffff
    s_mov_b32 s34, 1409024
    s_mov_b32 s35, 0x20000
    s_mov_b32 s36, s10
    s_and_b32 s37, s11, 0xffff
    s_mov_b32 s38, 524288
    s_mov_b32 s39, 0x20000
    s_barrier
    ds_read_b128 v[136:139], v184 offset:0
    ds_read_b64_tr_b16 v[144:145], v188 offset:0
    ds_read_b64_tr_b16 v[146:147], v188 offset:512
    ds_read_b128 v[140:143], v184 offset:4096
    ds_read_b64_tr_b16 v[148:149], v192 offset:0
    ds_read_b64_tr_b16 v[150:151], v192 offset:512
    ds_read_b64_tr_b16 v[152:153], v188 offset:8192
    ds_read_b64_tr_b16 v[154:155], v188 offset:8704
    ds_read_b64_tr_b16 v[156:157], v192 offset:8192
    ds_read_b64_tr_b16 v[158:159], v192 offset:8704
    s_waitcnt lgkmcnt(0)
    v_mfma_f32_32x32x16_bf16 v[8:23], v[144:147], v[136:139], 0
    ds_read_b128 v[160:163], v185 offset:0
    v_lshlrev_b32 v2, 16, v152
    ds_read_b64_tr_b16 v[168:169], v189 offset:0
    v_and_b32 v3, s86, v152
    v_mfma_f32_32x32x16_bf16 v[72:87], v[144:147], v[140:143], 0
    ds_read_b64_tr_b16 v[170:171], v189 offset:512
    v_lshlrev_b32 v6, 16, v156
    ds_read_b128 v[164:167], v185 offset:4096
    v_and_b32 v7, s86, v156
    v_mfma_f32_16x16x32_bf16 v[196:199], v[144:147], v[204:207], v[196:199]
    ds_read_b64_tr_b16 v[172:173], v193 offset:0
    v_add_f32 v236, v236, v2
    ds_read_b64_tr_b16 v[174:175], v193 offset:512
    v_mfma_f32_32x32x16_bf16 v[24:39], v[148:151], v[136:139], 0
    v_add_f32 v237, v237, v3
    ds_read_b64_tr_b16 v[176:177], v189 offset:8192
    v_add_f32 v238, v238, v6
    ds_read_b64_tr_b16 v[178:179], v189 offset:8704
    v_mfma_f32_16x16x32_bf16 v[200:203], v[148:151], v[204:207], v[200:203]
    v_add_f32 v239, v239, v7
    ds_read_b64_tr_b16 v[180:181], v193 offset:8192
    ds_read_b64_tr_b16 v[182:183], v193 offset:8704
    v_mfma_f32_32x32x16_bf16 v[88:103], v[148:151], v[140:143], 0
    v_lshlrev_b32 v2, 16, v153
    v_and_b32 v3, s86, v153
    v_lshlrev_b32 v6, 16, v157
    v_and_b32 v7, s86, v157
    v_add_f32 v236, v236, v2
    v_mfma_f32_32x32x16_bf16 v[40:55], v[152:155], v[136:139], 0
    v_add_f32 v237, v237, v3
    v_add_f32 v238, v238, v6
    v_add_f32 v239, v239, v7
    v_lshlrev_b32 v2, 16, v154
    v_and_b32 v3, s86, v154
    v_mfma_f32_32x32x16_bf16 v[104:119], v[152:155], v[140:143], 0
    v_lshlrev_b32 v6, 16, v158
    v_and_b32 v7, s86, v158
    v_add_f32 v236, v236, v2
    v_add_f32 v237, v237, v3
    v_add_f32 v238, v238, v6
    v_mfma_f32_32x32x16_bf16 v[56:71], v[156:159], v[136:139], 0
    v_add_f32 v239, v239, v7
    v_lshlrev_b32 v2, 16, v155
    v_and_b32 v3, s86, v155
    v_lshlrev_b32 v6, 16, v159
    v_and_b32 v7, s86, v159
    v_mfma_f32_32x32x16_bf16 v[120:135], v[156:159], v[140:143], 0
    v_add_f32 v236, v236, v2
    v_add_f32 v237, v237, v3
    v_add_f32 v238, v238, v6
    v_add_f32 v239, v239, v7
    s_waitcnt lgkmcnt(0)
    v_mfma_f32_32x32x16_bf16 v[8:23], v[168:171], v[160:163], v[8:23]
    ds_read_b128 v[136:139], v186 offset:0
    ds_read_b64_tr_b16 v[144:145], v190 offset:0
    ds_read_b64_tr_b16 v[146:147], v190 offset:512
    v_mfma_f32_32x32x16_bf16 v[72:87], v[168:171], v[164:167], v[72:87]
    ds_read_b128 v[140:143], v186 offset:4096
    ds_read_b64_tr_b16 v[148:149], v194 offset:0
    v_mfma_f32_32x32x16_bf16 v[24:39], v[172:175], v[160:163], v[24:39]
    ds_read_b64_tr_b16 v[150:151], v194 offset:512
    ds_read_b64_tr_b16 v[152:153], v190 offset:8192
    ds_read_b64_tr_b16 v[154:155], v190 offset:8704
    v_mfma_f32_32x32x16_bf16 v[88:103], v[172:175], v[164:167], v[88:103]
    ds_read_b64_tr_b16 v[156:157], v194 offset:8192
    ds_read_b64_tr_b16 v[158:159], v194 offset:8704
    v_mfma_f32_32x32x16_bf16 v[40:55], v[176:179], v[160:163], v[40:55]
    v_mfma_f32_32x32x16_bf16 v[104:119], v[176:179], v[164:167], v[104:119]
    v_mfma_f32_32x32x16_bf16 v[56:71], v[180:183], v[160:163], v[56:71]
    v_mfma_f32_32x32x16_bf16 v[120:135], v[180:183], v[164:167], v[120:135]
    s_waitcnt lgkmcnt(0)
    v_mfma_f32_32x32x16_bf16 v[8:23], v[144:147], v[136:139], v[8:23]
    ds_read_b128 v[160:163], v187 offset:0
    ds_read_b64_tr_b16 v[168:169], v191 offset:0
    ds_read_b64_tr_b16 v[170:171], v191 offset:512
    v_mfma_f32_32x32x16_bf16 v[72:87], v[144:147], v[140:143], v[72:87]
    ds_read_b128 v[164:167], v187 offset:4096
    ds_read_b64_tr_b16 v[172:173], v195 offset:0
    v_mfma_f32_32x32x16_bf16 v[24:39], v[148:151], v[136:139], v[24:39]
    ds_read_b64_tr_b16 v[174:175], v195 offset:512
    ds_read_b64_tr_b16 v[176:177], v191 offset:8192
    ds_read_b64_tr_b16 v[178:179], v191 offset:8704
    v_mfma_f32_32x32x16_bf16 v[88:103], v[148:151], v[140:143], v[88:103]
    ds_read_b64_tr_b16 v[180:181], v195 offset:8192
    ds_read_b64_tr_b16 v[182:183], v195 offset:8704
    v_mfma_f32_32x32x16_bf16 v[40:55], v[152:155], v[136:139], v[40:55]
    v_mfma_f32_32x32x16_bf16 v[104:119], v[152:155], v[140:143], v[104:119]
    v_mfma_f32_32x32x16_bf16 v[56:71], v[156:159], v[136:139], v[56:71]
    v_mfma_f32_32x32x16_bf16 v[120:135], v[156:159], v[140:143], v[120:135]
    s_waitcnt lgkmcnt(0)
    s_barrier
    v_mfma_f32_32x32x16_bf16 v[8:23], v[168:171], v[160:163], v[8:23]
    ds_read_b128 v[136:139], v184 offset:49152
    ds_read_b64_tr_b16 v[144:145], v188 offset:49152
    ds_read_b64_tr_b16 v[146:147], v188 offset:49664
    v_mfma_f32_32x32x16_bf16 v[72:87], v[168:171], v[164:167], v[72:87]
    ds_read_b128 v[140:143], v184 offset:53248
    ds_read_b64_tr_b16 v[148:149], v192 offset:49152
    v_mfma_f32_32x32x16_bf16 v[24:39], v[172:175], v[160:163], v[24:39]
    ds_read_b64_tr_b16 v[150:151], v192 offset:49664
    ds_read_b64_tr_b16 v[152:153], v188 offset:57344
    ds_read_b64_tr_b16 v[154:155], v188 offset:57856
    v_mfma_f32_32x32x16_bf16 v[88:103], v[172:175], v[164:167], v[88:103]
    ds_read_b64_tr_b16 v[156:157], v192 offset:57344
    ds_read_b64_tr_b16 v[158:159], v192 offset:57856
    v_mfma_f32_32x32x16_bf16 v[40:55], v[176:179], v[160:163], v[40:55]
    ds_read_b64_tr_b16 v[216:217], v235 offset:0
    ds_read_b64_tr_b16 v[218:219], v235 offset:256
    v_mfma_f32_32x32x16_bf16 v[104:119], v[176:179], v[164:167], v[104:119]
    ds_read_b64_tr_b16 v[220:221], v235 offset:512
    ds_read_b64_tr_b16 v[222:223], v235 offset:768
    v_mfma_f32_32x32x16_bf16 v[56:71], v[180:183], v[160:163], v[56:71]
    ds_read_b64_tr_b16 v[224:225], v235 offset:1024
    ds_read_b64_tr_b16 v[226:227], v235 offset:1280
    v_mfma_f32_32x32x16_bf16 v[120:135], v[180:183], v[164:167], v[120:135]
    ds_read_b64_tr_b16 v[228:229], v235 offset:1536
    ds_read_b64_tr_b16 v[230:231], v235 offset:1792
    s_waitcnt lgkmcnt(0)
    v_mfma_f32_32x32x16_bf16 v[8:23], v[144:147], v[136:139], v[8:23]
    ds_read_b128 v[160:163], v185 offset:49152
    v_lshlrev_b32 v2, 16, v152
    ds_read_b64_tr_b16 v[168:169], v189 offset:49152
    v_and_b32 v3, s86, v152
    v_mfma_f32_32x32x16_bf16 v[72:87], v[144:147], v[140:143], v[72:87]
    ds_read_b64_tr_b16 v[170:171], v189 offset:49664
    v_lshlrev_b32 v6, 16, v156
    ds_read_b128 v[164:167], v185 offset:53248
    v_and_b32 v7, s86, v156
    v_mfma_f32_16x16x32_bf16 v[196:199], v[144:147], v[204:207], v[196:199]
    ds_read_b64_tr_b16 v[172:173], v193 offset:49152
    v_add_f32 v236, v236, v2
    ds_read_b64_tr_b16 v[174:175], v193 offset:49664
    v_mfma_f32_32x32x16_bf16 v[24:39], v[148:151], v[136:139], v[24:39]
    v_add_f32 v237, v237, v3
    ds_read_b64_tr_b16 v[176:177], v189 offset:57344
    v_add_f32 v238, v238, v6
    ds_read_b64_tr_b16 v[178:179], v189 offset:57856
    v_mfma_f32_16x16x32_bf16 v[200:203], v[148:151], v[204:207], v[200:203]
    v_add_f32 v239, v239, v7
    ds_read_b64_tr_b16 v[180:181], v193 offset:57344
    ds_read_b64_tr_b16 v[182:183], v193 offset:57856
    v_mfma_f32_32x32x16_bf16 v[88:103], v[148:151], v[140:143], v[88:103]
    v_lshlrev_b32 v2, 16, v153
    v_and_b32 v3, s86, v153
    v_lshlrev_b32 v6, 16, v157
    v_and_b32 v7, s86, v157
    v_add_f32 v236, v236, v2
    v_mfma_f32_32x32x16_bf16 v[40:55], v[152:155], v[136:139], v[40:55]
    v_add_f32 v237, v237, v3
    v_add_f32 v238, v238, v6
    v_add_f32 v239, v239, v7
    v_lshlrev_b32 v2, 16, v154
    v_and_b32 v3, s86, v154
    v_mfma_f32_32x32x16_bf16 v[104:119], v[152:155], v[140:143], v[104:119]
    v_lshlrev_b32 v6, 16, v158
    v_and_b32 v7, s86, v158
    v_add_f32 v236, v236, v2
    v_add_f32 v237, v237, v3
    v_add_f32 v238, v238, v6
    v_mfma_f32_32x32x16_bf16 v[56:71], v[156:159], v[136:139], v[56:71]
    v_add_f32 v239, v239, v7
    v_lshlrev_b32 v2, 16, v155
    v_and_b32 v3, s86, v155
    v_lshlrev_b32 v6, 16, v159
    v_and_b32 v7, s86, v159
    v_mfma_f32_32x32x16_bf16 v[120:135], v[156:159], v[140:143], v[120:135]
    v_add_f32 v236, v236, v2
    v_add_f32 v237, v237, v3
    v_add_f32 v238, v238, v6
    v_add_f32 v239, v239, v7
    s_waitcnt lgkmcnt(0)
    v_mfma_f32_32x32x16_bf16 v[8:23], v[168:171], v[160:163], v[8:23]
    ds_read_b128 v[136:139], v186 offset:49152
    ds_read_b64_tr_b16 v[144:145], v190 offset:49152
    ds_read_b64_tr_b16 v[146:147], v190 offset:49664
    v_mfma_f32_32x32x16_bf16 v[72:87], v[168:171], v[164:167], v[72:87]
    ds_read_b128 v[140:143], v186 offset:53248
    ds_read_b64_tr_b16 v[148:149], v194 offset:49152
    v_mfma_f32_32x32x16_bf16 v[24:39], v[172:175], v[160:163], v[24:39]
    ds_read_b64_tr_b16 v[150:151], v194 offset:49664
    ds_read_b64_tr_b16 v[152:153], v190 offset:57344
    ds_read_b64_tr_b16 v[154:155], v190 offset:57856
    v_mfma_f32_32x32x16_bf16 v[88:103], v[172:175], v[164:167], v[88:103]
    ds_read_b64_tr_b16 v[156:157], v194 offset:57344
    ds_read_b64_tr_b16 v[158:159], v194 offset:57856
    v_mfma_f32_32x32x16_bf16 v[40:55], v[176:179], v[160:163], v[40:55]
    v_mfma_f32_32x32x16_bf16 v[104:119], v[176:179], v[164:167], v[104:119]
    v_mfma_f32_32x32x16_bf16 v[56:71], v[180:183], v[160:163], v[56:71]
    v_mfma_f32_32x32x16_bf16 v[120:135], v[180:183], v[164:167], v[120:135]
    s_waitcnt lgkmcnt(0)
    v_mfma_f32_32x32x16_bf16 v[8:23], v[144:147], v[136:139], v[8:23]
    ds_read_b128 v[160:163], v187 offset:49152
    ds_read_b64_tr_b16 v[168:169], v191 offset:49152
    ds_read_b64_tr_b16 v[170:171], v191 offset:49664
    v_mfma_f32_32x32x16_bf16 v[72:87], v[144:147], v[140:143], v[72:87]
    ds_read_b128 v[164:167], v187 offset:53248
    ds_read_b64_tr_b16 v[172:173], v195 offset:49152
    v_mfma_f32_32x32x16_bf16 v[24:39], v[148:151], v[136:139], v[24:39]
    ds_read_b64_tr_b16 v[174:175], v195 offset:49664
    ds_read_b64_tr_b16 v[176:177], v191 offset:57344
    ds_read_b64_tr_b16 v[178:179], v191 offset:57856
    v_mfma_f32_32x32x16_bf16 v[88:103], v[148:151], v[140:143], v[88:103]
    ds_read_b64_tr_b16 v[180:181], v195 offset:57344
    ds_read_b64_tr_b16 v[182:183], v195 offset:57856
    v_mfma_f32_32x32x16_bf16 v[40:55], v[152:155], v[136:139], v[40:55]
    v_add_u32 v184, 98304, v184
    v_add_u32 v185, 98304, v185
    v_add_u32 v186, 98304, v186
    v_mfma_f32_32x32x16_bf16 v[104:119], v[152:155], v[140:143], v[104:119]
    v_add_u32 v187, 98304, v187
    v_add_u32 v188, 98304, v188
    v_add_u32 v189, 98304, v189
    v_mfma_f32_32x32x16_bf16 v[56:71], v[156:159], v[136:139], v[56:71]
    v_add_u32 v190, 98304, v190
    v_add_u32 v191, 98304, v191
    v_add_u32 v192, 98304, v192
    v_mfma_f32_32x32x16_bf16 v[120:135], v[156:159], v[140:143], v[120:135]
    v_add_u32 v193, 98304, v193
    v_add_u32 v194, 98304, v194
    v_add_u32 v195, 98304, v195
    s_waitcnt lgkmcnt(0)
    s_barrier
    v_mfma_f32_32x32x16_bf16 v[8:23], v[168:171], v[160:163], v[8:23]
    ds_read_b128 v[136:139], v184 offset:0
    ds_read_b64_tr_b16 v[144:145], v188 offset:0
    ds_read_b64_tr_b16 v[146:147], v188 offset:512
    v_mfma_f32_32x32x16_bf16 v[72:87], v[168:171], v[164:167], v[72:87]
    ds_read_b128 v[140:143], v184 offset:4096
    ds_read_b64_tr_b16 v[148:149], v192 offset:0
    v_mfma_f32_32x32x16_bf16 v[24:39], v[172:175], v[160:163], v[24:39]
    ds_read_b64_tr_b16 v[150:151], v192 offset:512
    ds_read_b64_tr_b16 v[152:153], v188 offset:8192
    ds_read_b64_tr_b16 v[154:155], v188 offset:8704
    v_mfma_f32_32x32x16_bf16 v[88:103], v[172:175], v[164:167], v[88:103]
    ds_read_b64_tr_b16 v[156:157], v192 offset:8192
    ds_read_b64_tr_b16 v[158:159], v192 offset:8704
    v_mfma_f32_32x32x16_bf16 v[40:55], v[176:179], v[160:163], v[40:55]
    v_mfma_f32_32x32x16_bf16 v[104:119], v[176:179], v[164:167], v[104:119]
    v_mfma_f32_32x32x16_bf16 v[56:71], v[180:183], v[160:163], v[56:71]
    v_mfma_f32_32x32x16_bf16 v[120:135], v[180:183], v[164:167], v[120:135]
    s_waitcnt lgkmcnt(0)
    v_mfma_f32_32x32x16_bf16 v[8:23], v[144:147], v[136:139], v[8:23]
    ds_read_b128 v[160:163], v185 offset:0
    v_lshlrev_b32 v2, 16, v152
    ds_read_b64_tr_b16 v[168:169], v189 offset:0
    v_and_b32 v3, s86, v152
    v_mfma_f32_32x32x16_bf16 v[72:87], v[144:147], v[140:143], v[72:87]
    ds_read_b64_tr_b16 v[170:171], v189 offset:512
    v_lshlrev_b32 v6, 16, v156
    ds_read_b128 v[164:167], v185 offset:4096
    v_and_b32 v7, s86, v156
    v_mfma_f32_16x16x32_bf16 v[196:199], v[144:147], v[204:207], v[196:199]
    ds_read_b64_tr_b16 v[172:173], v193 offset:0
    v_add_f32 v236, v236, v2
    ds_read_b64_tr_b16 v[174:175], v193 offset:512
    v_mfma_f32_32x32x16_bf16 v[24:39], v[148:151], v[136:139], v[24:39]
    v_add_f32 v237, v237, v3
    ds_read_b64_tr_b16 v[176:177], v189 offset:8192
    v_add_f32 v238, v238, v6
    ds_read_b64_tr_b16 v[178:179], v189 offset:8704
    v_mfma_f32_16x16x32_bf16 v[200:203], v[148:151], v[204:207], v[200:203]
    v_add_f32 v239, v239, v7
    ds_read_b64_tr_b16 v[180:181], v193 offset:8192
    ds_read_b64_tr_b16 v[182:183], v193 offset:8704
    v_mfma_f32_32x32x16_bf16 v[88:103], v[148:151], v[140:143], v[88:103]
    v_lshlrev_b32 v2, 16, v153
    v_and_b32 v3, s86, v153
    v_lshlrev_b32 v6, 16, v157
    v_and_b32 v7, s86, v157
    v_add_f32 v236, v236, v2
    v_mfma_f32_32x32x16_bf16 v[40:55], v[152:155], v[136:139], v[40:55]
    v_add_f32 v237, v237, v3
    v_add_f32 v238, v238, v6
    v_add_f32 v239, v239, v7
    v_lshlrev_b32 v2, 16, v154
    v_and_b32 v3, s86, v154
    v_mfma_f32_32x32x16_bf16 v[104:119], v[152:155], v[140:143], v[104:119]
    v_lshlrev_b32 v6, 16, v158
    v_and_b32 v7, s86, v158
    v_add_f32 v236, v236, v2
    v_add_f32 v237, v237, v3
    v_add_f32 v238, v238, v6
    v_mfma_f32_32x32x16_bf16 v[56:71], v[156:159], v[136:139], v[56:71]
    v_add_f32 v239, v239, v7
    v_lshlrev_b32 v2, 16, v155
    v_and_b32 v3, s86, v155
    v_lshlrev_b32 v6, 16, v159
    v_and_b32 v7, s86, v159
    v_mfma_f32_32x32x16_bf16 v[120:135], v[156:159], v[140:143], v[120:135]
    v_add_f32 v236, v236, v2
    v_add_f32 v237, v237, v3
    v_add_f32 v238, v238, v6
    v_add_f32 v239, v239, v7
    s_waitcnt lgkmcnt(0)
    v_mfma_f32_32x32x16_bf16 v[8:23], v[168:171], v[160:163], v[8:23]
    ds_read_b128 v[136:139], v186 offset:0
    ds_read_b64_tr_b16 v[144:145], v190 offset:0
    ds_read_b64_tr_b16 v[146:147], v190 offset:512
    v_mfma_f32_32x32x16_bf16 v[72:87], v[168:171], v[164:167], v[72:87]
    ds_read_b128 v[140:143], v186 offset:4096
    ds_read_b64_tr_b16 v[148:149], v194 offset:0
    v_mfma_f32_32x32x16_bf16 v[24:39], v[172:175], v[160:163], v[24:39]
    ds_read_b64_tr_b16 v[150:151], v194 offset:512
    ds_read_b64_tr_b16 v[152:153], v190 offset:8192
    ds_read_b64_tr_b16 v[154:155], v190 offset:8704
    v_mfma_f32_32x32x16_bf16 v[88:103], v[172:175], v[164:167], v[88:103]
    ds_read_b64_tr_b16 v[156:157], v194 offset:8192
    ds_read_b64_tr_b16 v[158:159], v194 offset:8704
    v_mfma_f32_32x32x16_bf16 v[40:55], v[176:179], v[160:163], v[40:55]
    v_mfma_f32_32x32x16_bf16 v[104:119], v[176:179], v[164:167], v[104:119]
    v_mfma_f32_32x32x16_bf16 v[56:71], v[180:183], v[160:163], v[56:71]
    v_mfma_f32_32x32x16_bf16 v[120:135], v[180:183], v[164:167], v[120:135]
    s_waitcnt lgkmcnt(0)
    v_mfma_f32_32x32x16_bf16 v[8:23], v[144:147], v[136:139], v[8:23]
    ds_read_b128 v[160:163], v187 offset:0
    ds_read_b64_tr_b16 v[168:169], v191 offset:0
    ds_read_b64_tr_b16 v[170:171], v191 offset:512
    v_mfma_f32_32x32x16_bf16 v[72:87], v[144:147], v[140:143], v[72:87]
    ds_read_b128 v[164:167], v187 offset:4096
    ds_read_b64_tr_b16 v[172:173], v195 offset:0
    v_mfma_f32_32x32x16_bf16 v[24:39], v[148:151], v[136:139], v[24:39]
    ds_read_b64_tr_b16 v[174:175], v195 offset:512
    ds_read_b64_tr_b16 v[176:177], v191 offset:8192
    ds_read_b64_tr_b16 v[178:179], v191 offset:8704
    v_mfma_f32_32x32x16_bf16 v[88:103], v[148:151], v[140:143], v[88:103]
    ds_read_b64_tr_b16 v[180:181], v195 offset:8192
    ds_read_b64_tr_b16 v[182:183], v195 offset:8704
    v_mfma_f32_32x32x16_bf16 v[40:55], v[152:155], v[136:139], v[40:55]
    v_add_u32 v184, 4294868992, v184
    v_add_u32 v185, 4294868992, v185
    v_add_u32 v186, 4294868992, v186
    v_mfma_f32_32x32x16_bf16 v[104:119], v[152:155], v[140:143], v[104:119]
    v_add_u32 v187, 4294868992, v187
    v_add_u32 v188, 4294868992, v188
    v_add_u32 v189, 4294868992, v189
    v_mfma_f32_32x32x16_bf16 v[56:71], v[156:159], v[136:139], v[56:71]
    v_add_u32 v190, 4294868992, v190
    v_add_u32 v191, 4294868992, v191
    v_add_u32 v192, 4294868992, v192
    v_mfma_f32_32x32x16_bf16 v[120:135], v[156:159], v[140:143], v[120:135]
    v_add_u32 v193, 4294868992, v193
    v_add_u32 v194, 4294868992, v194
    v_add_u32 v195, 4294868992, v195
    s_waitcnt lgkmcnt(0)
    s_barrier
    v_mfma_f32_32x32x16_bf16 v[8:23], v[168:171], v[160:163], v[8:23]
    ds_read_b128 v[136:139], v184 offset:0
    ds_read_b64_tr_b16 v[144:145], v188 offset:0
    ds_read_b64_tr_b16 v[146:147], v188 offset:512
    v_mfma_f32_32x32x16_bf16 v[72:87], v[168:171], v[164:167], v[72:87]
    ds_read_b128 v[140:143], v184 offset:4096
    ds_read_b64_tr_b16 v[148:149], v192 offset:0
    v_mfma_f32_32x32x16_bf16 v[24:39], v[172:175], v[160:163], v[24:39]
    ds_read_b64_tr_b16 v[150:151], v192 offset:512
    ds_read_b64_tr_b16 v[152:153], v188 offset:8192
    ds_read_b64_tr_b16 v[154:155], v188 offset:8704
    v_mfma_f32_32x32x16_bf16 v[88:103], v[172:175], v[164:167], v[88:103]
    ds_read_b64_tr_b16 v[156:157], v192 offset:8192
    ds_read_b64_tr_b16 v[158:159], v192 offset:8704
    v_mfma_f32_32x32x16_bf16 v[40:55], v[176:179], v[160:163], v[40:55]
    v_mfma_f32_32x32x16_bf16 v[104:119], v[176:179], v[164:167], v[104:119]
    v_mfma_f32_32x32x16_bf16 v[56:71], v[180:183], v[160:163], v[56:71]
    v_mfma_f32_32x32x16_bf16 v[120:135], v[180:183], v[164:167], v[120:135]
    s_waitcnt lgkmcnt(0)
    v_mfma_f32_32x32x16_bf16 v[8:23], v[144:147], v[136:139], v[8:23]
    ds_read_b128 v[160:163], v185 offset:0
    v_lshlrev_b32 v2, 16, v152
    ds_read_b64_tr_b16 v[168:169], v189 offset:0
    v_and_b32 v3, s86, v152
    v_mfma_f32_32x32x16_bf16 v[72:87], v[144:147], v[140:143], v[72:87]
    ds_read_b64_tr_b16 v[170:171], v189 offset:512
    v_lshlrev_b32 v6, 16, v156
    ds_read_b128 v[164:167], v185 offset:4096
    v_and_b32 v7, s86, v156
    v_mfma_f32_16x16x32_bf16 v[196:199], v[144:147], v[204:207], v[196:199]
    ds_read_b64_tr_b16 v[172:173], v193 offset:0
    v_add_f32 v236, v236, v2
    ds_read_b64_tr_b16 v[174:175], v193 offset:512
    v_mfma_f32_32x32x16_bf16 v[24:39], v[148:151], v[136:139], v[24:39]
    v_add_f32 v237, v237, v3
    ds_read_b64_tr_b16 v[176:177], v189 offset:8192
    v_add_f32 v238, v238, v6
    ds_read_b64_tr_b16 v[178:179], v189 offset:8704
    v_mfma_f32_16x16x32_bf16 v[200:203], v[148:151], v[204:207], v[200:203]
    v_add_f32 v239, v239, v7
    ds_read_b64_tr_b16 v[180:181], v193 offset:8192
    ds_read_b64_tr_b16 v[182:183], v193 offset:8704
    v_mfma_f32_32x32x16_bf16 v[88:103], v[148:151], v[140:143], v[88:103]
    v_lshlrev_b32 v2, 16, v153
    v_and_b32 v3, s86, v153
    v_lshlrev_b32 v6, 16, v157
    v_and_b32 v7, s86, v157
    v_add_f32 v236, v236, v2
    v_mfma_f32_32x32x16_bf16 v[40:55], v[152:155], v[136:139], v[40:55]
    v_add_f32 v237, v237, v3
    v_add_f32 v238, v238, v6
    v_add_f32 v239, v239, v7
    v_lshlrev_b32 v2, 16, v154
    v_and_b32 v3, s86, v154
    v_mfma_f32_32x32x16_bf16 v[104:119], v[152:155], v[140:143], v[104:119]
    v_lshlrev_b32 v6, 16, v158
    v_and_b32 v7, s86, v158
    v_add_f32 v236, v236, v2
    v_add_f32 v237, v237, v3
    v_add_f32 v238, v238, v6
    v_mfma_f32_32x32x16_bf16 v[56:71], v[156:159], v[136:139], v[56:71]
    v_add_f32 v239, v239, v7
    v_lshlrev_b32 v2, 16, v155
    v_and_b32 v3, s86, v155
    v_lshlrev_b32 v6, 16, v159
    v_and_b32 v7, s86, v159
    v_mfma_f32_32x32x16_bf16 v[120:135], v[156:159], v[140:143], v[120:135]
    v_add_f32 v236, v236, v2
    v_add_f32 v237, v237, v3
    v_add_f32 v238, v238, v6
    v_add_f32 v239, v239, v7
    s_waitcnt lgkmcnt(0)
    v_mfma_f32_32x32x16_bf16 v[8:23], v[168:171], v[160:163], v[8:23]
    ds_read_b128 v[136:139], v186 offset:0
    ds_read_b64_tr_b16 v[144:145], v190 offset:0
    ds_read_b64_tr_b16 v[146:147], v190 offset:512
    v_mfma_f32_32x32x16_bf16 v[72:87], v[168:171], v[164:167], v[72:87]
    ds_read_b128 v[140:143], v186 offset:4096
    ds_read_b64_tr_b16 v[148:149], v194 offset:0
    v_mfma_f32_32x32x16_bf16 v[24:39], v[172:175], v[160:163], v[24:39]
    ds_read_b64_tr_b16 v[150:151], v194 offset:512
    ds_read_b64_tr_b16 v[152:153], v190 offset:8192
    ds_read_b64_tr_b16 v[154:155], v190 offset:8704
    v_mfma_f32_32x32x16_bf16 v[88:103], v[172:175], v[164:167], v[88:103]
    ds_read_b64_tr_b16 v[156:157], v194 offset:8192
    ds_read_b64_tr_b16 v[158:159], v194 offset:8704
    v_mfma_f32_32x32x16_bf16 v[40:55], v[176:179], v[160:163], v[40:55]
    v_mfma_f32_32x32x16_bf16 v[104:119], v[176:179], v[164:167], v[104:119]
    v_mfma_f32_32x32x16_bf16 v[56:71], v[180:183], v[160:163], v[56:71]
    v_mfma_f32_32x32x16_bf16 v[120:135], v[180:183], v[164:167], v[120:135]
    s_waitcnt lgkmcnt(0)
    v_mfma_f32_32x32x16_bf16 v[8:23], v[144:147], v[136:139], v[8:23]
    ds_read_b128 v[160:163], v187 offset:0
    ds_read_b64_tr_b16 v[168:169], v191 offset:0
    ds_read_b64_tr_b16 v[170:171], v191 offset:512
    v_mfma_f32_32x32x16_bf16 v[72:87], v[144:147], v[140:143], v[72:87]
    ds_read_b128 v[164:167], v187 offset:4096
    ds_read_b64_tr_b16 v[172:173], v195 offset:0
    v_mfma_f32_32x32x16_bf16 v[24:39], v[148:151], v[136:139], v[24:39]
    ds_read_b64_tr_b16 v[174:175], v195 offset:512
    ds_read_b64_tr_b16 v[176:177], v191 offset:8192
    ds_read_b64_tr_b16 v[178:179], v191 offset:8704
    v_mfma_f32_32x32x16_bf16 v[88:103], v[148:151], v[140:143], v[88:103]
    ds_read_b64_tr_b16 v[180:181], v195 offset:8192
    ds_read_b64_tr_b16 v[182:183], v195 offset:8704
    v_mfma_f32_32x32x16_bf16 v[40:55], v[152:155], v[136:139], v[40:55]
    v_mfma_f32_32x32x16_bf16 v[104:119], v[152:155], v[140:143], v[104:119]
    v_mfma_f32_32x32x16_bf16 v[56:71], v[156:159], v[136:139], v[56:71]
    v_mfma_f32_32x32x16_bf16 v[120:135], v[156:159], v[140:143], v[120:135]
    s_waitcnt lgkmcnt(0)
    s_barrier
    v_mfma_f32_32x32x16_bf16 v[8:23], v[168:171], v[160:163], v[8:23]
    ds_read_b128 v[136:139], v184 offset:49152
    ds_read_b64_tr_b16 v[144:145], v188 offset:49152
    ds_read_b64_tr_b16 v[146:147], v188 offset:49664
    v_mfma_f32_32x32x16_bf16 v[72:87], v[168:171], v[164:167], v[72:87]
    ds_read_b128 v[140:143], v184 offset:53248
    ds_read_b64_tr_b16 v[148:149], v192 offset:49152
    v_mfma_f32_32x32x16_bf16 v[24:39], v[172:175], v[160:163], v[24:39]
    ds_read_b64_tr_b16 v[150:151], v192 offset:49664
    ds_read_b64_tr_b16 v[152:153], v188 offset:57344
    ds_read_b64_tr_b16 v[154:155], v188 offset:57856
    v_mfma_f32_32x32x16_bf16 v[88:103], v[172:175], v[164:167], v[88:103]
    ds_read_b64_tr_b16 v[156:157], v192 offset:57344
    ds_read_b64_tr_b16 v[158:159], v192 offset:57856
    v_mfma_f32_32x32x16_bf16 v[40:55], v[176:179], v[160:163], v[40:55]
    v_mfma_f32_32x32x16_bf16 v[104:119], v[176:179], v[164:167], v[104:119]
    v_mfma_f32_32x32x16_bf16 v[56:71], v[180:183], v[160:163], v[56:71]
    v_mfma_f32_32x32x16_bf16 v[120:135], v[180:183], v[164:167], v[120:135]
    s_waitcnt lgkmcnt(0)
    v_mfma_f32_32x32x16_bf16 v[8:23], v[144:147], v[136:139], v[8:23]
    ds_read_b128 v[160:163], v185 offset:49152
    v_lshlrev_b32 v2, 16, v152
    ds_read_b64_tr_b16 v[168:169], v189 offset:49152
    v_and_b32 v3, s86, v152
    v_mfma_f32_32x32x16_bf16 v[72:87], v[144:147], v[140:143], v[72:87]
    ds_read_b64_tr_b16 v[170:171], v189 offset:49664
    v_lshlrev_b32 v6, 16, v156
    ds_read_b128 v[164:167], v185 offset:53248
    v_and_b32 v7, s86, v156
    v_mfma_f32_16x16x32_bf16 v[196:199], v[144:147], v[204:207], v[196:199]
    ds_read_b64_tr_b16 v[172:173], v193 offset:49152
    v_add_f32 v236, v236, v2
    ds_read_b64_tr_b16 v[174:175], v193 offset:49664
    v_mfma_f32_32x32x16_bf16 v[24:39], v[148:151], v[136:139], v[24:39]
    v_add_f32 v237, v237, v3
    ds_read_b64_tr_b16 v[176:177], v189 offset:57344
    v_add_f32 v238, v238, v6
    ds_read_b64_tr_b16 v[178:179], v189 offset:57856
    v_mfma_f32_16x16x32_bf16 v[200:203], v[148:151], v[204:207], v[200:203]
    v_add_f32 v239, v239, v7
    ds_read_b64_tr_b16 v[180:181], v193 offset:57344
    ds_read_b64_tr_b16 v[182:183], v193 offset:57856
    v_mfma_f32_32x32x16_bf16 v[88:103], v[148:151], v[140:143], v[88:103]
    v_lshlrev_b32 v2, 16, v153
    v_and_b32 v3, s86, v153
    v_lshlrev_b32 v6, 16, v157
    v_and_b32 v7, s86, v157
    v_add_f32 v236, v236, v2
    v_mfma_f32_32x32x16_bf16 v[40:55], v[152:155], v[136:139], v[40:55]
    v_add_f32 v237, v237, v3
    v_add_f32 v238, v238, v6
    v_add_f32 v239, v239, v7
    v_lshlrev_b32 v2, 16, v154
    v_and_b32 v3, s86, v154
    v_mfma_f32_32x32x16_bf16 v[104:119], v[152:155], v[140:143], v[104:119]
    v_lshlrev_b32 v6, 16, v158
    v_and_b32 v7, s86, v158
    v_add_f32 v236, v236, v2
    v_add_f32 v237, v237, v3
    v_add_f32 v238, v238, v6
    v_mfma_f32_32x32x16_bf16 v[56:71], v[156:159], v[136:139], v[56:71]
    v_add_f32 v239, v239, v7
    v_lshlrev_b32 v2, 16, v155
    v_and_b32 v3, s86, v155
    v_lshlrev_b32 v6, 16, v159
    v_and_b32 v7, s86, v159
    v_mfma_f32_32x32x16_bf16 v[120:135], v[156:159], v[140:143], v[120:135]
    v_add_f32 v236, v236, v2
    v_add_f32 v237, v237, v3
    v_add_f32 v238, v238, v6
    v_add_f32 v239, v239, v7
    s_waitcnt lgkmcnt(0)
    v_mfma_f32_32x32x16_bf16 v[8:23], v[168:171], v[160:163], v[8:23]
    ds_read_b128 v[136:139], v186 offset:49152
    ds_read_b64_tr_b16 v[144:145], v190 offset:49152
    ds_read_b64_tr_b16 v[146:147], v190 offset:49664
    v_mfma_f32_32x32x16_bf16 v[72:87], v[168:171], v[164:167], v[72:87]
    ds_read_b128 v[140:143], v186 offset:53248
    ds_read_b64_tr_b16 v[148:149], v194 offset:49152
    v_mfma_f32_32x32x16_bf16 v[24:39], v[172:175], v[160:163], v[24:39]
    ds_read_b64_tr_b16 v[150:151], v194 offset:49664
    ds_read_b64_tr_b16 v[152:153], v190 offset:57344
    ds_read_b64_tr_b16 v[154:155], v190 offset:57856
    v_mfma_f32_32x32x16_bf16 v[88:103], v[172:175], v[164:167], v[88:103]
    ds_read_b64_tr_b16 v[156:157], v194 offset:57344
    ds_read_b64_tr_b16 v[158:159], v194 offset:57856
    v_mfma_f32_32x32x16_bf16 v[40:55], v[176:179], v[160:163], v[40:55]
    v_mfma_f32_32x32x16_bf16 v[104:119], v[176:179], v[164:167], v[104:119]
    v_mfma_f32_32x32x16_bf16 v[56:71], v[180:183], v[160:163], v[56:71]
    v_mfma_f32_32x32x16_bf16 v[120:135], v[180:183], v[164:167], v[120:135]
    s_waitcnt lgkmcnt(0)
    v_mfma_f32_32x32x16_bf16 v[8:23], v[144:147], v[136:139], v[8:23]
    ds_read_b128 v[160:163], v187 offset:49152
    ds_read_b64_tr_b16 v[168:169], v191 offset:49152
    ds_read_b64_tr_b16 v[170:171], v191 offset:49664
    v_mfma_f32_32x32x16_bf16 v[72:87], v[144:147], v[140:143], v[72:87]
    ds_read_b128 v[164:167], v187 offset:53248
    ds_read_b64_tr_b16 v[172:173], v195 offset:49152
    v_mfma_f32_32x32x16_bf16 v[24:39], v[148:151], v[136:139], v[24:39]
    ds_read_b64_tr_b16 v[174:175], v195 offset:49664
    ds_read_b64_tr_b16 v[176:177], v191 offset:57344
    ds_read_b64_tr_b16 v[178:179], v191 offset:57856
    v_mfma_f32_32x32x16_bf16 v[88:103], v[148:151], v[140:143], v[88:103]
    ds_read_b64_tr_b16 v[180:181], v195 offset:57344
    ds_read_b64_tr_b16 v[182:183], v195 offset:57856
    v_mfma_f32_32x32x16_bf16 v[40:55], v[152:155], v[136:139], v[40:55]
    v_add_u32 v184, 98304, v184
    v_add_u32 v185, 98304, v185
    v_add_u32 v186, 98304, v186
    v_mfma_f32_32x32x16_bf16 v[104:119], v[152:155], v[140:143], v[104:119]
    v_add_u32 v187, 98304, v187
    v_add_u32 v188, 98304, v188
    v_add_u32 v189, 98304, v189
    v_mfma_f32_32x32x16_bf16 v[56:71], v[156:159], v[136:139], v[56:71]
    v_add_u32 v190, 98304, v190
    v_add_u32 v191, 98304, v191
    v_add_u32 v192, 98304, v192
    v_mfma_f32_32x32x16_bf16 v[120:135], v[156:159], v[140:143], v[120:135]
    v_add_u32 v193, 98304, v193
    v_add_u32 v194, 98304, v194
    v_add_u32 v195, 98304, v195
    s_waitcnt lgkmcnt(0)
    s_barrier
    v_mfma_f32_32x32x16_bf16 v[8:23], v[168:171], v[160:163], v[8:23]
    ds_read_b128 v[136:139], v184 offset:0
    ds_read_b64_tr_b16 v[144:145], v188 offset:0
    ds_read_b64_tr_b16 v[146:147], v188 offset:512
    v_mfma_f32_32x32x16_bf16 v[72:87], v[168:171], v[164:167], v[72:87]
    ds_read_b128 v[140:143], v184 offset:4096
    ds_read_b64_tr_b16 v[148:149], v192 offset:0
    v_mfma_f32_32x32x16_bf16 v[24:39], v[172:175], v[160:163], v[24:39]
    ds_read_b64_tr_b16 v[150:151], v192 offset:512
    ds_read_b64_tr_b16 v[152:153], v188 offset:8192
    ds_read_b64_tr_b16 v[154:155], v188 offset:8704
    v_mfma_f32_32x32x16_bf16 v[88:103], v[172:175], v[164:167], v[88:103]
    ds_read_b64_tr_b16 v[156:157], v192 offset:8192
    ds_read_b64_tr_b16 v[158:159], v192 offset:8704
    v_mfma_f32_32x32x16_bf16 v[40:55], v[176:179], v[160:163], v[40:55]
    v_mfma_f32_32x32x16_bf16 v[104:119], v[176:179], v[164:167], v[104:119]
    v_mfma_f32_32x32x16_bf16 v[56:71], v[180:183], v[160:163], v[56:71]
    v_mfma_f32_32x32x16_bf16 v[120:135], v[180:183], v[164:167], v[120:135]
    s_waitcnt lgkmcnt(0)
    v_mfma_f32_32x32x16_bf16 v[8:23], v[144:147], v[136:139], v[8:23]
    ds_read_b128 v[160:163], v185 offset:0
    v_lshlrev_b32 v2, 16, v152
    ds_read_b64_tr_b16 v[168:169], v189 offset:0
    v_and_b32 v3, s86, v152
    v_mfma_f32_32x32x16_bf16 v[72:87], v[144:147], v[140:143], v[72:87]
    ds_read_b64_tr_b16 v[170:171], v189 offset:512
    v_lshlrev_b32 v6, 16, v156
    ds_read_b128 v[164:167], v185 offset:4096
    v_and_b32 v7, s86, v156
    v_mfma_f32_16x16x32_bf16 v[196:199], v[144:147], v[204:207], v[196:199]
    ds_read_b64_tr_b16 v[172:173], v193 offset:0
    v_add_f32 v236, v236, v2
    ds_read_b64_tr_b16 v[174:175], v193 offset:512
    v_mfma_f32_32x32x16_bf16 v[24:39], v[148:151], v[136:139], v[24:39]
    v_add_f32 v237, v237, v3
    ds_read_b64_tr_b16 v[176:177], v189 offset:8192
    v_add_f32 v238, v238, v6
    ds_read_b64_tr_b16 v[178:179], v189 offset:8704
    v_mfma_f32_16x16x32_bf16 v[200:203], v[148:151], v[204:207], v[200:203]
    v_add_f32 v239, v239, v7
    ds_read_b64_tr_b16 v[180:181], v193 offset:8192
    ds_read_b64_tr_b16 v[182:183], v193 offset:8704
    v_mfma_f32_32x32x16_bf16 v[88:103], v[148:151], v[140:143], v[88:103]
    v_lshlrev_b32 v2, 16, v153
    v_and_b32 v3, s86, v153
    v_lshlrev_b32 v6, 16, v157
    v_and_b32 v7, s86, v157
    v_add_f32 v236, v236, v2
    v_mfma_f32_32x32x16_bf16 v[40:55], v[152:155], v[136:139], v[40:55]
    v_add_f32 v237, v237, v3
    v_add_f32 v238, v238, v6
    v_add_f32 v239, v239, v7
    v_lshlrev_b32 v2, 16, v154
    v_and_b32 v3, s86, v154
    v_mfma_f32_32x32x16_bf16 v[104:119], v[152:155], v[140:143], v[104:119]
    v_lshlrev_b32 v6, 16, v158
    v_and_b32 v7, s86, v158
    v_add_f32 v236, v236, v2
    v_add_f32 v237, v237, v3
    v_add_f32 v238, v238, v6
    v_mfma_f32_32x32x16_bf16 v[56:71], v[156:159], v[136:139], v[56:71]
    v_add_f32 v239, v239, v7
    v_lshlrev_b32 v2, 16, v155
    v_and_b32 v3, s86, v155
    v_lshlrev_b32 v6, 16, v159
    v_and_b32 v7, s86, v159
    v_mfma_f32_32x32x16_bf16 v[120:135], v[156:159], v[140:143], v[120:135]
    v_add_f32 v236, v236, v2
    v_add_f32 v237, v237, v3
    v_add_f32 v238, v238, v6
    v_add_f32 v239, v239, v7
    s_waitcnt lgkmcnt(0)
    v_mfma_f32_32x32x16_bf16 v[8:23], v[168:171], v[160:163], v[8:23]
    ds_read_b128 v[136:139], v186 offset:0
    ds_read_b64_tr_b16 v[144:145], v190 offset:0
    ds_read_b64_tr_b16 v[146:147], v190 offset:512
    v_mfma_f32_32x32x16_bf16 v[72:87], v[168:171], v[164:167], v[72:87]
    ds_read_b128 v[140:143], v186 offset:4096
    ds_read_b64_tr_b16 v[148:149], v194 offset:0
    v_mfma_f32_32x32x16_bf16 v[24:39], v[172:175], v[160:163], v[24:39]
    ds_read_b64_tr_b16 v[150:151], v194 offset:512
    ds_read_b64_tr_b16 v[152:153], v190 offset:8192
    ds_read_b64_tr_b16 v[154:155], v190 offset:8704
    v_mfma_f32_32x32x16_bf16 v[88:103], v[172:175], v[164:167], v[88:103]
    ds_read_b64_tr_b16 v[156:157], v194 offset:8192
    ds_read_b64_tr_b16 v[158:159], v194 offset:8704
    v_mfma_f32_32x32x16_bf16 v[40:55], v[176:179], v[160:163], v[40:55]
    v_mfma_f32_32x32x16_bf16 v[104:119], v[176:179], v[164:167], v[104:119]
    v_mfma_f32_32x32x16_bf16 v[56:71], v[180:183], v[160:163], v[56:71]
    v_mfma_f32_32x32x16_bf16 v[120:135], v[180:183], v[164:167], v[120:135]
    s_waitcnt lgkmcnt(0)
    v_mfma_f32_32x32x16_bf16 v[8:23], v[144:147], v[136:139], v[8:23]
    ds_read_b128 v[160:163], v187 offset:0
    ds_read_b64_tr_b16 v[168:169], v191 offset:0
    ds_read_b64_tr_b16 v[170:171], v191 offset:512
    v_mfma_f32_32x32x16_bf16 v[72:87], v[144:147], v[140:143], v[72:87]
    ds_read_b128 v[164:167], v187 offset:4096
    ds_read_b64_tr_b16 v[172:173], v195 offset:0
    v_mfma_f32_32x32x16_bf16 v[24:39], v[148:151], v[136:139], v[24:39]
    ds_read_b64_tr_b16 v[174:175], v195 offset:512
    ds_read_b64_tr_b16 v[176:177], v191 offset:8192
    ds_read_b64_tr_b16 v[178:179], v191 offset:8704
    v_mfma_f32_32x32x16_bf16 v[88:103], v[148:151], v[140:143], v[88:103]
    ds_read_b64_tr_b16 v[180:181], v195 offset:8192
    ds_read_b64_tr_b16 v[182:183], v195 offset:8704
    v_mfma_f32_32x32x16_bf16 v[40:55], v[152:155], v[136:139], v[40:55]
    v_add_u32 v184, 4294868992, v184
    v_add_u32 v185, 4294868992, v185
    v_add_u32 v186, 4294868992, v186
    v_mfma_f32_32x32x16_bf16 v[104:119], v[152:155], v[140:143], v[104:119]
    v_add_u32 v187, 4294868992, v187
    v_add_u32 v188, 4294868992, v188
    v_add_u32 v189, 4294868992, v189
    v_mfma_f32_32x32x16_bf16 v[56:71], v[156:159], v[136:139], v[56:71]
    v_add_u32 v190, 4294868992, v190
    v_add_u32 v191, 4294868992, v191
    v_add_u32 v192, 4294868992, v192
    v_mfma_f32_32x32x16_bf16 v[120:135], v[156:159], v[140:143], v[120:135]
    v_add_u32 v193, 4294868992, v193
    v_add_u32 v194, 4294868992, v194
    v_add_u32 v195, 4294868992, v195
    s_waitcnt lgkmcnt(0)
    s_barrier
    v_mfma_f32_32x32x16_bf16 v[8:23], v[168:171], v[160:163], v[8:23]
    ds_read_b128 v[136:139], v184 offset:0
    ds_read_b64_tr_b16 v[144:145], v188 offset:0
    ds_read_b64_tr_b16 v[146:147], v188 offset:512
    v_mfma_f32_32x32x16_bf16 v[72:87], v[168:171], v[164:167], v[72:87]
    ds_read_b128 v[140:143], v184 offset:4096
    ds_read_b64_tr_b16 v[148:149], v192 offset:0
    v_mfma_f32_32x32x16_bf16 v[24:39], v[172:175], v[160:163], v[24:39]
    ds_read_b64_tr_b16 v[150:151], v192 offset:512
    ds_read_b64_tr_b16 v[152:153], v188 offset:8192
    ds_read_b64_tr_b16 v[154:155], v188 offset:8704
    v_mfma_f32_32x32x16_bf16 v[88:103], v[172:175], v[164:167], v[88:103]
    ds_read_b64_tr_b16 v[156:157], v192 offset:8192
    ds_read_b64_tr_b16 v[158:159], v192 offset:8704
    v_mfma_f32_32x32x16_bf16 v[40:55], v[176:179], v[160:163], v[40:55]
    v_and_b32 v240, 31, v0
    v_lshlrev_b32 v1, 3, v240
    v_lshlrev_b32 v240, 2, v240
    s_mov_b32 s79, 0
    v_mfma_f32_32x32x16_bf16 v[104:119], v[176:179], v[164:167], v[104:119]
    s_add_u32 s79, s79, 154048
    s_lshl_b32 s78, s68, 7
    v_and_b32 v242, 1, v0
    v_lshlrev_b32 v242, 6, v242
    v_mfma_f32_32x32x16_bf16 v[56:71], v[180:183], v[160:163], v[56:71]
    v_lshrrev_b32 v6, 4, v0
    v_lshl_add_u32 v242, v6, 4, v242
    v_add_u32 v240, s79, v240
    v_add_u32 v241, s78, v240
    v_mfma_f32_32x32x16_bf16 v[120:135], v[180:183], v[164:167], v[120:135]
    s_add_u32 s78, s78, s79
    v_add_u32 v242, s78, v242
    buffer_load_dword v5, v4, s[64:67], 0 offen sc1
    s_waitcnt lgkmcnt(0)
    v_mfma_f32_32x32x16_bf16 v[8:23], v[144:147], v[136:139], v[8:23]
    ds_read_b128 v[160:163], v185 offset:0
    v_lshlrev_b32 v2, 16, v152
    ds_read_b64_tr_b16 v[168:169], v189 offset:0
    v_and_b32 v3, s86, v152
    v_mfma_f32_32x32x16_bf16 v[72:87], v[144:147], v[140:143], v[72:87]
    ds_read_b64_tr_b16 v[170:171], v189 offset:512
    v_lshlrev_b32 v6, 16, v156
    ds_read_b128 v[164:167], v185 offset:4096
    v_and_b32 v7, s86, v156
    v_mfma_f32_16x16x32_bf16 v[196:199], v[144:147], v[204:207], v[196:199]
    ds_read_b64_tr_b16 v[172:173], v193 offset:0
    v_add_f32 v236, v236, v2
    ds_read_b64_tr_b16 v[174:175], v193 offset:512
    v_mfma_f32_32x32x16_bf16 v[24:39], v[148:151], v[136:139], v[24:39]
    v_add_f32 v237, v237, v3
    ds_read_b64_tr_b16 v[176:177], v189 offset:8192
    v_add_f32 v238, v238, v6
    ds_read_b64_tr_b16 v[178:179], v189 offset:8704
    v_mfma_f32_16x16x32_bf16 v[200:203], v[148:151], v[204:207], v[200:203]
    v_add_f32 v239, v239, v7
    ds_read_b64_tr_b16 v[180:181], v193 offset:8192
    ds_read_b64_tr_b16 v[182:183], v193 offset:8704
    v_mfma_f32_32x32x16_bf16 v[88:103], v[148:151], v[140:143], v[88:103]
    v_lshlrev_b32 v2, 16, v153
    v_and_b32 v3, s86, v153
    v_lshlrev_b32 v6, 16, v157
    v_and_b32 v7, s86, v157
    v_add_f32 v236, v236, v2
    v_mfma_f32_32x32x16_bf16 v[40:55], v[152:155], v[136:139], v[40:55]
    v_add_f32 v237, v237, v3
    v_add_f32 v238, v238, v6
    v_add_f32 v239, v239, v7
    v_lshlrev_b32 v2, 16, v154
    v_and_b32 v3, s86, v154
    v_mfma_f32_32x32x16_bf16 v[104:119], v[152:155], v[140:143], v[104:119]
    v_lshlrev_b32 v6, 16, v158
    v_and_b32 v7, s86, v158
    v_add_f32 v236, v236, v2
    v_add_f32 v237, v237, v3
    v_add_f32 v238, v238, v6
    v_mfma_f32_32x32x16_bf16 v[56:71], v[156:159], v[136:139], v[56:71]
    v_add_f32 v239, v239, v7
    v_lshlrev_b32 v2, 16, v155
    v_and_b32 v3, s86, v155
    v_lshlrev_b32 v6, 16, v159
    v_and_b32 v7, s86, v159
    v_mfma_f32_32x32x16_bf16 v[120:135], v[156:159], v[140:143], v[120:135]
    v_add_f32 v236, v236, v2
    v_add_f32 v237, v237, v3
    v_add_f32 v238, v238, v6
    v_add_f32 v239, v239, v7
    s_waitcnt lgkmcnt(0)
    v_mfma_f32_32x32x16_bf16 v[8:23], v[168:171], v[160:163], v[8:23]
    ds_read_b128 v[136:139], v186 offset:0
    ds_read_b64_tr_b16 v[144:145], v190 offset:0
    ds_read_b64_tr_b16 v[146:147], v190 offset:512
    v_mfma_f32_32x32x16_bf16 v[72:87], v[168:171], v[164:167], v[72:87]
    ds_read_b128 v[140:143], v186 offset:4096
    ds_read_b64_tr_b16 v[148:149], v194 offset:0
    v_mfma_f32_32x32x16_bf16 v[24:39], v[172:175], v[160:163], v[24:39]
    ds_read_b64_tr_b16 v[150:151], v194 offset:512
    ds_read_b64_tr_b16 v[152:153], v190 offset:8192
    ds_read_b64_tr_b16 v[154:155], v190 offset:8704
    v_mfma_f32_32x32x16_bf16 v[88:103], v[172:175], v[164:167], v[88:103]
    ds_read_b64_tr_b16 v[156:157], v194 offset:8192
    ds_read_b64_tr_b16 v[158:159], v194 offset:8704
    v_mfma_f32_32x32x16_bf16 v[40:55], v[176:179], v[160:163], v[40:55]
    v_mfma_f32_32x32x16_bf16 v[104:119], v[176:179], v[164:167], v[104:119]
    v_mfma_f32_32x32x16_bf16 v[56:71], v[180:183], v[160:163], v[56:71]
    v_mfma_f32_32x32x16_bf16 v[120:135], v[180:183], v[164:167], v[120:135]
    s_waitcnt lgkmcnt(0)
    v_mfma_f32_32x32x16_bf16 v[8:23], v[144:147], v[136:139], v[8:23]
    ds_read_b128 v[160:163], v187 offset:0
    ds_read_b64_tr_b16 v[168:169], v191 offset:0
    ds_read_b64_tr_b16 v[170:171], v191 offset:512
    v_mfma_f32_32x32x16_bf16 v[72:87], v[144:147], v[140:143], v[72:87]
    ds_read_b128 v[164:167], v187 offset:4096
    ds_read_b64_tr_b16 v[172:173], v195 offset:0
    v_mfma_f32_32x32x16_bf16 v[24:39], v[148:151], v[136:139], v[24:39]
    ds_read_b64_tr_b16 v[174:175], v195 offset:512
    ds_read_b64_tr_b16 v[176:177], v191 offset:8192
    ds_read_b64_tr_b16 v[178:179], v191 offset:8704
    v_mfma_f32_32x32x16_bf16 v[88:103], v[148:151], v[140:143], v[88:103]
    ds_read_b64_tr_b16 v[180:181], v195 offset:8192
    ds_read_b64_tr_b16 v[182:183], v195 offset:8704
    v_mfma_f32_32x32x16_bf16 v[40:55], v[152:155], v[136:139], v[40:55]
    v_mfma_f32_32x32x16_bf16 v[104:119], v[152:155], v[140:143], v[104:119]
    v_mfma_f32_32x32x16_bf16 v[56:71], v[156:159], v[136:139], v[56:71]
    v_mfma_f32_32x32x16_bf16 v[120:135], v[156:159], v[140:143], v[120:135]
    s_waitcnt lgkmcnt(0)
    s_barrier
    v_mfma_f32_32x32x16_bf16 v[8:23], v[168:171], v[160:163], v[8:23]
    ds_read_b128 v[136:139], v184 offset:49152
    ds_read_b64_tr_b16 v[144:145], v188 offset:49152
    ds_read_b64_tr_b16 v[146:147], v188 offset:49664
    v_mfma_f32_32x32x16_bf16 v[72:87], v[168:171], v[164:167], v[72:87]
    ds_read_b128 v[140:143], v184 offset:53248
    ds_read_b64_tr_b16 v[148:149], v192 offset:49152
    v_mfma_f32_32x32x16_bf16 v[24:39], v[172:175], v[160:163], v[24:39]
    ds_read_b64_tr_b16 v[150:151], v192 offset:49664
    ds_read_b64_tr_b16 v[152:153], v188 offset:57344
    ds_read_b64_tr_b16 v[154:155], v188 offset:57856
    v_mfma_f32_32x32x16_bf16 v[88:103], v[172:175], v[164:167], v[88:103]
    ds_read_b64_tr_b16 v[156:157], v192 offset:57344
    ds_read_b64_tr_b16 v[158:159], v192 offset:57856
    v_mfma_f32_32x32x16_bf16 v[40:55], v[176:179], v[160:163], v[40:55]
    s_waitcnt vmcnt(0)
    v_cmp_gt_u32 vcc, 16, v5
    s_nop 0
    s_and_b32 s78, vcc_lo, 0xffff
    s_cbranch_scc1 k1_kv_c_cw
k1_kv_c_cok:
    s_lshl_b32 s78, s72, 3
    s_add_u32 s78, s78, s83
    s_lshl_b32 s78, s78, 8
    s_add_u32 s78, s78, 65536
    buffer_load_dwordx2 v[208:209], v1, s[56:59], s78 offen sc1
    s_lshl_b32 s78, s72, 3
    s_add_u32 s78, s78, s84
    s_lshl_b32 s78, s78, 8
    s_add_u32 s78, s78, 65536
    buffer_load_dwordx2 v[212:213], v1, s[56:59], s78 offen sc1
    v_mfma_f32_32x32x16_bf16 v[104:119], v[176:179], v[164:167], v[104:119]
    v_mfma_f32_32x32x16_bf16 v[56:71], v[180:183], v[160:163], v[56:71]
    v_mfma_f32_32x32x16_bf16 v[120:135], v[180:183], v[164:167], v[120:135]
    s_waitcnt lgkmcnt(0)
    v_mfma_f32_32x32x16_bf16 v[8:23], v[144:147], v[136:139], v[8:23]
    ds_read_b128 v[160:163], v185 offset:49152
    v_lshlrev_b32 v2, 16, v152
    ds_read_b64_tr_b16 v[168:169], v189 offset:49152
    v_and_b32 v3, s86, v152
    v_mfma_f32_32x32x16_bf16 v[72:87], v[144:147], v[140:143], v[72:87]
    ds_read_b64_tr_b16 v[170:171], v189 offset:49664
    v_lshlrev_b32 v6, 16, v156
    ds_read_b128 v[164:167], v185 offset:53248
    v_and_b32 v7, s86, v156
    v_mfma_f32_16x16x32_bf16 v[196:199], v[144:147], v[204:207], v[196:199]
    ds_read_b64_tr_b16 v[172:173], v193 offset:49152
    v_add_f32 v236, v236, v2
    ds_read_b64_tr_b16 v[174:175], v193 offset:49664
    v_mfma_f32_32x32x16_bf16 v[24:39], v[148:151], v[136:139], v[24:39]
    v_add_f32 v237, v237, v3
    ds_read_b64_tr_b16 v[176:177], v189 offset:57344
    v_add_f32 v238, v238, v6
    ds_read_b64_tr_b16 v[178:179], v189 offset:57856
    v_mfma_f32_16x16x32_bf16 v[200:203], v[148:151], v[204:207], v[200:203]
    v_add_f32 v239, v239, v7
    ds_read_b64_tr_b16 v[180:181], v193 offset:57344
    ds_read_b64_tr_b16 v[182:183], v193 offset:57856
    v_mfma_f32_32x32x16_bf16 v[88:103], v[148:151], v[140:143], v[88:103]
    v_lshlrev_b32 v2, 16, v153
    v_and_b32 v3, s86, v153
    v_lshlrev_b32 v6, 16, v157
    v_and_b32 v7, s86, v157
    v_add_f32 v236, v236, v2
    v_mfma_f32_32x32x16_bf16 v[40:55], v[152:155], v[136:139], v[40:55]
    v_add_f32 v237, v237, v3
    v_add_f32 v238, v238, v6
    v_add_f32 v239, v239, v7
    v_lshlrev_b32 v2, 16, v154
    v_and_b32 v3, s86, v154
    v_mfma_f32_32x32x16_bf16 v[104:119], v[152:155], v[140:143], v[104:119]
    v_lshlrev_b32 v6, 16, v158
    v_and_b32 v7, s86, v158
    v_add_f32 v236, v236, v2
    v_add_f32 v237, v237, v3
    v_add_f32 v238, v238, v6
    v_mfma_f32_32x32x16_bf16 v[56:71], v[156:159], v[136:139], v[56:71]
    v_add_f32 v239, v239, v7
    v_lshlrev_b32 v2, 16, v155
    v_and_b32 v3, s86, v155
    v_lshlrev_b32 v6, 16, v159
    v_and_b32 v7, s86, v159
    v_mfma_f32_32x32x16_bf16 v[120:135], v[156:159], v[140:143], v[120:135]
    v_add_f32 v236, v236, v2
    v_add_f32 v237, v237, v3
    v_add_f32 v238, v238, v6
    v_add_f32 v239, v239, v7
    s_waitcnt lgkmcnt(0)
    v_mfma_f32_32x32x16_bf16 v[8:23], v[168:171], v[160:163], v[8:23]
    ds_read_b128 v[136:139], v186 offset:49152
    ds_read_b64_tr_b16 v[144:145], v190 offset:49152
    ds_read_b64_tr_b16 v[146:147], v190 offset:49664
    v_mfma_f32_32x32x16_bf16 v[72:87], v[168:171], v[164:167], v[72:87]
    ds_read_b128 v[140:143], v186 offset:53248
    ds_read_b64_tr_b16 v[148:149], v194 offset:49152
    v_mfma_f32_32x32x16_bf16 v[24:39], v[172:175], v[160:163], v[24:39]
    ds_read_b64_tr_b16 v[150:151], v194 offset:49664
    ds_read_b64_tr_b16 v[152:153], v190 offset:57344
    ds_read_b64_tr_b16 v[154:155], v190 offset:57856
    v_mfma_f32_32x32x16_bf16 v[88:103], v[172:175], v[164:167], v[88:103]
    ds_read_b64_tr_b16 v[156:157], v194 offset:57344
    ds_read_b64_tr_b16 v[158:159], v194 offset:57856
    v_mfma_f32_32x32x16_bf16 v[40:55], v[176:179], v[160:163], v[40:55]
    v_mfma_f32_32x32x16_bf16 v[104:119], v[176:179], v[164:167], v[104:119]
    v_mfma_f32_32x32x16_bf16 v[56:71], v[180:183], v[160:163], v[56:71]
    v_mfma_f32_32x32x16_bf16 v[120:135], v[180:183], v[164:167], v[120:135]
    s_waitcnt lgkmcnt(0)
    v_mfma_f32_32x32x16_bf16 v[8:23], v[144:147], v[136:139], v[8:23]
    ds_read_b128 v[160:163], v187 offset:49152
    ds_read_b64_tr_b16 v[168:169], v191 offset:49152
    ds_read_b64_tr_b16 v[170:171], v191 offset:49664
    ds_read_b128 v[164:167], v187 offset:53248
    ds_read_b64_tr_b16 v[172:173], v195 offset:49152
    ds_read_b64_tr_b16 v[174:175], v195 offset:49664
    v_mfma_f32_32x32x16_bf16 v[72:87], v[144:147], v[140:143], v[72:87]
    ds_read_b64_tr_b16 v[176:177], v191 offset:57344
    ds_read_b64_tr_b16 v[178:179], v191 offset:57856
    ds_read_b64_tr_b16 v[180:181], v195 offset:57344
    ds_read_b64_tr_b16 v[182:183], v195 offset:57856
    v_add_f32 v236, v236, v237
    v_mfma_f32_32x32x16_bf16 v[24:39], v[148:151], v[136:139], v[24:39]
    v_add_f32 v238, v238, v239
    v_mov_b32 v237, v236
    v_mov_b32 v239, v238
    s_nop 0
    v_permlane32_swap_b32 v236, v237
    v_permlane32_swap_b32 v238, v239
    v_add_f32 v236, v236, v237
    v_mfma_f32_32x32x16_bf16 v[88:103], v[148:151], v[140:143], v[88:103]
    v_add_f32 v238, v238, v239
    ds_write_b128 v242, v[196:199] offset:0
    ds_write_b128 v242, v[200:203] offset:512
    ds_write_b32 v241, v236 offset:1024
    ds_write_b32 v241, v238 offset:1536
    s_waitcnt lgkmcnt(0)
    s_barrier
    ds_read_b32 v196, v240 offset:0
    ds_read_b32 v197, v240 offset:128
    ds_read_b32 v198, v240 offset:256
    ds_read_b32 v199, v240 offset:384
    ds_read_b32 v200, v240 offset:512
    ds_read_b32 v201, v240 offset:640
    ds_read_b32 v202, v240 offset:768
    ds_read_b32 v203, v240 offset:896
    ds_read_b32 v192, v240 offset:1024
    ds_read_b32 v193, v240 offset:1152
    ds_read_b32 v194, v240 offset:1280
    ds_read_b32 v195, v240 offset:1408
    ds_read_b32 v204, v240 offset:1536
    ds_read_b32 v205, v240 offset:1664
    ds_read_b32 v206, v240 offset:1792
    ds_read_b32 v207, v240 offset:1920
    s_waitcnt vmcnt(0)
    s_mov_b32 vcc_lo, -1
    s_mov_b32 vcc_hi, 0
    v_mfma_f32_32x32x16_bf16 v[40:55], v[152:155], v[136:139], v[40:55]
    v_cvt_pk_bf16_f32 v184, v208, v208
    v_cvt_pk_bf16_f32 v188, v212, v212
    v_rsq_f32 v211, v209
    v_rsq_f32 v215, v213
    v_and_b32 v186, s86, v184
    v_and_b32 v190, s86, v188
    v_mfma_f32_32x32x16_bf16 v[104:119], v[152:155], v[140:143], v[104:119]
    v_sub_f32 v186, v208, v186
    v_sub_f32 v190, v212, v190
    v_cvt_pk_bf16_f32 v185, v186, 0
    v_cvt_pk_bf16_f32 v189, v190, 0
    v_cndmask_b32 v184, 0, v184, vcc
    v_mfma_f32_32x32x16_bf16 v[56:71], v[156:159], v[136:139], v[56:71]
    v_cndmask_b32 v188, 0, v188, vcc
    v_cndmask_b32 v185, 0, v185, vcc
    v_cndmask_b32 v189, 0, v189, vcc
    v_mov_b32 v186, 0
    v_mov_b32 v190, 0
    v_mov_b32 v187, 0
    v_mfma_f32_32x32x16_bf16 v[120:135], v[156:159], v[140:143], v[120:135]
    v_mov_b32 v191, 0
    v_mul_f32 v210, 0x3fb8aa3b, v211
    v_mul_f32 v214, 0x3fb8aa3b, v215
    v_mul_f32 v209, v209, v211
    v_mul_f32 v213, v213, v215
    s_waitcnt lgkmcnt(0)
    v_mfma_f32_32x32x16_bf16 v[40:55], v[176:179], v[160:163], v[40:55]
    v_add_f32 v196, v196, v197
    v_add_f32 v200, v200, v201
    v_add_f32 v192, v192, v193
    v_add_f32 v204, v204, v205
    v_add_f32 v198, v198, v199
    v_add_f32 v202, v202, v203
    v_add_f32 v194, v194, v195
    v_add_f32 v206, v206, v207
    v_add_f32 v196, v196, v198
    v_add_f32 v200, v200, v202
    v_mfma_f32_32x32x16_bf16 v[56:71], v[180:183], v[160:163], v[56:71]
    v_add_f32 v192, v192, v194
    v_add_f32 v204, v204, v206
    v_cvt_pk_bf16_f32 v197, v196, v196
    v_cvt_pk_bf16_f32 v201, v200, v200
    v_cvt_pk_bf16_f32 v193, v192, v192
    v_cvt_pk_bf16_f32 v205, v204, v204
    v_and_b32 v197, s86, v197
    v_and_b32 v201, s86, v201
    v_and_b32 v193, s86, v193
    v_and_b32 v205, s86, v205
    v_mfma_f32_32x32x16_bf16 v[8:23], v[168:171], v[160:163], v[8:23]
    v_sub_f32 v197, v196, v197
    v_sub_f32 v201, v200, v201
    v_sub_f32 v193, v192, v193
    v_sub_f32 v205, v204, v205
    v_cvt_pk_bf16_f32 v196, v196, v197
    v_cvt_pk_bf16_f32 v200, v200, v201
    v_cvt_pk_bf16_f32 v192, v192, v193
    v_cvt_pk_bf16_f32 v204, v204, v205
    v_mov_b32 v197, v196
    v_mov_b32 v201, v200
    v_mfma_f32_32x32x16_bf16 v[24:39], v[172:175], v[160:163], v[24:39]
    v_mov_b32 v193, v192
    v_mov_b32 v205, v204
    v_mov_b32 v198, 0
    v_mov_b32 v202, 0
    v_mov_b32 v194, 0
    v_mov_b32 v206, 0
    v_mov_b32 v199, 0
    v_mov_b32 v203, 0
    v_mov_b32 v195, 0
    v_mov_b32 v207, 0
    s_nop 0
    v_mfma_f32_32x32x16_bf16 v[40:55], v[192:195], v[184:187], v[40:55]
    v_bfe_u32 v243, v0, 4, 1
    v_mul_u32_u24 v243, 0x8000, v243
    v_lshl_or_b32 v243, v243, 16, v243
    v_xor_b32 v216, v216, v243
    v_xor_b32 v217, v217, v243
    v_xor_b32 v218, v218, v243
    v_xor_b32 v219, v219, v243
    v_xor_b32 v220, v220, v243
    v_mfma_f32_32x32x16_bf16 v[56:71], v[204:207], v[184:187], v[56:71]
    v_xor_b32 v221, v221, v243
    v_xor_b32 v222, v222, v243
    v_xor_b32 v223, v223, v243
    v_xor_b32 v224, v224, v243
    v_xor_b32 v225, v225, v243
    v_xor_b32 v226, v226, v243
    v_xor_b32 v227, v227, v243
    v_xor_b32 v228, v228, v243
    v_mfma_f32_32x32x16_bf16 v[8:23], v[196:199], v[184:187], v[8:23]
    v_xor_b32 v229, v229, v243
    v_xor_b32 v230, v230, v243
    v_xor_b32 v231, v231, v243
    v_cvt_pk_bf16_f32 v2, v209, v209
    v_mov_b32 v3, v2
    v_cvt_pk_bf16_f32 v6, v213, v213
    v_mov_b32 v7, v6
    v_lshrrev_b32 v244, 5, v0
    v_mfma_f32_32x32x16_bf16 v[24:39], v[200:203], v[184:187], v[24:39]
    v_lshlrev_b32 v244, 3, v244
    v_sub_u32 v244, v232, v244
    v_add_u32 v244, 96, v244
    ds_write_b64 v244, v[2:3] offset:0
    ds_write_b64 v244, v[2:3] offset:3584
    ds_write_b64 v244, v[2:3] offset:7168
    ds_write_b64 v244, v[2:3] offset:10752
    v_mfma_f32_32x32x16_bf16 v[104:119], v[176:179], v[164:167], v[104:119]
    v_cvt_pk_bf16_f32 v40, v40, v41
    v_cvt_pk_bf16_f32 v41, v42, v43
    v_cvt_pk_bf16_f32 v42, v44, v45
    v_cvt_pk_bf16_f32 v43, v46, v47
    v_cvt_pk_bf16_f32 v44, v48, v49
    v_mfma_f32_32x32x16_bf16 v[104:119], v[192:195], v[188:191], v[104:119]
    v_cvt_pk_bf16_f32 v45, v50, v51
    v_cvt_pk_bf16_f32 v46, v52, v53
    v_cvt_pk_bf16_f32 v47, v54, v55
    v_cvt_pk_bf16_f32 v56, v56, v57
    v_mfma_f32_32x32x16_bf16 v[120:135], v[180:183], v[164:167], v[120:135]
    v_cvt_pk_bf16_f32 v57, v58, v59
    v_cvt_pk_bf16_f32 v58, v60, v61
    v_cvt_pk_bf16_f32 v59, v62, v63
    v_cvt_pk_bf16_f32 v60, v64, v65
    v_cvt_pk_bf16_f32 v61, v66, v67
    v_mfma_f32_32x32x16_bf16 v[120:135], v[204:207], v[188:191], v[120:135]
    v_cvt_pk_bf16_f32 v62, v68, v69
    v_cvt_pk_bf16_f32 v63, v70, v71
    ds_write_b128 v232, v[40:43] offset:64
    ds_write_b128 v232, v[44:47] offset:3648
    v_mfma_f32_32x32x16_bf16 v[72:87], v[168:171], v[164:167], v[72:87]
    ds_write_b128 v232, v[56:59] offset:7232
    ds_write_b128 v232, v[60:63] offset:10816
    v_cvt_pk_bf16_f32 v8, v8, v9
    v_cvt_pk_bf16_f32 v9, v10, v11
    v_cvt_pk_bf16_f32 v10, v12, v13
    v_mfma_f32_32x32x16_bf16 v[72:87], v[196:199], v[188:191], v[72:87]
    v_cvt_pk_bf16_f32 v11, v14, v15
    v_cvt_pk_bf16_f32 v12, v16, v17
    v_cvt_pk_bf16_f32 v13, v18, v19
    v_cvt_pk_bf16_f32 v14, v20, v21
    v_mfma_f32_32x32x16_bf16 v[88:103], v[172:175], v[164:167], v[88:103]
    v_cvt_pk_bf16_f32 v15, v22, v23
    v_cvt_pk_bf16_f32 v24, v24, v25
    v_cvt_pk_bf16_f32 v25, v26, v27
    v_cvt_pk_bf16_f32 v26, v28, v29
    v_cvt_pk_bf16_f32 v27, v30, v31
    v_mfma_f32_32x32x16_bf16 v[88:103], v[200:203], v[188:191], v[88:103]
    v_cvt_pk_bf16_f32 v28, v32, v33
    v_cvt_pk_bf16_f32 v29, v34, v35
    v_cvt_pk_bf16_f32 v30, v36, v37
    v_cvt_pk_bf16_f32 v31, v38, v39
    s_waitcnt lgkmcnt(0)
    v_mfma_f32_32x32x16_bf16 v[136:151], v[216:219], v[8:11], 0
    v_cvt_pk_bf16_f32 v104, v104, v105
    v_cvt_pk_bf16_f32 v105, v106, v107
    v_cvt_pk_bf16_f32 v106, v108, v109
    v_cvt_pk_bf16_f32 v107, v110, v111
    v_cvt_pk_bf16_f32 v108, v112, v113
    v_cvt_pk_bf16_f32 v109, v114, v115
    v_cvt_pk_bf16_f32 v110, v116, v117
    v_cvt_pk_bf16_f32 v111, v118, v119
    v_mfma_f32_32x32x16_bf16 v[152:167], v[220:223], v[12:15], 0
    v_cvt_pk_bf16_f32 v120, v120, v121
    v_cvt_pk_bf16_f32 v121, v122, v123
    v_cvt_pk_bf16_f32 v122, v124, v125
    v_cvt_pk_bf16_f32 v123, v126, v127
    v_cvt_pk_bf16_f32 v124, v128, v129
    v_cvt_pk_bf16_f32 v125, v130, v131
    v_cvt_pk_bf16_f32 v126, v132, v133
    v_cvt_pk_bf16_f32 v127, v134, v135
    v_mfma_f32_32x32x16_bf16 v[40:55], v[224:227], v[24:27], 0
    v_cvt_pk_bf16_f32 v72, v72, v73
    v_cvt_pk_bf16_f32 v73, v74, v75
    v_cvt_pk_bf16_f32 v74, v76, v77
    v_cvt_pk_bf16_f32 v75, v78, v79
    v_cvt_pk_bf16_f32 v76, v80, v81
    v_cvt_pk_bf16_f32 v77, v82, v83
    v_cvt_pk_bf16_f32 v78, v84, v85
    v_cvt_pk_bf16_f32 v79, v86, v87
    v_mfma_f32_32x32x16_bf16 v[56:71], v[228:231], v[28:31], 0
    v_cvt_pk_bf16_f32 v88, v88, v89
    v_cvt_pk_bf16_f32 v89, v90, v91
    v_cvt_pk_bf16_f32 v90, v92, v93
    v_cvt_pk_bf16_f32 v91, v94, v95
    v_cvt_pk_bf16_f32 v92, v96, v97
    v_cvt_pk_bf16_f32 v93, v98, v99
    v_cvt_pk_bf16_f32 v94, v100, v101
    v_cvt_pk_bf16_f32 v95, v102, v103
    v_max3_f32 v184, v136, v137, v138
    v_max3_f32 v188, v152, v153, v154
    v_max3_f32 v192, v40, v41, v42
    s_nop 0
    v_max3_f32 v204, v56, v57, v58
    v_max3_f32 v185, v144, v145, v146
    v_max3_f32 v189, v160, v161, v162
    v_max3_f32 v193, v48, v49, v50
    v_max3_f32 v205, v64, v65, v66
    v_max3_f32 v186, v139, v140, v141
    v_max3_f32 v190, v155, v156, v157
    v_max3_f32 v194, v43, v44, v45
    v_max3_f32 v206, v59, v60, v61
    v_max3_f32 v187, v147, v148, v149
    v_max3_f32 v191, v163, v164, v165
    v_max3_f32 v195, v51, v52, v53
    v_max3_f32 v207, v67, v68, v69
    v_max3_f32 v184, v142, v143, v184
    v_max3_f32 v188, v158, v159, v188
    v_max3_f32 v192, v46, v47, v192
    v_max3_f32 v204, v62, v63, v204
    v_max3_f32 v185, v150, v151, v185
    v_max3_f32 v189, v166, v167, v189
    v_max3_f32 v193, v54, v55, v193
    v_max3_f32 v205, v70, v71, v205
    v_max_f32 v184, v184, v186
    v_max_f32 v188, v188, v190
    v_max_f32 v192, v192, v194
    v_max_f32 v204, v204, v206
    v_max_f32 v185, v185, v187
    v_max_f32 v189, v189, v191
    v_max_f32 v193, v193, v195
    v_max_f32 v205, v205, v207
    v_permlane32_swap_b32 v184, v185
    v_permlane32_swap_b32 v188, v189
    v_permlane32_swap_b32 v192, v193
    v_permlane32_swap_b32 v204, v205
    v_max_f32 v184, v184, v185
    v_max_f32 v188, v188, v189
    v_max_f32 v192, v192, v193
    v_max_f32 v204, v204, v205
    v_mul_f32 v184, v210, v184
    v_mul_f32 v188, v210, v188
    v_mul_f32 v192, v210, v192
    v_mul_f32 v204, v210, v204
    v_mov_b32 v185, v184
    v_mov_b32 v189, v188
    v_mov_b32 v193, v192
    v_mov_b32 v205, v204
    v_permlane32_swap_b32 v184, v185
    v_permlane32_swap_b32 v188, v189
    v_permlane32_swap_b32 v192, v193
    v_permlane32_swap_b32 v204, v205
    v_fma_f32 v136, v136, v210, -v184
    v_fma_f32 v152, v152, v210, -v188
    v_fma_f32 v40, v40, v210, -v192
    v_fma_f32 v56, v56, v210, -v204
    v_fma_f32 v137, v137, v210, -v184
    v_fma_f32 v153, v153, v210, -v188
    v_fma_f32 v41, v41, v210, -v192
    v_fma_f32 v57, v57, v210, -v204
    v_fma_f32 v138, v138, v210, -v184
    v_fma_f32 v154, v154, v210, -v188
    v_fma_f32 v42, v42, v210, -v192
    v_fma_f32 v58, v58, v210, -v204
    v_fma_f32 v139, v139, v210, -v184
    v_fma_f32 v155, v155, v210, -v188
    v_fma_f32 v43, v43, v210, -v192
    v_fma_f32 v59, v59, v210, -v204
    v_fma_f32 v140, v140, v210, -v184
    v_fma_f32 v156, v156, v210, -v188
    v_fma_f32 v44, v44, v210, -v192
    v_fma_f32 v60, v60, v210, -v204
    v_fma_f32 v141, v141, v210, -v184
    v_fma_f32 v157, v157, v210, -v188
    v_fma_f32 v45, v45, v210, -v192
    v_fma_f32 v61, v61, v210, -v204
    v_fma_f32 v142, v142, v210, -v184
    v_fma_f32 v158, v158, v210, -v188
    v_fma_f32 v46, v46, v210, -v192
    v_fma_f32 v62, v62, v210, -v204
    v_fma_f32 v143, v143, v210, -v184
    v_fma_f32 v159, v159, v210, -v188
    v_fma_f32 v47, v47, v210, -v192
    v_fma_f32 v63, v63, v210, -v204
    v_fma_f32 v144, v144, v210, -v185
    v_fma_f32 v160, v160, v210, -v189
    v_fma_f32 v48, v48, v210, -v193
    v_fma_f32 v64, v64, v210, -v205
    v_fma_f32 v145, v145, v210, -v185
    v_fma_f32 v161, v161, v210, -v189
    v_fma_f32 v49, v49, v210, -v193
    v_fma_f32 v65, v65, v210, -v205
    v_fma_f32 v146, v146, v210, -v185
    v_fma_f32 v162, v162, v210, -v189
    v_fma_f32 v50, v50, v210, -v193
    v_fma_f32 v66, v66, v210, -v205
    v_fma_f32 v147, v147, v210, -v185
    v_fma_f32 v163, v163, v210, -v189
    v_fma_f32 v51, v51, v210, -v193
    v_fma_f32 v67, v67, v210, -v205
    v_fma_f32 v148, v148, v210, -v185
    v_fma_f32 v164, v164, v210, -v189
    v_fma_f32 v52, v52, v210, -v193
    v_fma_f32 v68, v68, v210, -v205
    v_fma_f32 v149, v149, v210, -v185
    v_fma_f32 v165, v165, v210, -v189
    v_fma_f32 v53, v53, v210, -v193
    v_fma_f32 v69, v69, v210, -v205
    v_fma_f32 v150, v150, v210, -v185
    v_fma_f32 v166, v166, v210, -v189
    v_fma_f32 v54, v54, v210, -v193
    v_fma_f32 v70, v70, v210, -v205
    v_fma_f32 v151, v151, v210, -v185
    v_fma_f32 v167, v167, v210, -v189
    v_fma_f32 v55, v55, v210, -v193
    v_fma_f32 v71, v71, v210, -v205
    v_exp_f32 v136, v136
    v_exp_f32 v152, v152
    v_exp_f32 v40, v40
    v_exp_f32 v56, v56
    v_exp_f32 v137, v137
    v_exp_f32 v153, v153
    v_exp_f32 v41, v41
    v_exp_f32 v57, v57
    v_exp_f32 v138, v138
    v_exp_f32 v154, v154
    v_exp_f32 v42, v42
    v_exp_f32 v58, v58
    v_exp_f32 v139, v139
    v_exp_f32 v155, v155
    v_exp_f32 v43, v43
    v_exp_f32 v59, v59
    v_exp_f32 v140, v140
    v_exp_f32 v156, v156
    v_exp_f32 v44, v44
    v_exp_f32 v60, v60
    v_exp_f32 v141, v141
    v_exp_f32 v157, v157
    v_exp_f32 v45, v45
    v_exp_f32 v61, v61
    v_exp_f32 v142, v142
    v_exp_f32 v158, v158
    v_exp_f32 v46, v46
    v_exp_f32 v62, v62
    v_exp_f32 v143, v143
    v_exp_f32 v159, v159
    v_exp_f32 v47, v47
    v_exp_f32 v63, v63
    v_exp_f32 v144, v144
    v_exp_f32 v160, v160
    v_exp_f32 v48, v48
    v_exp_f32 v64, v64
    v_exp_f32 v145, v145
    v_exp_f32 v161, v161
    v_exp_f32 v49, v49
    v_exp_f32 v65, v65
    v_exp_f32 v146, v146
    v_exp_f32 v162, v162
    v_exp_f32 v50, v50
    v_exp_f32 v66, v66
    v_exp_f32 v147, v147
    v_exp_f32 v163, v163
    v_exp_f32 v51, v51
    v_exp_f32 v67, v67
    v_exp_f32 v148, v148
    v_exp_f32 v164, v164
    v_exp_f32 v52, v52
    v_exp_f32 v68, v68
    v_exp_f32 v149, v149
    v_exp_f32 v165, v165
    v_exp_f32 v53, v53
    v_exp_f32 v69, v69
    v_exp_f32 v150, v150
    v_exp_f32 v166, v166
    v_exp_f32 v54, v54
    v_exp_f32 v70, v70
    v_exp_f32 v151, v151
    v_exp_f32 v167, v167
    v_exp_f32 v55, v55
    v_exp_f32 v71, v71
    v_add_f32 v184, v136, v137
    v_add_f32 v188, v152, v153
    v_add_f32 v192, v40, v41
    v_add_f32 v204, v56, v57
    v_add_f32 v185, v144, v145
    v_add_f32 v189, v160, v161
    v_add_f32 v193, v48, v49
    v_add_f32 v205, v64, v65
    v_add_f32 v186, v138, v139
    v_add_f32 v190, v154, v155
    v_add_f32 v194, v42, v43
    v_add_f32 v206, v58, v59
    v_add_f32 v187, v146, v147
    v_add_f32 v191, v162, v163
    v_add_f32 v195, v50, v51
    v_add_f32 v207, v66, v67
    v_add_f32 v184, v184, v140
    v_add_f32 v188, v188, v156
    v_add_f32 v192, v192, v44
    v_add_f32 v204, v204, v60
    v_add_f32 v185, v185, v148
    v_add_f32 v189, v189, v164
    v_add_f32 v193, v193, v52
    v_add_f32 v205, v205, v68
    v_add_f32 v186, v186, v141
    v_add_f32 v190, v190, v157
    v_add_f32 v194, v194, v45
    v_add_f32 v206, v206, v61
    v_add_f32 v187, v187, v149
    v_add_f32 v191, v191, v165
    v_add_f32 v195, v195, v53
    v_add_f32 v207, v207, v69
    v_add_f32 v184, v184, v142
    v_add_f32 v188, v188, v158
    v_add_f32 v192, v192, v46
    v_add_f32 v204, v204, v62
    v_add_f32 v185, v185, v150
    v_add_f32 v189, v189, v166
    v_add_f32 v193, v193, v54
    v_add_f32 v205, v205, v70
    v_add_f32 v186, v186, v143
    v_add_f32 v190, v190, v159
    v_add_f32 v194, v194, v47
    v_add_f32 v206, v206, v63
    v_add_f32 v187, v187, v151
    v_add_f32 v191, v191, v167
    v_add_f32 v195, v195, v55
    v_add_f32 v207, v207, v71
    v_add_f32 v184, v184, v186
    v_add_f32 v188, v188, v190
    v_add_f32 v192, v192, v194
    v_add_f32 v204, v204, v206
    v_add_f32 v185, v185, v187
    v_add_f32 v189, v189, v191
    v_add_f32 v193, v193, v195
    v_add_f32 v205, v205, v207
    v_permlane32_swap_b32 v184, v185
    v_permlane32_swap_b32 v188, v189
    v_permlane32_swap_b32 v192, v193
    v_permlane32_swap_b32 v204, v205
    v_add_f32 v184, v184, v185
    v_add_f32 v188, v188, v189
    v_add_f32 v192, v192, v193
    v_add_f32 v204, v204, v205
    v_rcp_f32 v184, v184
    v_rcp_f32 v188, v188
    v_rcp_f32 v192, v192
    v_rcp_f32 v204, v204
    v_mul_f32 v184, v184, v211
    v_mul_f32 v188, v188, v211
    v_mul_f32 v192, v192, v211
    v_mul_f32 v204, v204, v211
    v_mov_b32 v185, v184
    v_mov_b32 v189, v188
    v_mov_b32 v193, v192
    v_mov_b32 v205, v204
    v_permlane32_swap_b32 v184, v185
    v_permlane32_swap_b32 v188, v189
    v_permlane32_swap_b32 v192, v193
    v_permlane32_swap_b32 v204, v205
    v_mul_f32 v136, v136, v184
    v_mul_f32 v152, v152, v188
    v_mul_f32 v40, v40, v192
    v_mul_f32 v56, v56, v204
    v_mul_f32 v137, v137, v184
    v_mul_f32 v153, v153, v188
    v_mul_f32 v41, v41, v192
    v_mul_f32 v57, v57, v204
    v_mul_f32 v138, v138, v184
    v_mul_f32 v154, v154, v188
    v_mul_f32 v42, v42, v192
    v_mul_f32 v58, v58, v204
    v_mul_f32 v139, v139, v184
    v_mul_f32 v155, v155, v188
    v_mul_f32 v43, v43, v192
    v_mul_f32 v59, v59, v204
    v_mul_f32 v140, v140, v184
    v_mul_f32 v156, v156, v188
    v_mul_f32 v44, v44, v192
    v_mul_f32 v60, v60, v204
    v_mul_f32 v141, v141, v184
    v_mul_f32 v157, v157, v188
    v_mul_f32 v45, v45, v192
    v_mul_f32 v61, v61, v204
    v_mul_f32 v142, v142, v184
    v_mul_f32 v158, v158, v188
    v_mul_f32 v46, v46, v192
    v_mul_f32 v62, v62, v204
    v_mul_f32 v143, v143, v184
    v_mul_f32 v159, v159, v188
    v_mul_f32 v47, v47, v192
    v_mul_f32 v63, v63, v204
    v_mul_f32 v144, v144, v185
    v_mul_f32 v160, v160, v189
    v_mul_f32 v48, v48, v193
    v_mul_f32 v64, v64, v205
    v_mul_f32 v145, v145, v185
    v_mul_f32 v161, v161, v189
    v_mul_f32 v49, v49, v193
    v_mul_f32 v65, v65, v205
    v_mul_f32 v146, v146, v185
    v_mul_f32 v162, v162, v189
    v_mul_f32 v50, v50, v193
    v_mul_f32 v66, v66, v205
    v_mul_f32 v147, v147, v185
    v_mul_f32 v163, v163, v189
    v_mul_f32 v51, v51, v193
    v_mul_f32 v67, v67, v205
    v_mul_f32 v148, v148, v185
    v_mul_f32 v164, v164, v189
    v_mul_f32 v52, v52, v193
    v_mul_f32 v68, v68, v205
    v_mul_f32 v149, v149, v185
    v_mul_f32 v165, v165, v189
    v_mul_f32 v53, v53, v193
    v_mul_f32 v69, v69, v205
    v_mul_f32 v150, v150, v185
    v_mul_f32 v166, v166, v189
    v_mul_f32 v54, v54, v193
    v_mul_f32 v70, v70, v205
    v_mul_f32 v151, v151, v185
    v_mul_f32 v167, v167, v189
    v_mul_f32 v55, v55, v193
    v_mul_f32 v71, v71, v205
    v_cvt_pk_bf16_f32 v136, v136, v137
    v_cvt_pk_bf16_f32 v152, v152, v153
    v_cvt_pk_bf16_f32 v40, v40, v41
    v_cvt_pk_bf16_f32 v56, v56, v57
    v_cvt_pk_bf16_f32 v137, v138, v139
    v_cvt_pk_bf16_f32 v153, v154, v155
    v_cvt_pk_bf16_f32 v41, v42, v43
    v_cvt_pk_bf16_f32 v57, v58, v59
    v_cvt_pk_bf16_f32 v138, v140, v141
    v_cvt_pk_bf16_f32 v154, v156, v157
    v_cvt_pk_bf16_f32 v42, v44, v45
    v_cvt_pk_bf16_f32 v58, v60, v61
    v_cvt_pk_bf16_f32 v139, v142, v143
    v_cvt_pk_bf16_f32 v155, v158, v159
    v_cvt_pk_bf16_f32 v43, v46, v47
    v_cvt_pk_bf16_f32 v59, v62, v63
    v_cvt_pk_bf16_f32 v140, v144, v145
    v_cvt_pk_bf16_f32 v156, v160, v161
    v_cvt_pk_bf16_f32 v44, v48, v49
    v_cvt_pk_bf16_f32 v60, v64, v65
    v_cvt_pk_bf16_f32 v141, v146, v147
    v_cvt_pk_bf16_f32 v157, v162, v163
    v_cvt_pk_bf16_f32 v45, v50, v51
    v_cvt_pk_bf16_f32 v61, v66, v67
    v_cvt_pk_bf16_f32 v142, v148, v149
    v_cvt_pk_bf16_f32 v158, v164, v165
    v_cvt_pk_bf16_f32 v46, v52, v53
    v_cvt_pk_bf16_f32 v62, v68, v69
    v_cvt_pk_bf16_f32 v143, v150, v151
    v_cvt_pk_bf16_f32 v159, v166, v167
    v_cvt_pk_bf16_f32 v47, v54, v55
    v_cvt_pk_bf16_f32 v63, v70, v71
    ds_write_b128 v232, v[136:139] offset:0
    ds_write_b128 v232, v[152:155] offset:3584
    ds_write_b128 v232, v[40:43] offset:7168
    ds_write_b128 v232, v[56:59] offset:10752
    ds_write_b128 v232, v[140:143] offset:32
    ds_write_b128 v232, v[156:159] offset:3616
    ds_write_b128 v232, v[44:47] offset:7200
    ds_write_b128 v232, v[60:63] offset:10784
    s_waitcnt lgkmcnt(0)
    ds_read_b64_tr_b16 v[168:169], v233 offset:0
    ds_read_b64_tr_b16 v[170:171], v233 offset:448
    ds_read_b64_tr_b16 v[172:173], v234 offset:0
    ds_read_b64_tr_b16 v[174:175], v234 offset:448
    ds_read_b64_tr_b16 v[176:177], v233 offset:1792
    ds_read_b64_tr_b16 v[178:179], v233 offset:2240
    ds_read_b64_tr_b16 v[180:181], v234 offset:1792
    ds_read_b64_tr_b16 v[182:183], v234 offset:2240
    s_waitcnt lgkmcnt(4)
    v_mfma_f32_32x32x16_bf16 v[8:23], v[168:171], v[172:175], 0
    ds_read_b64_tr_b16 v[168:169], v233 offset:3584
    ds_read_b64_tr_b16 v[170:171], v233 offset:4032
    ds_read_b64_tr_b16 v[172:173], v234 offset:3584
    ds_read_b64_tr_b16 v[174:175], v234 offset:4032
    s_waitcnt lgkmcnt(4)
    v_mfma_f32_32x32x16_bf16 v[8:23], v[176:179], v[180:183], v[8:23]
    ds_read_b64_tr_b16 v[176:177], v233 offset:5376
    ds_read_b64_tr_b16 v[178:179], v233 offset:5824
    ds_read_b64_tr_b16 v[180:181], v234 offset:5376
    ds_read_b64_tr_b16 v[182:183], v234 offset:5824
    s_waitcnt lgkmcnt(4)
    v_mfma_f32_32x32x16_bf16 v[24:39], v[168:171], v[172:175], 0
    ds_read_b64_tr_b16 v[168:169], v233 offset:7168
    ds_read_b64_tr_b16 v[170:171], v233 offset:7616
    ds_read_b64_tr_b16 v[172:173], v234 offset:7168
    ds_read_b64_tr_b16 v[174:175], v234 offset:7616
    s_waitcnt lgkmcnt(4)
    v_mfma_f32_32x32x16_bf16 v[24:39], v[176:179], v[180:183], v[24:39]
    ds_read_b64_tr_b16 v[176:177], v233 offset:8960
    ds_read_b64_tr_b16 v[178:179], v233 offset:9408
    ds_read_b64_tr_b16 v[180:181], v234 offset:8960
    ds_read_b64_tr_b16 v[182:183], v234 offset:9408
    s_waitcnt lgkmcnt(4)
    v_mfma_f32_32x32x16_bf16 v[40:55], v[168:171], v[172:175], 0
    ds_read_b64_tr_b16 v[168:169], v233 offset:10752
    ds_read_b64_tr_b16 v[170:171], v233 offset:11200
    ds_read_b64_tr_b16 v[172:173], v234 offset:10752
    ds_read_b64_tr_b16 v[174:175], v234 offset:11200
    s_waitcnt lgkmcnt(4)
    v_mfma_f32_32x32x16_bf16 v[40:55], v[176:179], v[180:183], v[40:55]
    ds_read_b64_tr_b16 v[176:177], v233 offset:12544
    ds_read_b64_tr_b16 v[178:179], v233 offset:12992
    ds_read_b64_tr_b16 v[180:181], v234 offset:12544
    ds_read_b64_tr_b16 v[182:183], v234 offset:12992
    s_waitcnt lgkmcnt(4)
    v_mfma_f32_32x32x16_bf16 v[56:71], v[168:171], v[172:175], 0
    s_waitcnt lgkmcnt(0)
    v_mfma_f32_32x32x16_bf16 v[56:71], v[176:179], v[180:183], v[56:71]
    ds_write_b64 v244, v[6:7] offset:0
    ds_write_b64 v244, v[6:7] offset:3584
    ds_write_b64 v244, v[6:7] offset:7168
    ds_write_b64 v244, v[6:7] offset:10752
    ds_write_b128 v232, v[104:107] offset:64
    ds_write_b128 v232, v[108:111] offset:3648
    ds_write_b128 v232, v[120:123] offset:7232
    ds_write_b128 v232, v[124:127] offset:10816
    s_waitcnt lgkmcnt(0)
    v_mfma_f32_32x32x16_bf16 v[136:151], v[216:219], v[72:75], 0
    v_mfma_f32_32x32x16_bf16 v[152:167], v[220:223], v[76:79], 0
    v_mfma_f32_32x32x16_bf16 v[104:119], v[224:227], v[88:91], 0
    v_mfma_f32_32x32x16_bf16 v[120:135], v[228:231], v[92:95], 0
    s_nop 8
    v_max3_f32 v184, v136, v137, v138
    v_max3_f32 v188, v152, v153, v154
    v_max3_f32 v192, v104, v105, v106
    v_max3_f32 v204, v120, v121, v122
    v_max3_f32 v185, v144, v145, v146
    v_max3_f32 v189, v160, v161, v162
    v_max3_f32 v193, v112, v113, v114
    v_max3_f32 v205, v128, v129, v130
    v_max3_f32 v186, v139, v140, v141
    v_max3_f32 v190, v155, v156, v157
    v_max3_f32 v194, v107, v108, v109
    v_max3_f32 v206, v123, v124, v125
    v_max3_f32 v187, v147, v148, v149
    v_max3_f32 v191, v163, v164, v165
    v_max3_f32 v195, v115, v116, v117
    v_max3_f32 v207, v131, v132, v133
    v_max3_f32 v184, v142, v143, v184
    v_max3_f32 v188, v158, v159, v188
    v_max3_f32 v192, v110, v111, v192
    v_max3_f32 v204, v126, v127, v204
    v_max3_f32 v185, v150, v151, v185
    v_max3_f32 v189, v166, v167, v189
    v_max3_f32 v193, v118, v119, v193
    v_max3_f32 v205, v134, v135, v205
    v_max_f32 v184, v184, v186
    v_max_f32 v188, v188, v190
    v_max_f32 v192, v192, v194
    v_max_f32 v204, v204, v206
    v_max_f32 v185, v185, v187
    v_max_f32 v189, v189, v191
    v_max_f32 v193, v193, v195
    v_max_f32 v205, v205, v207
    v_permlane32_swap_b32 v184, v185
    v_permlane32_swap_b32 v188, v189
    v_permlane32_swap_b32 v192, v193
    v_permlane32_swap_b32 v204, v205
    v_max_f32 v184, v184, v185
    v_max_f32 v188, v188, v189
    v_max_f32 v192, v192, v193
    v_max_f32 v204, v204, v205
    v_mul_f32 v184, v214, v184
    v_mul_f32 v188, v214, v188
    v_mul_f32 v192, v214, v192
    v_mul_f32 v204, v214, v204
    v_mov_b32 v185, v184
    v_mov_b32 v189, v188
    v_mov_b32 v193, v192
    v_mov_b32 v205, v204
    v_permlane32_swap_b32 v184, v185
    v_permlane32_swap_b32 v188, v189
    v_permlane32_swap_b32 v192, v193
    v_permlane32_swap_b32 v204, v205
    v_fma_f32 v136, v136, v214, -v184
    v_fma_f32 v152, v152, v214, -v188
    v_fma_f32 v104, v104, v214, -v192
    v_fma_f32 v120, v120, v214, -v204
    v_fma_f32 v137, v137, v214, -v184
    v_fma_f32 v153, v153, v214, -v188
    v_fma_f32 v105, v105, v214, -v192
    v_fma_f32 v121, v121, v214, -v204
    v_fma_f32 v138, v138, v214, -v184
    v_fma_f32 v154, v154, v214, -v188
    v_fma_f32 v106, v106, v214, -v192
    v_fma_f32 v122, v122, v214, -v204
    v_fma_f32 v139, v139, v214, -v184
    v_fma_f32 v155, v155, v214, -v188
    v_fma_f32 v107, v107, v214, -v192
    v_fma_f32 v123, v123, v214, -v204
    v_fma_f32 v140, v140, v214, -v184
    v_fma_f32 v156, v156, v214, -v188
    v_fma_f32 v108, v108, v214, -v192
    v_fma_f32 v124, v124, v214, -v204
    v_fma_f32 v141, v141, v214, -v184
    v_fma_f32 v157, v157, v214, -v188
    v_fma_f32 v109, v109, v214, -v192
    v_fma_f32 v125, v125, v214, -v204
    v_fma_f32 v142, v142, v214, -v184
    v_fma_f32 v158, v158, v214, -v188
    v_fma_f32 v110, v110, v214, -v192
    v_fma_f32 v126, v126, v214, -v204
    v_fma_f32 v143, v143, v214, -v184
    v_fma_f32 v159, v159, v214, -v188
    v_fma_f32 v111, v111, v214, -v192
    v_fma_f32 v127, v127, v214, -v204
    v_fma_f32 v144, v144, v214, -v185
    v_fma_f32 v160, v160, v214, -v189
    v_fma_f32 v112, v112, v214, -v193
    v_fma_f32 v128, v128, v214, -v205
    v_fma_f32 v145, v145, v214, -v185
    v_fma_f32 v161, v161, v214, -v189
    v_fma_f32 v113, v113, v214, -v193
    v_fma_f32 v129, v129, v214, -v205
    v_fma_f32 v146, v146, v214, -v185
    v_fma_f32 v162, v162, v214, -v189
    v_fma_f32 v114, v114, v214, -v193
    v_fma_f32 v130, v130, v214, -v205
    v_fma_f32 v147, v147, v214, -v185
    v_fma_f32 v163, v163, v214, -v189
    v_fma_f32 v115, v115, v214, -v193
    v_fma_f32 v131, v131, v214, -v205
    v_fma_f32 v148, v148, v214, -v185
    v_fma_f32 v164, v164, v214, -v189
    v_fma_f32 v116, v116, v214, -v193
    v_fma_f32 v132, v132, v214, -v205
    v_fma_f32 v149, v149, v214, -v185
    v_fma_f32 v165, v165, v214, -v189
    v_fma_f32 v117, v117, v214, -v193
    v_fma_f32 v133, v133, v214, -v205
    v_fma_f32 v150, v150, v214, -v185
    v_fma_f32 v166, v166, v214, -v189
    v_fma_f32 v118, v118, v214, -v193
    v_fma_f32 v134, v134, v214, -v205
    v_fma_f32 v151, v151, v214, -v185
    v_fma_f32 v167, v167, v214, -v189
    v_fma_f32 v119, v119, v214, -v193
    v_fma_f32 v135, v135, v214, -v205
    v_exp_f32 v136, v136
    v_exp_f32 v152, v152
    v_exp_f32 v104, v104
    v_exp_f32 v120, v120
    v_exp_f32 v137, v137
    v_exp_f32 v153, v153
    v_exp_f32 v105, v105
    v_exp_f32 v121, v121
    v_exp_f32 v138, v138
    v_exp_f32 v154, v154
    v_exp_f32 v106, v106
    v_exp_f32 v122, v122
    v_exp_f32 v139, v139
    v_exp_f32 v155, v155
    v_exp_f32 v107, v107
    v_exp_f32 v123, v123
    v_exp_f32 v140, v140
    v_exp_f32 v156, v156
    v_exp_f32 v108, v108
    v_exp_f32 v124, v124
    v_exp_f32 v141, v141
    v_exp_f32 v157, v157
    v_exp_f32 v109, v109
    v_exp_f32 v125, v125
    v_exp_f32 v142, v142
    v_exp_f32 v158, v158
    v_exp_f32 v110, v110
    v_exp_f32 v126, v126
    v_exp_f32 v143, v143
    v_exp_f32 v159, v159
    v_exp_f32 v111, v111
    v_exp_f32 v127, v127
    v_exp_f32 v144, v144
    v_exp_f32 v160, v160
    v_exp_f32 v112, v112
    v_exp_f32 v128, v128
    v_exp_f32 v145, v145
    v_exp_f32 v161, v161
    v_exp_f32 v113, v113
    v_exp_f32 v129, v129
    v_exp_f32 v146, v146
    v_exp_f32 v162, v162
    v_exp_f32 v114, v114
    v_exp_f32 v130, v130
    v_exp_f32 v147, v147
    v_exp_f32 v163, v163
    v_exp_f32 v115, v115
    v_exp_f32 v131, v131
    v_exp_f32 v148, v148
    v_exp_f32 v164, v164
    v_exp_f32 v116, v116
    v_exp_f32 v132, v132
    v_exp_f32 v149, v149
    v_exp_f32 v165, v165
    v_exp_f32 v117, v117
    v_exp_f32 v133, v133
    v_exp_f32 v150, v150
    v_exp_f32 v166, v166
    v_exp_f32 v118, v118
    v_exp_f32 v134, v134
    v_exp_f32 v151, v151
    v_exp_f32 v167, v167
    v_exp_f32 v119, v119
    v_exp_f32 v135, v135
    v_add_f32 v184, v136, v137
    v_add_f32 v188, v152, v153
    v_add_f32 v192, v104, v105
    v_add_f32 v204, v120, v121
    v_add_f32 v185, v144, v145
    v_add_f32 v189, v160, v161
    v_add_f32 v193, v112, v113
    v_add_f32 v205, v128, v129
    v_add_f32 v186, v138, v139
    v_add_f32 v190, v154, v155
    v_add_f32 v194, v106, v107
    v_add_f32 v206, v122, v123
    v_add_f32 v187, v146, v147
    v_add_f32 v191, v162, v163
    v_add_f32 v195, v114, v115
    v_add_f32 v207, v130, v131
    v_add_f32 v184, v184, v140
    v_add_f32 v188, v188, v156
    v_add_f32 v192, v192, v108
    v_add_f32 v204, v204, v124
    v_add_f32 v185, v185, v148
    v_add_f32 v189, v189, v164
    v_add_f32 v193, v193, v116
    v_add_f32 v205, v205, v132
    v_add_f32 v186, v186, v141
    v_add_f32 v190, v190, v157
    v_add_f32 v194, v194, v109
    v_add_f32 v206, v206, v125
    v_add_f32 v187, v187, v149
    v_add_f32 v191, v191, v165
    v_add_f32 v195, v195, v117
    v_add_f32 v207, v207, v133
    v_add_f32 v184, v184, v142
    v_add_f32 v188, v188, v158
    v_add_f32 v192, v192, v110
    v_add_f32 v204, v204, v126
    v_add_f32 v185, v185, v150
    v_add_f32 v189, v189, v166
    v_add_f32 v193, v193, v118
    v_add_f32 v205, v205, v134
    v_add_f32 v186, v186, v143
    v_add_f32 v190, v190, v159
    v_add_f32 v194, v194, v111
    v_add_f32 v206, v206, v127
    v_add_f32 v187, v187, v151
    v_add_f32 v191, v191, v167
    v_add_f32 v195, v195, v119
    v_add_f32 v207, v207, v135
    v_add_f32 v184, v184, v186
    v_add_f32 v188, v188, v190
    v_add_f32 v192, v192, v194
    v_add_f32 v204, v204, v206
    v_add_f32 v185, v185, v187
    v_add_f32 v189, v189, v191
    v_add_f32 v193, v193, v195
    v_add_f32 v205, v205, v207
    v_permlane32_swap_b32 v184, v185
    v_permlane32_swap_b32 v188, v189
    v_permlane32_swap_b32 v192, v193
    v_permlane32_swap_b32 v204, v205
    v_add_f32 v184, v184, v185
    v_add_f32 v188, v188, v189
    v_add_f32 v192, v192, v193
    v_add_f32 v204, v204, v205
    v_rcp_f32 v184, v184
    v_rcp_f32 v188, v188
    v_rcp_f32 v192, v192
    v_rcp_f32 v204, v204
    v_mul_f32 v184, v184, v215
    v_mul_f32 v188, v188, v215
    v_mul_f32 v192, v192, v215
    v_mul_f32 v204, v204, v215
    v_mov_b32 v185, v184
    v_mov_b32 v189, v188
    v_mov_b32 v193, v192
    v_mov_b32 v205, v204
    v_permlane32_swap_b32 v184, v185
    v_permlane32_swap_b32 v188, v189
    v_permlane32_swap_b32 v192, v193
    v_permlane32_swap_b32 v204, v205
    v_mul_f32 v136, v136, v184
    v_mul_f32 v152, v152, v188
    v_mul_f32 v104, v104, v192
    v_mul_f32 v120, v120, v204
    v_mul_f32 v137, v137, v184
    v_mul_f32 v153, v153, v188
    v_mul_f32 v105, v105, v192
    v_mul_f32 v121, v121, v204
    v_mul_f32 v138, v138, v184
    v_mul_f32 v154, v154, v188
    v_mul_f32 v106, v106, v192
    v_mul_f32 v122, v122, v204
    v_mul_f32 v139, v139, v184
    v_mul_f32 v155, v155, v188
    v_mul_f32 v107, v107, v192
    v_mul_f32 v123, v123, v204
    v_mul_f32 v140, v140, v184
    v_mul_f32 v156, v156, v188
    v_mul_f32 v108, v108, v192
    v_mul_f32 v124, v124, v204
    v_mul_f32 v141, v141, v184
    v_mul_f32 v157, v157, v188
    v_mul_f32 v109, v109, v192
    v_mul_f32 v125, v125, v204
    v_mul_f32 v142, v142, v184
    v_mul_f32 v158, v158, v188
    v_mul_f32 v110, v110, v192
    v_mul_f32 v126, v126, v204
    v_mul_f32 v143, v143, v184
    v_mul_f32 v159, v159, v188
    v_mul_f32 v111, v111, v192
    v_mul_f32 v127, v127, v204
    v_mul_f32 v144, v144, v185
    v_mul_f32 v160, v160, v189
    v_mul_f32 v112, v112, v193
    v_mul_f32 v128, v128, v205
    v_mul_f32 v145, v145, v185
    v_mul_f32 v161, v161, v189
    v_mul_f32 v113, v113, v193
    v_mul_f32 v129, v129, v205
    v_mul_f32 v146, v146, v185
    v_mul_f32 v162, v162, v189
    v_mul_f32 v114, v114, v193
    v_mul_f32 v130, v130, v205
    v_mul_f32 v147, v147, v185
    v_mul_f32 v163, v163, v189
    v_mul_f32 v115, v115, v193
    v_mul_f32 v131, v131, v205
    v_mul_f32 v148, v148, v185
    v_mul_f32 v164, v164, v189
    v_mul_f32 v116, v116, v193
    v_mul_f32 v132, v132, v205
    v_mul_f32 v149, v149, v185
    v_mul_f32 v165, v165, v189
    v_mul_f32 v117, v117, v193
    v_mul_f32 v133, v133, v205
    v_mul_f32 v150, v150, v185
    v_mul_f32 v166, v166, v189
    v_mul_f32 v118, v118, v193
    v_mul_f32 v134, v134, v205
    v_mul_f32 v151, v151, v185
    v_mul_f32 v167, v167, v189
    v_mul_f32 v119, v119, v193
    v_mul_f32 v135, v135, v205
    v_cvt_pk_bf16_f32 v136, v136, v137
    v_cvt_pk_bf16_f32 v152, v152, v153
    v_cvt_pk_bf16_f32 v104, v104, v105
    v_cvt_pk_bf16_f32 v120, v120, v121
    v_cvt_pk_bf16_f32 v137, v138, v139
    v_cvt_pk_bf16_f32 v153, v154, v155
    v_cvt_pk_bf16_f32 v105, v106, v107
    v_cvt_pk_bf16_f32 v121, v122, v123
    v_cvt_pk_bf16_f32 v138, v140, v141
    v_cvt_pk_bf16_f32 v154, v156, v157
    v_cvt_pk_bf16_f32 v106, v108, v109
    v_cvt_pk_bf16_f32 v122, v124, v125
    v_cvt_pk_bf16_f32 v139, v142, v143
    v_cvt_pk_bf16_f32 v155, v158, v159
    v_cvt_pk_bf16_f32 v107, v110, v111
    v_cvt_pk_bf16_f32 v123, v126, v127
    v_cvt_pk_bf16_f32 v140, v144, v145
    v_cvt_pk_bf16_f32 v156, v160, v161
    v_cvt_pk_bf16_f32 v108, v112, v113
    v_cvt_pk_bf16_f32 v124, v128, v129
    v_cvt_pk_bf16_f32 v141, v146, v147
    v_cvt_pk_bf16_f32 v157, v162, v163
    v_cvt_pk_bf16_f32 v109, v114, v115
    v_cvt_pk_bf16_f32 v125, v130, v131
    v_cvt_pk_bf16_f32 v142, v148, v149
    v_cvt_pk_bf16_f32 v158, v164, v165
    v_cvt_pk_bf16_f32 v110, v116, v117
    v_cvt_pk_bf16_f32 v126, v132, v133
    v_cvt_pk_bf16_f32 v143, v150, v151
    v_cvt_pk_bf16_f32 v159, v166, v167
    v_cvt_pk_bf16_f32 v111, v118, v119
    v_cvt_pk_bf16_f32 v127, v134, v135
    ds_write_b128 v232, v[136:139] offset:0
    ds_write_b128 v232, v[152:155] offset:3584
    ds_write_b128 v232, v[104:107] offset:7168
    ds_write_b128 v232, v[120:123] offset:10752
    ds_write_b128 v232, v[140:143] offset:32
    ds_write_b128 v232, v[156:159] offset:3616
    ds_write_b128 v232, v[108:111] offset:7200
    ds_write_b128 v232, v[124:127] offset:10784
    v_and_b32 v244, 31, v0
    v_min_u32 v244, 16, v244
    v_lshrrev_b32 v235, 5, v0
    v_mad_u32_u24 v244, v235, 17, v244
    v_lshlrev_b32 v244, 4, v244
    s_mul_i32 s78, s68, 15360
    s_add_u32 s78, s78, 53376
    v_add_u32 v244, s78, v244
    v_mov_b32 v241, 163776
    v_mov_b32 v242, 1
    s_waitcnt lgkmcnt(0)
    ds_read_b64_tr_b16 v[168:169], v233 offset:0
    ds_read_b64_tr_b16 v[170:171], v233 offset:448
    ds_read_b64_tr_b16 v[172:173], v234 offset:0
    ds_read_b64_tr_b16 v[174:175], v234 offset:448
    ds_read_b64_tr_b16 v[176:177], v233 offset:1792
    ds_read_b64_tr_b16 v[178:179], v233 offset:2240
    ds_read_b64_tr_b16 v[180:181], v234 offset:1792
    ds_read_b64_tr_b16 v[182:183], v234 offset:2240
    s_waitcnt lgkmcnt(4)
    v_mfma_f32_32x32x16_bf16 v[8:23], v[168:171], v[172:175], v[8:23]
    ds_read_b64_tr_b16 v[168:169], v233 offset:3584
    ds_read_b64_tr_b16 v[170:171], v233 offset:4032
    ds_read_b64_tr_b16 v[172:173], v234 offset:3584
    ds_read_b64_tr_b16 v[174:175], v234 offset:4032
    s_waitcnt lgkmcnt(4)
    v_mfma_f32_32x32x16_bf16 v[8:23], v[176:179], v[180:183], v[8:23]
    ds_read_b64_tr_b16 v[176:177], v233 offset:5376
    ds_read_b64_tr_b16 v[178:179], v233 offset:5824
    ds_read_b64_tr_b16 v[180:181], v234 offset:5376
    ds_read_b64_tr_b16 v[182:183], v234 offset:5824
    s_waitcnt lgkmcnt(4)
    v_mfma_f32_32x32x16_bf16 v[24:39], v[168:171], v[172:175], v[24:39]
    ds_read_b64_tr_b16 v[168:169], v233 offset:7168
    ds_read_b64_tr_b16 v[170:171], v233 offset:7616
    ds_read_b64_tr_b16 v[172:173], v234 offset:7168
    ds_read_b64_tr_b16 v[174:175], v234 offset:7616
    s_waitcnt lgkmcnt(4)
    v_mfma_f32_32x32x16_bf16 v[24:39], v[176:179], v[180:183], v[24:39]
    ds_read_b64_tr_b16 v[176:177], v233 offset:8960
    ds_read_b64_tr_b16 v[178:179], v233 offset:9408
    ds_read_b64_tr_b16 v[180:181], v234 offset:8960
    ds_read_b64_tr_b16 v[182:183], v234 offset:9408
    s_waitcnt lgkmcnt(4)
    v_mfma_f32_32x32x16_bf16 v[40:55], v[168:171], v[172:175], v[40:55]
    ds_read_b64_tr_b16 v[168:169], v233 offset:10752
    ds_read_b64_tr_b16 v[170:171], v233 offset:11200
    ds_read_b64_tr_b16 v[172:173], v234 offset:10752
    ds_read_b64_tr_b16 v[174:175], v234 offset:11200
    s_waitcnt lgkmcnt(4)
    v_mfma_f32_32x32x16_bf16 v[40:55], v[176:179], v[180:183], v[40:55]
    ds_read_b64_tr_b16 v[176:177], v233 offset:12544
    ds_read_b64_tr_b16 v[178:179], v233 offset:12992
    ds_read_b64_tr_b16 v[180:181], v234 offset:12544
    ds_read_b64_tr_b16 v[182:183], v234 offset:12992
    s_waitcnt lgkmcnt(4)
    v_mfma_f32_32x32x16_bf16 v[56:71], v[168:171], v[172:175], v[56:71]
    s_waitcnt lgkmcnt(0)
    v_mfma_f32_32x32x16_bf16 v[56:71], v[176:179], v[180:183], v[56:71]
    ds_write_b128 v244, v[8:11] offset:0
    ds_write_b128 v244, v[12:15] offset:544
    ds_write_b128 v244, v[16:19] offset:1088
    ds_write_b128 v244, v[20:23] offset:1632
    ds_write_b128 v244, v[24:27] offset:2176
    ds_write_b128 v244, v[28:31] offset:2720
    ds_write_b128 v244, v[32:35] offset:3264
    ds_write_b128 v244, v[36:39] offset:3808
    ds_write_b128 v244, v[40:43] offset:4352
    ds_write_b128 v244, v[44:47] offset:4896
    ds_write_b128 v244, v[48:51] offset:5440
    ds_write_b128 v244, v[52:55] offset:5984
    ds_write_b128 v244, v[56:59] offset:6528
    ds_write_b128 v244, v[60:63] offset:7072
    ds_write_b128 v244, v[64:67] offset:7616
    ds_write_b128 v244, v[68:71] offset:8160
    s_waitcnt lgkmcnt(0)
    s_mov_b64 exec, 1
    ds_add_u32 v241, v242 offset:8
    s_mov_b64 exec, -1
    s_branch p2_gemm
k1_kv_c_cw:
    s_mov_b32 s98, 0
k1_kv_c_cl:
    s_sleep 4
    buffer_load_dword v5, v4, s[64:67], 0 offen sc1
    s_waitcnt vmcnt(0)
    v_cmp_gt_u32 vcc, 16, v5
    s_add_u32 s98, s98, 1
    s_cmp_gt_u32 s98, 0x8000
    s_cbranch_scc1 k1_kv_c_cok
    s_and_b32 s78, vcc_lo, 0xffff
    s_cbranch_scc1 k1_kv_c_cl
    s_branch k1_kv_c_cok
k1_q:
    s_sub_u32 s78, s69, 28
    s_lshl_b32 s72, s70, 2
    s_add_u32 s72, s72, s78
    s_mov_b32 s73, s71
    s_lshl_b32 s79, s72, 17
    s_lshl_b32 s91, s71, 9
    s_cmp_lt_u32 s68, 4
    s_cbranch_scc1 k1_q_c
    s_sub_u32 s74, s68, 4
    s_lshr_b32 s62, s69, 2
    s_add_u32 s62, s62, s69
    v_lshrrev_b32 v8, 3, v0
    v_and_b32 v9, 7, v0
    s_lshl_b32 s78, s74, 3
    v_add_u32 v10, s78, v8
    v_bfe_u32 v11, v10, 1, 3
    v_xor_b32 v11, v11, v9
    v_lshlrev_b32 v11, 4, v11
    v_lshl_add_u32 v16, v10, 10, v11
    s_lshl_b32 s77, s74, 10
    v_and_b32 v11, 2, v8
    v_lshlrev_b32 v11, 1, v11
    v_xor_b32 v11, v11, v9
    v_lshlrev_b32 v11, 4, v11
    s_mov_b32 s80, 3072
    v_mad_u32_u24 v17, v10, s80, v11
    v_add_u32 v17, s91, v17
    s_waitcnt lgkmcnt(0)
    s_add_u32 s24, s4, s79
    s_addc_u32 s25, s5, 0
    s_and_b32 s25, s25, 0xffff
    s_mov_b32 s26, 131072
    s_mov_b32 s27, 0x20000
    s_mov_b32 s28, s6
    s_and_b32 s29, s7, 0xffff
    s_mov_b32 s30, 1572864
    s_mov_b32 s31, 0x20000
    s_mov_b32 s44, s4
    s_and_b32 s45, s5, 0xffff
    s_mov_b32 s46, 2097152
    s_mov_b32 s47, 0x20000
    s_lshl_b32 s85, s2, 2
    s_add_u32 s85, s85, s74
    s_lshl_b32 s78, s85, 11
    buffer_load_dwordx4 v[20:23], v4, s[44:47], s78 offen
    buffer_load_dwordx4 v[24:27], v4, s[44:47], s78 offen offset:1024
    s_and_b32 s78, s62, 0
    s_xor_b32 s78, s78, 0
    s_lshl_b32 s63, s78, 7
    s_mul_i32 s87, s78, 196608
    s_add_u32 m0, s77, 0
    s_add_u32 s78, s63, 0
    buffer_load_dwordx4 v16, s[24:27], s78 offen lds
    s_add_u32 m0, s77, 4096
    s_add_u32 s78, s63, 32768
    buffer_load_dwordx4 v16, s[24:27], s78 offen lds
    s_add_u32 m0, s77, 8192
    s_add_u32 s78, s63, 65536
    buffer_load_dwordx4 v16, s[24:27], s78 offen lds
    s_add_u32 m0, s77, 12288
    s_add_u32 s78, s63, 98304
    buffer_load_dwordx4 v16, s[24:27], s78 offen lds
    s_add_u32 m0, s77, 16384
    s_add_u32 s78, s87, 0
    buffer_load_dwordx4 v17, s[28:31], s78 offen lds
    s_add_u32 m0, s77, 20480
    s_add_u32 s78, s87, 98304
    buffer_load_dwordx4 v17, s[28:31], s78 offen lds
    s_add_u32 m0, s77, 24576
    s_add_u32 s78, s87, 128
    buffer_load_dwordx4 v17, s[28:31], s78 offen lds
    s_add_u32 m0, s77, 28672
    s_add_u32 s78, s87, 98432
    buffer_load_dwordx4 v17, s[28:31], s78 offen lds
    s_add_u32 m0, s77, 32768
    s_add_u32 s78, s87, 256
    buffer_load_dwordx4 v17, s[28:31], s78 offen lds
    s_add_u32 m0, s77, 36864
    s_add_u32 s78, s87, 98560
    buffer_load_dwordx4 v17, s[28:31], s78 offen lds
    s_add_u32 m0, s77, 40960
    s_add_u32 s78, s87, 384
    buffer_load_dwordx4 v17, s[28:31], s78 offen lds
    s_add_u32 m0, s77, 45056
    s_add_u32 s78, s87, 98688
    buffer_load_dwordx4 v17, s[28:31], s78 offen lds
    s_lshl_b32 s92, s70, 1
    s_add_u32 s92, s92, s71
    s_mov_b32 s64, s20
    s_and_b32 s65, s21, 0xffff
    s_mov_b32 s66, 256
    s_mov_b32 s67, 0x20000
    s_add_u32 s56, s22, 11534336
    s_addc_u32 s57, s23, 0
    s_and_b32 s57, s57, 0xffff
    s_mov_b32 s58, 81920
    s_mov_b32 s59, 0x20000
    s_and_b32 s93, s69, 3
    s_lshr_b32 s94, s69, 2
    s_mul_i32 s95, s94, 1
    s_mul_i32 s78, s93, 6
    s_add_u32 s95, s95, s78
    s_sub_u32 s78, s95, 22
    s_cmp_ge_u32 s95, 22
    s_cselect_b32 s95, s78, s95
    s_add_u32 s96, s95, 0
    s_sub_u32 s78, s96, 22
    s_cmp_ge_u32 s96, 22
    s_cselect_b32 s96, s78, s96
    s_lshl_b32 s95, s95, 12
    s_lshl_b32 s96, s96, 16
    s_lshl_b32 s78, s92, 2
    s_add_u32 s93, s93, s78
    s_mul_i32 s97, s74, 8192
    s_add_u32 s97, s97, 114944
    s_mul_i32 s60, s74, 12288
    s_add_u32 s60, s60, 0
    s_mul_i32 s61, s74, 10240
    s_add_u32 s61, s61, 53376
    s_add_u32 s48, s22, 9437184
    s_addc_u32 s49, s23, 0
    s_and_b32 s49, s49, 0xffff
    s_mov_b32 s50, 2097152
    s_mov_b32 s51, 0x20000
    s_lshl_b32 s78, s92, 3
    s_lshl_b32 s79, s74, 1
    s_add_u32 s78, s78, s79
    s_lshl_b32 s90, s78, 15
    s_add_u32 s91, s90, 32768
    s_lshl_b32 s89, s69, 10
    s_mov_b32 s36, s8
    s_and_b32 s37, s9, 0xffff
    s_mov_b32 s38, 16384
    s_mov_b32 s39, 0x20000
    s_mov_b32 s78, 0x10000
    s_lshr_b32 s79, s89, 1
    s_cmp_eq_u32 s74, 0
    s_cselect_b32 s78, s79, s78
    s_lshl_b32 s79, s74, 9
    s_add_u32 m0, s79, 160256
    s_cmp_lt_u32 s74, 1
    s_cselect_b32 exec_lo, -1, 1
    s_mov_b32 exec_hi, 0
    s_cselect_b32 m0, m0, 163840
    s_nop 0
    buffer_load_dwordx4 v4, s[36:39], s78 offen lds
    s_mov_b64 exec, -1
    v_mov_b32 v36, 0xffff0000
    v_mov_b32 v7, 0
    v_mov_b32 v6, 1
    v_mov_b32 v5, 163776
    v_mov_b32 v28, -1
    v_mov_b32 v29, -1
    v_mov_b32 v30, -1
    v_mov_b32 v31, -1
    ds_write_b32 v5, v7 offset:0
    ds_write_b32 v5, v7 offset:4
    ds_write_b32 v5, v7 offset:8
    ds_write_b32 v5, v7 offset:12
    ds_write_b32 v5, v7 offset:16
    ds_write_b32 v5, v7 offset:32
    ds_write_b32 v5, v7 offset:36
    ds_write_b32 v5, v7 offset:40
    ds_write_b32 v5, v7 offset:44
    ds_write_b32 v5, v7 offset:48
    ds_write_b32 v5, v7 offset:52
    ds_write_b32 v5, v7 offset:56
    ds_write_b32 v5, v7 offset:60
    s_waitcnt lgkmcnt(0)
    s_and_b32 s78, s62, 0
    s_xor_b32 s78, s78, 1
    s_lshl_b32 s63, s78, 7
    s_mul_i32 s87, s78, 196608
    s_add_u32 m0, s77, 49152
    s_add_u32 s78, s63, 0
    buffer_load_dwordx4 v16, s[24:27], s78 offen lds
    s_add_u32 m0, s77, 53248
    s_add_u32 s78, s63, 32768
    buffer_load_dwordx4 v16, s[24:27], s78 offen lds
    s_add_u32 m0, s77, 57344
    s_add_u32 s78, s63, 65536
    buffer_load_dwordx4 v16, s[24:27], s78 offen lds
    s_add_u32 m0, s77, 61440
    s_add_u32 s78, s63, 98304
    buffer_load_dwordx4 v16, s[24:27], s78 offen lds
    s_add_u32 m0, s77, 65536
    s_add_u32 s78, s87, 0
    buffer_load_dwordx4 v17, s[28:31], s78 offen lds
    s_add_u32 m0, s77, 69632
    s_add_u32 s78, s87, 98304
    buffer_load_dwordx4 v17, s[28:31], s78 offen lds
    s_add_u32 m0, s77, 73728
    s_add_u32 s78, s87, 128
    buffer_load_dwordx4 v17, s[28:31], s78 offen lds
    s_add_u32 m0, s77, 77824
    s_add_u32 s78, s87, 98432
    buffer_load_dwordx4 v17, s[28:31], s78 offen lds
    s_add_u32 m0, s77, 81920
    s_add_u32 s78, s87, 256
    buffer_load_dwordx4 v17, s[28:31], s78 offen lds
    s_add_u32 m0, s77, 86016
    s_add_u32 s78, s87, 98560
    buffer_load_dwordx4 v17, s[28:31], s78 offen lds
    s_add_u32 m0, s77, 90112
    s_add_u32 s78, s87, 384
    buffer_load_dwordx4 v17, s[28:31], s78 offen lds
    s_add_u32 m0, s77, 94208
    s_add_u32 s78, s87, 98688
    buffer_load_dwordx4 v17, s[28:31], s78 offen lds
    s_waitcnt vmcnt(13)
    s_barrier
    s_waitcnt vmcnt(13)
    v_lshlrev_b32 v8, 16, v20
    v_lshlrev_b32 v10, 16, v24
    v_and_b32 v9, v36, v20
    v_and_b32 v11, v36, v24
    v_add_f32 v32, v8, v9
    v_add_f32 v34, v10, v11
    v_mul_f32 v33, v8, v8
    v_mul_f32 v35, v10, v10
    v_fmac_f32 v33, v9, v9
    v_fmac_f32 v35, v11, v11
    v_lshlrev_b32 v8, 16, v21
    v_lshlrev_b32 v10, 16, v25
    v_and_b32 v9, v36, v21
    v_and_b32 v11, v36, v25
    v_add_f32 v32, v32, v8
    v_add_f32 v34, v34, v10
    v_fmac_f32 v33, v8, v8
    v_fmac_f32 v35, v10, v10
    v_add_f32 v32, v32, v9
    v_add_f32 v34, v34, v11
    v_fmac_f32 v33, v9, v9
    v_fmac_f32 v35, v11, v11
    v_lshlrev_b32 v8, 16, v22
    v_lshlrev_b32 v10, 16, v26
    v_and_b32 v9, v36, v22
    v_and_b32 v11, v36, v26
    v_add_f32 v32, v32, v8
    v_add_f32 v34, v34, v10
    v_fmac_f32 v33, v8, v8
    v_fmac_f32 v35, v10, v10
    v_add_f32 v32, v32, v9
    v_add_f32 v34, v34, v11
    v_fmac_f32 v33, v9, v9
    v_fmac_f32 v35, v11, v11
    v_lshlrev_b32 v8, 16, v23
    v_lshlrev_b32 v10, 16, v27
    v_and_b32 v9, v36, v23
    v_and_b32 v11, v36, v27
    v_add_f32 v32, v32, v8
    v_add_f32 v34, v34, v10
    v_fmac_f32 v33, v8, v8
    v_fmac_f32 v35, v10, v10
    v_add_f32 v32, v32, v9
    v_add_f32 v34, v34, v11
    v_fmac_f32 v33, v9, v9
    v_fmac_f32 v35, v11, v11
    v_add_f32 v32, v32, v32 row_ror:8 row_mask:0xf bank_mask:0xf
    v_add_f32 v34, v34, v34 row_ror:8 row_mask:0xf bank_mask:0xf
    v_add_f32 v33, v33, v33 row_ror:8 row_mask:0xf bank_mask:0xf
    v_add_f32 v35, v35, v35 row_ror:8 row_mask:0xf bank_mask:0xf
    v_add_f32 v32, v32, v32 row_ror:4 row_mask:0xf bank_mask:0xf
    v_add_f32 v34, v34, v34 row_ror:4 row_mask:0xf bank_mask:0xf
    v_add_f32 v33, v33, v33 row_ror:4 row_mask:0xf bank_mask:0xf
    v_add_f32 v35, v35, v35 row_ror:4 row_mask:0xf bank_mask:0xf
    v_add_f32 v32, v32, v32 row_ror:2 row_mask:0xf bank_mask:0xf
    v_add_f32 v34, v34, v34 row_ror:2 row_mask:0xf bank_mask:0xf
    v_add_f32 v33, v33, v33 row_ror:2 row_mask:0xf bank_mask:0xf
    v_add_f32 v35, v35, v35 row_ror:2 row_mask:0xf bank_mask:0xf
    v_add_f32 v32, v32, v32 row_ror:1 row_mask:0xf bank_mask:0xf
    v_add_f32 v34, v34, v34 row_ror:1 row_mask:0xf bank_mask:0xf
    v_add_f32 v33, v33, v33 row_ror:1 row_mask:0xf bank_mask:0xf
    v_add_f32 v35, v35, v35 row_ror:1 row_mask:0xf bank_mask:0xf
    v_mov_b32 v8, v32
    v_mov_b32 v10, v34
    v_mov_b32 v9, v33
    v_mov_b32 v11, v35
    v_permlane16_swap_b32 v32, v8
    v_permlane16_swap_b32 v34, v10
    v_permlane16_swap_b32 v33, v9
    v_permlane16_swap_b32 v35, v11
    v_add_f32 v32, v32, v8
    v_add_f32 v34, v34, v10
    v_add_f32 v33, v33, v9
    v_add_f32 v35, v35, v11
    v_mov_b32 v8, v32
    v_mov_b32 v10, v34
    v_mov_b32 v9, v33
    v_mov_b32 v11, v35
    v_permlane32_swap_b32 v32, v8
    v_permlane32_swap_b32 v34, v10
    v_permlane32_swap_b32 v33, v9
    v_permlane32_swap_b32 v35, v11
    v_add_f32 v32, v32, v8
    v_add_f32 v34, v34, v10
    v_add_f32 v33, v33, v9
    v_add_f32 v35, v35, v11
    v_mul_f32 v32, 0xbb000000, v32
    v_mul_f32 v34, 0xbb000000, v34
    v_mul_f32 v33, 0x3b000000, v33
    v_mul_f32 v35, 0x3b000000, v35
    v_fma_f32 v33, -v32, v32, v33
    v_fma_f32 v35, -v34, v34, v35
    v_max_f32 v33, 0, v33
    v_max_f32 v35, 0, v35
    v_add_f32 v33, 0x3727c5ac, v33
    v_add_f32 v35, 0x3727c5ac, v35
    s_lshl_b32 s78, s85, 4
    s_add_u32 s78, s78, 65536
    s_mov_b64 exec, 1
    buffer_store_dwordx2 v[32:33], v7, s[56:59], s78 offen sc1
    buffer_store_dwordx2 v[34:35], v7, s[56:59], s78 offen offset:8 sc1
    s_and_b32 s78, s74, 1
    s_lshl_b32 s3, s72, 1
    s_add_u32 s3, s3, s78
    s_lshl_b32 s3, s3, 6
    s_lshl_b32 s78, s73, 1
    s_add_u32 s3, s3, s78
    s_lshr_b32 s78, s74, 1
    s_add_u32 s3, s3, s78
    s_add_u32 s3, s3, 48
    s_lshl_b32 s3, s3, 2
    buffer_store_dword v7, v7, s[56:59], s3 offen sc1
    s_mov_b64 exec, -1
    s_add_u32 s78, s90, s89
    buffer_store_dwordx4 v[28:31], v4, s[48:51], s78 offen sc1
    s_add_u32 s78, s91, s89
    buffer_store_dwordx4 v[28:31], v4, s[48:51], s78 offen sc1
    s_and_b32 s78, s62, 1
    s_xor_b32 s78, s78, 2
    s_lshl_b32 s63, s78, 7
    s_mul_i32 s87, s78, 196608
    s_add_u32 m0, s77, 98304
    s_add_u32 s78, s63, 0
    buffer_load_dwordx4 v16, s[24:27], s78 offen lds
    s_add_u32 m0, s77, 102400
    s_add_u32 s78, s63, 32768
    buffer_load_dwordx4 v16, s[24:27], s78 offen lds
    s_add_u32 m0, s77, 106496
    s_add_u32 s78, s63, 65536
    buffer_load_dwordx4 v16, s[24:27], s78 offen lds
    s_add_u32 m0, s77, 110592
    s_add_u32 s78, s63, 98304
    buffer_load_dwordx4 v16, s[24:27], s78 offen lds
    s_add_u32 m0, s77, 114688
    s_add_u32 s78, s87, 0
    buffer_load_dwordx4 v17, s[28:31], s78 offen lds
    s_add_u32 m0, s77, 118784
    s_add_u32 s78, s87, 98304
    buffer_load_dwordx4 v17, s[28:31], s78 offen lds
    s_add_u32 m0, s77, 122880
    s_add_u32 s78, s87, 128
    buffer_load_dwordx4 v17, s[28:31], s78 offen lds
    s_add_u32 m0, s77, 126976
    s_add_u32 s78, s87, 98432
    buffer_load_dwordx4 v17, s[28:31], s78 offen lds
    s_add_u32 m0, s77, 131072
    s_add_u32 s78, s87, 256
    buffer_load_dwordx4 v17, s[28:31], s78 offen lds
    s_add_u32 m0, s77, 135168
    s_add_u32 s78, s87, 98560
    buffer_load_dwordx4 v17, s[28:31], s78 offen lds
    s_add_u32 m0, s77, 139264
    s_add_u32 s78, s87, 384
    buffer_load_dwordx4 v17, s[28:31], s78 offen lds
    s_add_u32 m0, s77, 143360
    s_add_u32 s78, s87, 98688
    buffer_load_dwordx4 v17, s[28:31], s78 offen lds
    s_waitcnt vmcnt(17)
    s_barrier
    s_and_b32 s78, s62, 1
    s_xor_b32 s78, s78, 3
    s_lshl_b32 s63, s78, 7
    s_mul_i32 s87, s78, 196608
    s_add_u32 m0, s77, 0
    s_add_u32 s78, s63, 0
    buffer_load_dwordx4 v16, s[24:27], s78 offen lds
    s_add_u32 m0, s77, 4096
    s_add_u32 s78, s63, 32768
    buffer_load_dwordx4 v16, s[24:27], s78 offen lds
    s_add_u32 m0, s77, 8192
    s_add_u32 s78, s63, 65536
    buffer_load_dwordx4 v16, s[24:27], s78 offen lds
    s_add_u32 m0, s77, 12288
    s_add_u32 s78, s63, 98304
    buffer_load_dwordx4 v16, s[24:27], s78 offen lds
    s_add_u32 m0, s77, 16384
    s_add_u32 s78, s87, 0
    buffer_load_dwordx4 v17, s[28:31], s78 offen lds
    s_add_u32 m0, s77, 20480
    s_add_u32 s78, s87, 98304
    buffer_load_dwordx4 v17, s[28:31], s78 offen lds
    s_add_u32 m0, s77, 24576
    s_add_u32 s78, s87, 128
    buffer_load_dwordx4 v17, s[28:31], s78 offen lds
    s_add_u32 m0, s77, 28672
    s_add_u32 s78, s87, 98432
    buffer_load_dwordx4 v17, s[28:31], s78 offen lds
    s_add_u32 m0, s77, 32768
    s_add_u32 s78, s87, 256
    buffer_load_dwordx4 v17, s[28:31], s78 offen lds
    s_add_u32 m0, s77, 36864
    s_add_u32 s78, s87, 98560
    buffer_load_dwordx4 v17, s[28:31], s78 offen lds
    s_add_u32 m0, s77, 40960
    s_add_u32 s78, s87, 384
    buffer_load_dwordx4 v17, s[28:31], s78 offen lds
    s_add_u32 m0, s77, 45056
    s_add_u32 s78, s87, 98688
    buffer_load_dwordx4 v17, s[28:31], s78 offen lds
    s_waitcnt vmcnt(12)
    s_barrier
    s_lshl_b32 s78, s74, 12
    s_and_b32 s79, s2, 15
    s_lshl_b32 s79, s79, 4
    s_add_u32 s78, s78, s79
    s_mov_b64 exec, 1
    buffer_atomic_add v6, v7, s[64:67], s78 offen
    s_mov_b64 exec, -1
    s_and_b32 s78, s62, 3
    s_xor_b32 s78, s78, 4
    s_lshl_b32 s63, s78, 7
    s_mul_i32 s87, s78, 196608
    s_add_u32 m0, s77, 49152
    s_add_u32 s78, s63, 0
    buffer_load_dwordx4 v16, s[24:27], s78 offen lds
    s_add_u32 m0, s77, 53248
    s_add_u32 s78, s63, 32768
    buffer_load_dwordx4 v16, s[24:27], s78 offen lds
    s_add_u32 m0, s77, 57344
    s_add_u32 s78, s63, 65536
    buffer_load_dwordx4 v16, s[24:27], s78 offen lds
    s_add_u32 m0, s77, 61440
    s_add_u32 s78, s63, 98304
    buffer_load_dwordx4 v16, s[24:27], s78 offen lds
    s_add_u32 m0, s77, 65536
    s_add_u32 s78, s87, 0
    buffer_load_dwordx4 v17, s[28:31], s78 offen lds
    s_add_u32 m0, s77, 69632
    s_add_u32 s78, s87, 98304
    buffer_load_dwordx4 v17, s[28:31], s78 offen lds
    s_add_u32 m0, s77, 73728
    s_add_u32 s78, s87, 128
    buffer_load_dwordx4 v17, s[28:31], s78 offen lds
    s_add_u32 m0, s77, 77824
    s_add_u32 s78, s87, 98432
    buffer_load_dwordx4 v17, s[28:31], s78 offen lds
    s_add_u32 m0, s77, 81920
    s_add_u32 s78, s87, 256
    buffer_load_dwordx4 v17, s[28:31], s78 offen lds
    s_add_u32 m0, s77, 86016
    s_add_u32 s78, s87, 98560
    buffer_load_dwordx4 v17, s[28:31], s78 offen lds
    s_add_u32 m0, s77, 90112
    s_add_u32 s78, s87, 384
    buffer_load_dwordx4 v17, s[28:31], s78 offen lds
    s_add_u32 m0, s77, 94208
    s_add_u32 s78, s87, 98688
    buffer_load_dwordx4 v17, s[28:31], s78 offen lds
    s_waitcnt vmcnt(13)
    s_barrier
    s_and_b32 s78, s62, 3
    s_xor_b32 s78, s78, 5
    s_lshl_b32 s63, s78, 7
    s_mul_i32 s87, s78, 196608
    s_add_u32 m0, s77, 98304
    s_add_u32 s78, s63, 0
    buffer_load_dwordx4 v16, s[24:27], s78 offen lds
    s_add_u32 m0, s77, 102400
    s_add_u32 s78, s63, 32768
    buffer_load_dwordx4 v16, s[24:27], s78 offen lds
    s_add_u32 m0, s77, 106496
    s_add_u32 s78, s63, 65536
    buffer_load_dwordx4 v16, s[24:27], s78 offen lds
    s_add_u32 m0, s77, 110592
    s_add_u32 s78, s63, 98304
    buffer_load_dwordx4 v16, s[24:27], s78 offen lds
    s_add_u32 m0, s77, 114688
    s_add_u32 s78, s87, 0
    buffer_load_dwordx4 v17, s[28:31], s78 offen lds
    s_add_u32 m0, s77, 118784
    s_add_u32 s78, s87, 98304
    buffer_load_dwordx4 v17, s[28:31], s78 offen lds
    s_add_u32 m0, s77, 122880
    s_add_u32 s78, s87, 128
    buffer_load_dwordx4 v17, s[28:31], s78 offen lds
    s_add_u32 m0, s77, 126976
    s_add_u32 s78, s87, 98432
    buffer_load_dwordx4 v17, s[28:31], s78 offen lds
    s_add_u32 m0, s77, 131072
    s_add_u32 s78, s87, 256
    buffer_load_dwordx4 v17, s[28:31], s78 offen lds
    s_add_u32 m0, s77, 135168
    s_add_u32 s78, s87, 98560
    buffer_load_dwordx4 v17, s[28:31], s78 offen lds
    s_add_u32 m0, s77, 139264
    s_add_u32 s78, s87, 384
    buffer_load_dwordx4 v17, s[28:31], s78 offen lds
    s_add_u32 m0, s77, 143360
    s_add_u32 s78, s87, 98688
    buffer_load_dwordx4 v17, s[28:31], s78 offen lds
    s_waitcnt vmcnt(12)
    s_barrier
    s_and_b32 s78, s62, 3
    s_xor_b32 s78, s78, 6
    s_lshl_b32 s63, s78, 7
    s_mul_i32 s87, s78, 196608
    s_add_u32 m0, s77, 0
    s_add_u32 s78, s63, 0
    buffer_load_dwordx4 v16, s[24:27], s78 offen lds
    s_add_u32 m0, s77, 4096
    s_add_u32 s78, s63, 32768
    buffer_load_dwordx4 v16, s[24:27], s78 offen lds
    s_add_u32 m0, s77, 8192
    s_add_u32 s78, s63, 65536
    buffer_load_dwordx4 v16, s[24:27], s78 offen lds
    s_add_u32 m0, s77, 12288
    s_add_u32 s78, s63, 98304
    buffer_load_dwordx4 v16, s[24:27], s78 offen lds
    s_add_u32 m0, s77, 16384
    s_add_u32 s78, s87, 0
    buffer_load_dwordx4 v17, s[28:31], s78 offen lds
    s_add_u32 m0, s77, 20480
    s_add_u32 s78, s87, 98304
    buffer_load_dwordx4 v17, s[28:31], s78 offen lds
    s_add_u32 m0, s77, 24576
    s_add_u32 s78, s87, 128
    buffer_load_dwordx4 v17, s[28:31], s78 offen lds
    s_add_u32 m0, s77, 28672
    s_add_u32 s78, s87, 98432
    buffer_load_dwordx4 v17, s[28:31], s78 offen lds
    s_add_u32 m0, s77, 32768
    s_add_u32 s78, s87, 256
    buffer_load_dwordx4 v17, s[28:31], s78 offen lds
    s_add_u32 m0, s77, 36864
    s_add_u32 s78, s87, 98560
    buffer_load_dwordx4 v17, s[28:31], s78 offen lds
    s_add_u32 m0, s77, 40960
    s_add_u32 s78, s87, 384
    buffer_load_dwordx4 v17, s[28:31], s78 offen lds
    s_add_u32 m0, s77, 45056
    s_add_u32 s78, s87, 98688
    buffer_load_dwordx4 v17, s[28:31], s78 offen lds
    s_waitcnt vmcnt(12)
    s_barrier
    s_and_b32 s78, s62, 3
    s_xor_b32 s78, s78, 7
    s_lshl_b32 s63, s78, 7
    s_mul_i32 s87, s78, 196608
    s_add_u32 m0, s77, 49152
    s_add_u32 s78, s63, 0
    buffer_load_dwordx4 v16, s[24:27], s78 offen lds
    s_add_u32 m0, s77, 53248
    s_add_u32 s78, s63, 32768
    buffer_load_dwordx4 v16, s[24:27], s78 offen lds
    s_add_u32 m0, s77, 57344
    s_add_u32 s78, s63, 65536
    buffer_load_dwordx4 v16, s[24:27], s78 offen lds
    s_add_u32 m0, s77, 61440
    s_add_u32 s78, s63, 98304
    buffer_load_dwordx4 v16, s[24:27], s78 offen lds
    s_add_u32 m0, s77, 65536
    s_add_u32 s78, s87, 0
    buffer_load_dwordx4 v17, s[28:31], s78 offen lds
    s_add_u32 m0, s77, 69632
    s_add_u32 s78, s87, 98304
    buffer_load_dwordx4 v17, s[28:31], s78 offen lds
    s_add_u32 m0, s77, 73728
    s_add_u32 s78, s87, 128
    buffer_load_dwordx4 v17, s[28:31], s78 offen lds
    s_add_u32 m0, s77, 77824
    s_add_u32 s78, s87, 98432
    buffer_load_dwordx4 v17, s[28:31], s78 offen lds
    s_add_u32 m0, s77, 81920
    s_add_u32 s78, s87, 256
    buffer_load_dwordx4 v17, s[28:31], s78 offen lds
    s_add_u32 m0, s77, 86016
    s_add_u32 s78, s87, 98560
    buffer_load_dwordx4 v17, s[28:31], s78 offen lds
    s_add_u32 m0, s77, 90112
    s_add_u32 s78, s87, 384
    buffer_load_dwordx4 v17, s[28:31], s78 offen lds
    s_add_u32 m0, s77, 94208
    s_add_u32 s78, s87, 98688
    buffer_load_dwordx4 v17, s[28:31], s78 offen lds
    s_mov_b32 s32, s16
    s_and_b32 s33, s17, 0xffff
    s_mov_b32 s34, 1409024
    s_mov_b32 s35, 0x20000
    v_lshrrev_b32 v8, 3, v0
    v_and_b32 v9, 7, v0
    v_and_b32 v10, 2, v8
    v_lshlrev_b32 v10, 1, v10
    v_xor_b32 v10, v10, v9
    v_lshlrev_b32 v10, 4, v10
    v_lshl_add_u32 v2, v8, 10, v10
    s_lshl_b32 s78, s74, 14
    s_lshl_b32 s79, s94, 7
    s_add_u32 s78, s78, s79
    v_add_u32 v2, s78, v2
    v_add_u32 v3, 8192, v2
    s_waitcnt vmcnt(12)
    s_barrier
    s_add_u32 m0, s97, 0
    s_nop 0
    buffer_load_dwordx4 v2, s[32:35], s96 offen lds
    s_add_u32 m0, s97, 1024
    s_nop 0
    buffer_load_dwordx4 v3, s[32:35], s96 offen lds
    s_add_u32 s96, s96, 65536
    s_cmp_eq_u32 s96, 1441792
    s_cselect_b32 s96, 0, s96
    s_add_u32 m0, s97, 2048
    s_nop 0
    buffer_load_dwordx4 v2, s[32:35], s96 offen lds
    s_add_u32 m0, s97, 3072
    s_nop 0
    buffer_load_dwordx4 v3, s[32:35], s96 offen lds
    s_add_u32 s96, s96, 65536
    s_cmp_eq_u32 s96, 1441792
    s_cselect_b32 s96, 0, s96
    s_add_u32 m0, s97, 4096
    s_nop 0
    buffer_load_dwordx4 v2, s[32:35], s96 offen lds
    s_add_u32 m0, s97, 5120
    s_nop 0
    buffer_load_dwordx4 v3, s[32:35], s96 offen lds
    s_add_u32 s96, s96, 65536
    s_cmp_eq_u32 s96, 1441792
    s_cselect_b32 s96, 0, s96
    s_add_u32 m0, s97, 6144
    s_nop 0
    buffer_load_dwordx4 v2, s[32:35], s96 offen lds
    s_add_u32 m0, s97, 7168
    s_nop 0
    buffer_load_dwordx4 v3, s[32:35], s96 offen lds
    s_add_u32 s96, s96, 65536
    s_cmp_eq_u32 s96, 1441792
    s_cselect_b32 s96, 0, s96
    s_waitcnt vmcnt(0)
    s_barrier
    s_add_u32 m0, s60, 0
    s_nop 0
    buffer_load_dwordx4 v2, s[32:35], s96 offen lds
    s_add_u32 m0, s60, 1024
    s_nop 0
    buffer_load_dwordx4 v3, s[32:35], s96 offen lds
    s_add_u32 s96, s96, 65536
    s_cmp_eq_u32 s96, 1441792
    s_cselect_b32 s96, 0, s96
    s_add_u32 m0, s60, 2048
    s_nop 0
    buffer_load_dwordx4 v2, s[32:35], s96 offen lds
    s_add_u32 m0, s60, 3072
    s_nop 0
    buffer_load_dwordx4 v3, s[32:35], s96 offen lds
    s_add_u32 s96, s96, 65536
    s_cmp_eq_u32 s96, 1441792
    s_cselect_b32 s96, 0, s96
    s_add_u32 m0, s60, 4096
    s_nop 0
    buffer_load_dwordx4 v2, s[32:35], s96 offen lds
    s_add_u32 m0, s60, 5120
    s_nop 0
    buffer_load_dwordx4 v3, s[32:35], s96 offen lds
    s_add_u32 s96, s96, 65536
    s_cmp_eq_u32 s96, 1441792
    s_cselect_b32 s96, 0, s96
    s_add_u32 m0, s60, 6144
    s_nop 0
    buffer_load_dwordx4 v2, s[32:35], s96 offen lds
    s_add_u32 m0, s60, 7168
    s_nop 0
    buffer_load_dwordx4 v3, s[32:35], s96 offen lds
    s_add_u32 s96, s96, 65536
    s_cmp_eq_u32 s96, 1441792
    s_cselect_b32 s96, 0, s96
    s_add_u32 m0, s60, 8192
    s_nop 0
    buffer_load_dwordx4 v2, s[32:35], s96 offen lds
    s_add_u32 m0, s60, 9216
    s_nop 0
    buffer_load_dwordx4 v3, s[32:35], s96 offen lds
    s_add_u32 s96, s96, 65536
    s_cmp_eq_u32 s96, 1441792
    s_cselect_b32 s96, 0, s96
    s_add_u32 m0, s60, 10240
    s_nop 0
    buffer_load_dwordx4 v2, s[32:35], s96 offen lds
    s_add_u32 m0, s60, 11264
    s_nop 0
    buffer_load_dwordx4 v3, s[32:35], s96 offen lds
    s_add_u32 s96, s96, 65536
    s_cmp_eq_u32 s96, 1441792
    s_cselect_b32 s96, 0, s96
    s_barrier
    s_add_u32 s24, s22, 8388608
    s_addc_u32 s25, s23, 0
    s_and_b32 s25, s25, 0xffff
    s_mov_b32 s26, 1048576
    s_mov_b32 s27, 0x20000
    s_add_u32 s28, s22, 6291456
    s_addc_u32 s29, s23, 0
    s_and_b32 s29, s29, 0xffff
    s_mov_b32 s30, 2097152
    s_mov_b32 s31, 0x20000
    s_mov_b32 s82, 1069066811
    s_add_u32 m0, s61, 0
    s_nop 0
    buffer_load_dwordx4 v2, s[32:35], s96 offen lds
    s_add_u32 m0, s61, 1024
    s_nop 0
    buffer_load_dwordx4 v3, s[32:35], s96 offen lds
    s_add_u32 s96, s96, 65536
    s_cmp_eq_u32 s96, 1441792
    s_cselect_b32 s96, 0, s96
    s_add_u32 m0, s61, 2048
    s_nop 0
    buffer_load_dwordx4 v2, s[32:35], s96 offen lds
    s_add_u32 m0, s61, 3072
    s_nop 0
    buffer_load_dwordx4 v3, s[32:35], s96 offen lds
    s_add_u32 s96, s96, 65536
    s_cmp_eq_u32 s96, 1441792
    s_cselect_b32 s96, 0, s96
    s_add_u32 m0, s61, 4096
    s_nop 0
    buffer_load_dwordx4 v2, s[32:35], s96 offen lds
    s_add_u32 m0, s61, 5120
    s_nop 0
    buffer_load_dwordx4 v3, s[32:35], s96 offen lds
    s_add_u32 s96, s96, 65536
    s_cmp_eq_u32 s96, 1441792
    s_cselect_b32 s96, 0, s96
    s_add_u32 m0, s61, 6144
    s_nop 0
    buffer_load_dwordx4 v2, s[32:35], s96 offen lds
    s_add_u32 m0, s61, 7168
    s_nop 0
    buffer_load_dwordx4 v3, s[32:35], s96 offen lds
    s_add_u32 s96, s96, 65536
    s_cmp_eq_u32 s96, 1441792
    s_cselect_b32 s96, 0, s96
    s_add_u32 m0, s61, 8192
    s_nop 0
    buffer_load_dwordx4 v2, s[32:35], s96 offen lds
    s_add_u32 m0, s61, 9216
    s_nop 0
    buffer_load_dwordx4 v3, s[32:35], s96 offen lds
    s_add_u32 s96, s96, 65536
    s_cmp_eq_u32 s96, 1441792
    s_cselect_b32 s96, 0, s96
    s_waitcnt vmcnt(10)
    s_mov_b64 exec, 1
    ds_add_u32 v5, v6 offset:16
    s_mov_b64 exec, -1
    v_mov_b32 v120, 1069066811
    s_lshl_b32 s80, s92, 2
    s_add_u32 s80, s80, s74
    s_lshl_b32 s80, s80, 8
    s_lshr_b32 s78, s69, 4
    s_lshl_b32 s78, s78, 3
    s_add_u32 s80, s80, s78
    v_and_b32 v23, 1, v0
    v_lshlrev_b32 v23, 2, v23
    buffer_load_dword v22, v23, s[56:59], s80 offen offset:192 sc1
    v_and_b32 v16, 31, v0
    v_min_u32 v16, 16, v16
    v_and_b32 v17, 32, v0
    v_add_u32 v16, v16, v17
    v_lshlrev_b32 v24, 4, v16
    s_lshl_b32 s75, s74, 10
    v_mov_b32 v18, 163776
    v_mov_b32 v19, 1
    v_lshrrev_b32 v20, 5, v0
    v_bfe_u32 v21, v0, 2, 2
    v_lshl_add_u32 v25, v20, 2, v21
    v_lshlrev_b32 v25, 5, v25
    v_and_b32 v21, 3, v0
    v_lshl_add_u32 v25, v21, 3, v25
    v_add_u32 v25, 160256, v25
    ds_read_b64_tr_b16 v[40:41], v25 offset:0
    ds_read_b64_tr_b16 v[42:43], v25 offset:256
    v_bfe_u32 v21, v0, 4, 1
    v_mul_u32_u24 v26, 0x8000, v21
    v_lshl_or_b32 v26, v26, 16, v26
    s_lshl_b32 s78, s74, 9
    v_lshlrev_b32 v28, 3, v0
    v_add_u32 v28, 147712, v28
    v_add_u32 v27, s78, v28
    s_waitcnt vmcnt(0) lgkmcnt(0)
    s_mov_b64 exec, 1
    ds_add_u32 v18, v19 offset:12
    s_mov_b64 exec, -1
    v_xor_b32 v40, v40, v26
    v_xor_b32 v41, v41, v26
    v_xor_b32 v42, v42, v26
    v_xor_b32 v43, v43, v26
    s_mov_b32 s98, 0
k1_q_lq_chk:
    s_waitcnt vmcnt(0)
    v_cmp_ne_u32 vcc, 1, v22
    s_cbranch_vccz k1_q_lq_ok
    s_add_u32 s98, s98, 1
    s_cmp_gt_u32 s98, 0x8000
    s_cbranch_scc1 k1_q_lq_ok
    s_sleep 4
    buffer_load_dword v22, v23, s[56:59], s80 offen offset:192 sc1
    s_branch k1_q_lq_chk
k1_q_lq_ok:
    s_add_u32 s78, s90, s89
    buffer_load_dwordx4 v[32:35], v4, s[28:31], s78 offen sc1
    s_add_u32 s78, s91, s89
    buffer_load_dwordx4 v[36:39], v4, s[28:31], s78 offen sc1
    v_and_b32 v23, 7, v0
    v_lshlrev_b32 v23, 17, v23
    v_lshrrev_b32 v16, 3, v0
    v_mov_b32 v17, s89
    v_lshl_add_u32 v23, v17, 2, v23
    s_waitcnt vmcnt(0)
    v_mfma_f32_32x32x16_bf16 v[64:79], v[40:43], v[32:35], 0
    v_mfma_f32_32x32x16_bf16 v[80:95], v[40:43], v[36:39], 0
    s_nop 10
    v_max3_f32 v112, v64, v65, v66
    v_max3_f32 v116, v80, v81, v82
    v_max3_f32 v113, v72, v73, v74
    v_max3_f32 v117, v88, v89, v90
    v_max3_f32 v114, v67, v68, v69
    v_max3_f32 v118, v83, v84, v85
    v_max3_f32 v115, v75, v76, v77
    v_max3_f32 v119, v91, v92, v93
    v_max3_f32 v112, v70, v71, v112
    v_max3_f32 v116, v86, v87, v116
    v_max3_f32 v113, v78, v79, v113
    v_max3_f32 v117, v94, v95, v117
    v_max_f32 v112, v112, v114
    v_max_f32 v116, v116, v118
    v_max_f32 v113, v113, v115
    v_max_f32 v117, v117, v119
    s_nop 0
    v_permlane32_swap_b32 v112, v113
    v_permlane32_swap_b32 v116, v117
    v_max_f32 v112, v112, v113
    v_max_f32 v116, v116, v117
    v_mul_f32 v112, v120, v112
    v_mul_f32 v116, v120, v116
    v_mov_b32 v113, v112
    v_mov_b32 v117, v116
    s_nop 0
    v_permlane32_swap_b32 v112, v113
    v_permlane32_swap_b32 v116, v117
    v_fma_f32 v64, v64, v120, -v112
    v_fma_f32 v80, v80, v120, -v116
    v_fma_f32 v65, v65, v120, -v112
    v_fma_f32 v81, v81, v120, -v116
    v_fma_f32 v66, v66, v120, -v112
    v_fma_f32 v82, v82, v120, -v116
    v_fma_f32 v67, v67, v120, -v112
    v_fma_f32 v83, v83, v120, -v116
    v_fma_f32 v68, v68, v120, -v112
    v_fma_f32 v84, v84, v120, -v116
    v_fma_f32 v69, v69, v120, -v112
    v_fma_f32 v85, v85, v120, -v116
    v_fma_f32 v70, v70, v120, -v112
    v_fma_f32 v86, v86, v120, -v116
    v_fma_f32 v71, v71, v120, -v112
    v_fma_f32 v87, v87, v120, -v116
    v_fma_f32 v72, v72, v120, -v113
    v_fma_f32 v88, v88, v120, -v117
    v_fma_f32 v73, v73, v120, -v113
    v_fma_f32 v89, v89, v120, -v117
    v_fma_f32 v74, v74, v120, -v113
    v_fma_f32 v90, v90, v120, -v117
    v_fma_f32 v75, v75, v120, -v113
    v_fma_f32 v91, v91, v120, -v117
    v_fma_f32 v76, v76, v120, -v113
    v_fma_f32 v92, v92, v120, -v117
    v_fma_f32 v77, v77, v120, -v113
    v_fma_f32 v93, v93, v120, -v117
    v_fma_f32 v78, v78, v120, -v113
    v_fma_f32 v94, v94, v120, -v117
    v_fma_f32 v79, v79, v120, -v113
    v_fma_f32 v95, v95, v120, -v117
    v_exp_f32 v64, v64
    v_exp_f32 v80, v80
    v_exp_f32 v65, v65
    v_exp_f32 v81, v81
    v_exp_f32 v66, v66
    v_exp_f32 v82, v82
    v_exp_f32 v67, v67
    v_exp_f32 v83, v83
    v_exp_f32 v68, v68
    v_exp_f32 v84, v84
    v_exp_f32 v69, v69
    v_exp_f32 v85, v85
    v_exp_f32 v70, v70
    v_exp_f32 v86, v86
    v_exp_f32 v71, v71
    v_exp_f32 v87, v87
    v_exp_f32 v72, v72
    v_exp_f32 v88, v88
    v_exp_f32 v73, v73
    v_exp_f32 v89, v89
    v_exp_f32 v74, v74
    v_exp_f32 v90, v90
    v_exp_f32 v75, v75
    v_exp_f32 v91, v91
    v_exp_f32 v76, v76
    v_exp_f32 v92, v92
    v_exp_f32 v77, v77
    v_exp_f32 v93, v93
    v_exp_f32 v78, v78
    v_exp_f32 v94, v94
    v_exp_f32 v79, v79
    v_exp_f32 v95, v95
    v_add_f32 v112, v64, v65
    v_add_f32 v116, v80, v81
    v_add_f32 v113, v72, v73
    v_add_f32 v117, v88, v89
    v_add_f32 v114, v66, v67
    v_add_f32 v118, v82, v83
    v_add_f32 v115, v74, v75
    v_add_f32 v119, v90, v91
    v_add_f32 v112, v112, v68
    v_add_f32 v116, v116, v84
    v_add_f32 v113, v113, v76
    v_add_f32 v117, v117, v92
    v_add_f32 v114, v114, v69
    v_add_f32 v118, v118, v85
    v_add_f32 v115, v115, v77
    v_add_f32 v119, v119, v93
    v_add_f32 v112, v112, v70
    v_add_f32 v116, v116, v86
    v_add_f32 v113, v113, v78
    v_add_f32 v117, v117, v94
    v_add_f32 v114, v114, v71
    v_add_f32 v118, v118, v87
    v_add_f32 v115, v115, v79
    v_add_f32 v119, v119, v95
    v_add_f32 v112, v112, v114
    v_add_f32 v116, v116, v118
    v_add_f32 v113, v113, v115
    buffer_load_dword v22, v23, s[24:27], s75 offen sc1
    v_add_f32 v117, v117, v119
    v_permlane32_swap_b32 v112, v113
    s_nop 0
    v_permlane32_swap_b32 v116, v117
    v_add_f32 v112, v112, v113
    v_add_f32 v116, v116, v117
    v_rcp_f32 v112, v112
    v_rcp_f32 v116, v116
    v_mov_b32 v113, v112
    v_mov_b32 v117, v116
    s_nop 0
    v_permlane32_swap_b32 v112, v113
    v_permlane32_swap_b32 v116, v117
    v_mul_f32 v64, v64, v112
    v_mul_f32 v80, v80, v116
    v_mul_f32 v65, v65, v112
    v_mul_f32 v81, v81, v116
    v_mul_f32 v66, v66, v112
    v_mul_f32 v82, v82, v116
    v_mul_f32 v67, v67, v112
    v_mul_f32 v83, v83, v116
    v_mul_f32 v68, v68, v112
    v_mul_f32 v84, v84, v116
    v_mul_f32 v69, v69, v112
    v_mul_f32 v85, v85, v116
    v_mul_f32 v70, v70, v112
    v_mul_f32 v86, v86, v116
    v_mul_f32 v71, v71, v112
    v_mul_f32 v87, v87, v116
    v_mul_f32 v72, v72, v113
    v_mul_f32 v88, v88, v117
    v_mul_f32 v73, v73, v113
    v_mul_f32 v89, v89, v117
    v_mul_f32 v74, v74, v113
    v_mul_f32 v90, v90, v117
    v_mul_f32 v75, v75, v113
    v_mul_f32 v91, v91, v117
    v_mul_f32 v76, v76, v113
    v_mul_f32 v92, v92, v117
    v_mul_f32 v77, v77, v113
    v_mul_f32 v93, v93, v117
    v_mul_f32 v78, v78, v113
    v_mul_f32 v94, v94, v117
    v_mul_f32 v79, v79, v113
    v_mul_f32 v95, v95, v117
    v_cvt_pk_bf16_f32 v96, v64, v65
    v_cvt_pk_bf16_f32 v104, v80, v81
    v_cvt_pk_bf16_f32 v97, v66, v67
    v_cvt_pk_bf16_f32 v105, v82, v83
    v_cvt_pk_bf16_f32 v98, v68, v69
    v_cvt_pk_bf16_f32 v106, v84, v85
    v_cvt_pk_bf16_f32 v99, v70, v71
    v_cvt_pk_bf16_f32 v107, v86, v87
    v_cvt_pk_bf16_f32 v100, v72, v73
    v_cvt_pk_bf16_f32 v108, v88, v89
    v_cvt_pk_bf16_f32 v101, v74, v75
    v_cvt_pk_bf16_f32 v109, v90, v91
    v_cvt_pk_bf16_f32 v102, v76, v77
    v_cvt_pk_bf16_f32 v110, v92, v93
    v_cvt_pk_bf16_f32 v103, v78, v79
    v_cvt_pk_bf16_f32 v111, v94, v95
    s_setprio 3
    s_mov_b32 s98, 0
k1_q_lp_chk:
    s_waitcnt vmcnt(0)
    v_cmp_eq_u32 vcc, -1, v22
    s_nop 0
    s_and_b32 s78, vcc_lo, 255
    s_bcnt1_i32_b32 s78, s78
    s_cmp_le_u32 s78, 2
    s_cbranch_scc1 k1_q_lp_ok
    s_add_u32 s98, s98, 1
    s_cmp_gt_u32 s98, 0x8000
    s_cbranch_scc1 k1_q_lp_ok
    s_sleep 6
    buffer_load_dword v22, v23, s[24:27], s75 offen sc1
    s_branch k1_q_lp_chk
k1_q_lp_ok:
    s_mov_b32 s98, 0
k1_q_lk_ld:
    s_lshl_b32 s79, s89, 2
    s_add_u32 s79, s79, s75
    s_add_u32 s76, s79, 0
    buffer_load_dwordx4 v[32:35], v24, s[24:27], s76 offen sc1
    s_add_u32 s76, s79, 131072
    buffer_load_dwordx4 v[36:39], v24, s[24:27], s76 offen sc1
    s_add_u32 s76, s79, 262144
    buffer_load_dwordx4 v[40:43], v24, s[24:27], s76 offen sc1
    s_add_u32 s76, s79, 393216
    buffer_load_dwordx4 v[44:47], v24, s[24:27], s76 offen sc1
    s_add_u32 s76, s79, 524288
    buffer_load_dwordx4 v[48:51], v24, s[24:27], s76 offen sc1
    s_add_u32 s76, s79, 655360
    buffer_load_dwordx4 v[52:55], v24, s[24:27], s76 offen sc1
    s_add_u32 s76, s79, 786432
    buffer_load_dwordx4 v[56:59], v24, s[24:27], s76 offen sc1
    s_add_u32 s76, s79, 917504
    buffer_load_dwordx4 v[60:63], v24, s[24:27], s76 offen sc1
    s_waitcnt vmcnt(0)
    v_max3_u32 v20, v32, v33, v34
    v_max3_u32 v21, v35, v36, v37
    v_max3_u32 v20, v38, v39, v20
    v_max_u32 v20, v20, v21
    v_max3_u32 v22, v40, v41, v42
    v_max3_u32 v21, v43, v44, v45
    v_max3_u32 v22, v46, v47, v22
    v_max_u32 v22, v22, v21
    v_max_u32 v20, v20, v22
    v_max3_u32 v22, v48, v49, v50
    v_max3_u32 v21, v51, v52, v53
    v_max3_u32 v22, v54, v55, v22
    v_max_u32 v22, v22, v21
    v_max_u32 v20, v20, v22
    v_max3_u32 v22, v56, v57, v58
    v_max3_u32 v21, v59, v60, v61
    v_max3_u32 v22, v62, v63, v22
    v_max_u32 v22, v22, v21
    v_max_u32 v20, v20, v22
    v_cmp_eq_u32 vcc, -1, v20
    s_cbranch_vccz k1_q_lk_ok
    s_add_u32 s98, s98, 1
    s_cmp_gt_u32 s98, 0x8000
    s_cbranch_scc1 k1_q_lk_ok
    s_sleep 2
    s_branch k1_q_lk_ld
k1_q_lk_ok:
    v_add_f32 v32, v32, v48
    v_add_f32 v33, v33, v49
    v_add_f32 v34, v34, v50
    v_add_f32 v35, v35, v51
    v_add_f32 v36, v36, v52
    v_add_f32 v37, v37, v53
    v_add_f32 v38, v38, v54
    v_add_f32 v39, v39, v55
    v_add_f32 v40, v40, v56
    v_add_f32 v41, v41, v57
    v_add_f32 v42, v42, v58
    v_add_f32 v43, v43, v59
    v_add_f32 v44, v44, v60
    v_add_f32 v45, v45, v61
    v_add_f32 v46, v46, v62
    v_add_f32 v47, v47, v63
    v_add_f32 v32, v32, v40
    v_add_f32 v33, v33, v41
    v_add_f32 v34, v34, v42
    v_add_f32 v35, v35, v43
    v_add_f32 v36, v36, v44
    v_add_f32 v37, v37, v45
    v_add_f32 v38, v38, v46
    v_add_f32 v39, v39, v47
    v_add_f32 v32, v32, v36
    v_add_f32 v33, v33, v37
    v_add_f32 v34, v34, v38
    v_add_f32 v35, v35, v39
    v_cvt_pk_bf16_f32 v36, v32, v33
    v_cvt_pk_bf16_f32 v37, v34, v35
    ds_write_b64 v27, v[36:37] offset:0
    s_waitcnt lgkmcnt(0)
    s_mov_b64 exec, 1
    ds_add_u32 v18, v19 offset:0
    s_mov_b64 exec, -1
    s_mov_b32 s98, 0
k1_q_l_pc_w:
    ds_read_b32 v20, v18 offset:0
    s_waitcnt lgkmcnt(0)
    v_readfirstlane_b32 s79, v20
    s_add_u32 s98, s98, 1
    s_cmp_gt_u32 s98, 0x100000
    s_cbranch_scc1 k1_q_l_pc_k
    s_cmp_lt_u32 s79, 4
    s_cbranch_scc1 k1_q_l_pc_w
k1_q_l_pc_k:
    ds_read_b64 v[32:33], v28 offset:0
    ds_read_b64 v[34:35], v28 offset:512
    ds_read_b64 v[36:37], v28 offset:1024
    ds_read_b64 v[38:39], v28 offset:1536
    s_waitcnt lgkmcnt(0)
    v_mfma_f32_32x32x16_bf16 v[48:63], v[32:35], v[96:99], 0
    v_mfma_f32_32x32x16_bf16 v[64:79], v[32:35], v[104:107], 0
    v_mfma_f32_32x32x16_bf16 v[48:63], v[36:39], v[100:103], v[48:63]
    v_mfma_f32_32x32x16_bf16 v[64:79], v[36:39], v[108:111], v[64:79]
    s_nop 10
    v_add_f32 v56, 0x358637bd, v56
    v_rcp_f32 v56, v56
    s_add_u32 s78, s90, s89
    v_mul_f32 v48, v48, v56
    v_mul_f32 v49, v49, v56
    v_mul_f32 v50, v50, v56
    v_mul_f32 v51, v51, v56
    v_mul_f32 v52, v52, v56
    v_mul_f32 v53, v53, v56
    v_mul_f32 v54, v54, v56
    v_mul_f32 v55, v55, v56
    v_cvt_pk_bf16_f32 v60, v48, v49
    v_cvt_pk_bf16_f32 v61, v50, v51
    v_cvt_pk_bf16_f32 v62, v52, v53
    v_cvt_pk_bf16_f32 v63, v54, v55
    buffer_store_dwordx4 v[60:63], v4, s[48:51], s78 offen sc1
    v_add_f32 v72, 0x358637bd, v72
    v_rcp_f32 v72, v72
    s_add_u32 s78, s91, s89
    v_mul_f32 v64, v64, v72
    v_mul_f32 v65, v65, v72
    v_mul_f32 v66, v66, v72
    v_mul_f32 v67, v67, v72
    v_mul_f32 v68, v68, v72
    v_mul_f32 v69, v69, v72
    v_mul_f32 v70, v70, v72
    v_mul_f32 v71, v71, v72
    v_cvt_pk_bf16_f32 v76, v64, v65
    v_cvt_pk_bf16_f32 v77, v66, v67
    v_cvt_pk_bf16_f32 v78, v68, v69
    v_cvt_pk_bf16_f32 v79, v70, v71
    buffer_store_dwordx4 v[76:79], v4, s[48:51], s78 offen sc1
    s_endpgm
k1_q_c:
    s_and_b32 s74, s68, 1
    s_lshr_b32 s75, s68, 1
    s_lshl_b32 s76, s74, 1
    s_add_u32 s76, s76, s75
    s_lshl_b32 s83, s74, 1
    s_add_u32 s84, s83, 1
    v_and_b32 v1, 31, v0
    v_lshrrev_b32 v220, 5, v0
    v_bfe_u32 v221, v0, 1, 3
    v_bfe_u32 v223, v0, 2, 2
    v_lshl_add_u32 v223, v220, 3, v223
    v_and_b32 v224, 3, v0
    v_lshlrev_b32 v224, 3, v224
    v_bfe_u32 v6, v0, 4, 1
    v_and_b32 v7, 2, v223
    v_or_b32 v6, v6, v7
    v_lshl_add_u32 v224, v223, 7, v224
    v_xor_b32 v7, 2, v6
    v_lshl_add_u32 v7, v7, 5, v224
    v_lshl_add_u32 v224, v6, 5, v224
    s_lshl_b32 s80, s75, 14
    s_add_u32 s80, s80, 16384
    s_add_u32 s78, s76, 0
    s_and_b32 s78, s78, 3
    s_lshl_b32 s79, s78, 1
    v_add_u32 v222, s79, v220
    v_xor_b32 v222, v222, v221
    v_lshlrev_b32 v222, 4, v222
    v_lshl_add_u32 v222, v1, 7, v222
    s_lshl_b32 s79, s83, 12
    v_add_u32 v184, s79, v222
    s_mul_i32 s78, s78, 2048
    s_add_u32 s79, s78, s80
    v_add_u32 v188, s79, v224
    v_add_u32 v192, s79, v7
    s_add_u32 s78, s76, 1
    s_and_b32 s78, s78, 3
    s_lshl_b32 s79, s78, 1
    v_add_u32 v222, s79, v220
    v_xor_b32 v222, v222, v221
    v_lshlrev_b32 v222, 4, v222
    v_lshl_add_u32 v222, v1, 7, v222
    s_lshl_b32 s79, s83, 12
    v_add_u32 v185, s79, v222
    s_mul_i32 s78, s78, 2048
    s_add_u32 s79, s78, s80
    v_add_u32 v189, s79, v224
    v_add_u32 v193, s79, v7
    s_add_u32 s78, s76, 2
    s_and_b32 s78, s78, 3
    s_lshl_b32 s79, s78, 1
    v_add_u32 v222, s79, v220
    v_xor_b32 v222, v222, v221
    v_lshlrev_b32 v222, 4, v222
    v_lshl_add_u32 v222, v1, 7, v222
    s_lshl_b32 s79, s83, 12
    v_add_u32 v186, s79, v222
    s_mul_i32 s78, s78, 2048
    s_add_u32 s79, s78, s80
    v_add_u32 v190, s79, v224
    v_add_u32 v194, s79, v7
    s_add_u32 s78, s76, 3
    s_and_b32 s78, s78, 3
    s_lshl_b32 s79, s78, 1
    v_add_u32 v222, s79, v220
    v_xor_b32 v222, v222, v221
    v_lshlrev_b32 v222, 4, v222
    v_lshl_add_u32 v222, v1, 7, v222
    s_lshl_b32 s79, s83, 12
    v_add_u32 v187, s79, v222
    s_mul_i32 s78, s78, 2048
    s_add_u32 s79, s78, s80
    v_add_u32 v191, s79, v224
    v_add_u32 v195, s79, v7
    v_lshrrev_b32 v1, 4, v0
    v_xor_b32 v1, v1, v0
    v_and_b32 v1, 1, v1
    v_add_u32 v1, -1, v1
    v_and_b32 v204, 0x3f803f80, v1
    v_and_b32 v205, 0x3f803f80, v1
    v_and_b32 v206, 0x3f803f80, v1
    v_and_b32 v207, 0x3f803f80, v1
    v_mov_b32 v196, 0
    v_mov_b32 v197, 0
    v_mov_b32 v198, 0
    v_mov_b32 v199, 0
    v_mov_b32 v200, 0
    v_mov_b32 v201, 0
    v_mov_b32 v202, 0
    v_mov_b32 v203, 0
    v_mov_b32 v216, 0
    v_mov_b32 v217, 0
    v_mov_b32 v218, 0
    v_mov_b32 v219, 0
    s_mov_b32 s86, 0xffff0000
    s_mov_b32 s82, 1069066811
    s_waitcnt lgkmcnt(0)
    s_lshl_b32 s92, s70, 1
    s_add_u32 s92, s92, s71
    s_mov_b32 s64, s20
    s_and_b32 s65, s21, 0xffff
    s_mov_b32 s66, 256
    s_mov_b32 s67, 0x20000
    s_add_u32 s56, s22, 11534336
    s_addc_u32 s57, s23, 0
    s_and_b32 s57, s57, 0xffff
    s_mov_b32 s58, 81920
    s_mov_b32 s59, 0x20000
    s_and_b32 s93, s69, 3
    s_lshr_b32 s94, s69, 2
    s_mul_i32 s95, s94, 1
    s_mul_i32 s78, s93, 6
    s_add_u32 s95, s95, s78
    s_sub_u32 s78, s95, 22
    s_cmp_ge_u32 s95, 22
    s_cselect_b32 s95, s78, s95
    s_add_u32 s96, s95, 15
    s_sub_u32 s78, s96, 22
    s_cmp_ge_u32 s96, 22
    s_cselect_b32 s96, s78, s96
    s_lshl_b32 s95, s95, 12
    s_lshl_b32 s96, s96, 16
    s_lshl_b32 s78, s92, 2
    s_add_u32 s93, s93, s78
    s_mul_i32 s97, s68, 8192
    s_add_u32 s97, s97, 114944
    s_mul_i32 s60, s68, 12288
    s_add_u32 s60, s60, 0
    s_mul_i32 s61, s68, 10240
    s_add_u32 s61, s61, 53376
    s_lshl_b32 s78, s93, 16
    s_add_u32 s78, s78, 9437184
    s_add_u32 s48, s22, s78
    s_addc_u32 s49, s23, 0
    s_and_b32 s49, s49, 0xffff
    s_mov_b32 s50, 32768
    s_mov_b32 s51, 0x20000
    s_add_u32 s78, s78, 32768
    s_add_u32 s52, s22, s78
    s_addc_u32 s53, s23, 0
    s_and_b32 s53, s53, 0xffff
    s_mov_b32 s54, 32768
    s_mov_b32 s55, 0x20000
    s_add_u32 s40, s22, 6291456
    s_addc_u32 s41, s23, 0
    s_and_b32 s41, s41, 0xffff
    s_mov_b32 s42, 2097152
    s_mov_b32 s43, 0x20000
    s_lshl_b32 s80, s75, 3
    s_lshl_b32 s78, s71, 4
    s_add_u32 s80, s80, s78
    s_lshl_b32 s78, s72, 2
    s_add_u32 s78, s78, s83
    s_lshl_b32 s78, s78, 5
    s_add_u32 s78, s78, s80
    s_lshl_b32 s88, s78, 10
    s_lshl_b32 s78, s72, 2
    s_add_u32 s78, s78, s84
    s_lshl_b32 s78, s78, 5
    s_add_u32 s78, s78, s80
    s_lshl_b32 s90, s78, 10
    s_add_u32 s89, s88, 4096
    s_add_u32 s91, s90, 4096
    s_and_b32 s78, s68, 1
    s_lshl_b32 s3, s72, 1
    s_add_u32 s3, s3, s78
    s_lshl_b32 s3, s3, 6
    s_lshl_b32 s78, s73, 1
    s_add_u32 s3, s3, s78
    s_lshr_b32 s78, s68, 1
    s_add_u32 s3, s3, s78
    s_add_u32 s3, s3, 48
    s_lshl_b32 s3, s3, 2
    s_mul_i32 s78, s93, 176128
    s_add_u32 s24, s22, s78
    s_addc_u32 s25, s23, 0
    s_and_b32 s25, s25, 0xffff
    s_mov_b32 s26, 88064
    s_mov_b32 s27, 0x20000
    s_add_u32 s78, s78, 88064
    s_add_u32 s28, s22, s78
    s_addc_u32 s29, s23, 0
    s_and_b32 s29, s29, 0xffff
    s_mov_b32 s30, 88064
    s_mov_b32 s31, 0x20000
    s_mov_b32 s32, s16
    s_and_b32 s33, s17, 0xffff
    s_mov_b32 s34, 1409024
    s_mov_b32 s35, 0x20000
    s_mov_b32 s36, s10
    s_and_b32 s37, s11, 0xffff
    s_mov_b32 s38, 524288
    s_mov_b32 s39, 0x20000
    s_barrier
    ds_read_b128 v[136:139], v184 offset:0
    ds_read_b64_tr_b16 v[144:145], v188 offset:0
    ds_read_b64_tr_b16 v[146:147], v188 offset:512
    ds_read_b128 v[140:143], v184 offset:4096
    ds_read_b64_tr_b16 v[148:149], v192 offset:0
    ds_read_b64_tr_b16 v[150:151], v192 offset:512
    ds_read_b64_tr_b16 v[152:153], v188 offset:8192
    ds_read_b64_tr_b16 v[154:155], v188 offset:8704
    ds_read_b64_tr_b16 v[156:157], v192 offset:8192
    ds_read_b64_tr_b16 v[158:159], v192 offset:8704
    s_waitcnt lgkmcnt(0)
    v_mfma_f32_32x32x16_bf16 v[8:23], v[144:147], v[136:139], 0
    ds_read_b128 v[160:163], v185 offset:0
    v_lshlrev_b32 v2, 16, v152
    ds_read_b64_tr_b16 v[168:169], v189 offset:0
    v_and_b32 v3, s86, v152
    v_mfma_f32_32x32x16_bf16 v[72:87], v[144:147], v[140:143], 0
    ds_read_b64_tr_b16 v[170:171], v189 offset:512
    v_lshlrev_b32 v6, 16, v156
    ds_read_b128 v[164:167], v185 offset:4096
    v_and_b32 v7, s86, v156
    v_mfma_f32_16x16x32_bf16 v[196:199], v[144:147], v[204:207], v[196:199]
    ds_read_b64_tr_b16 v[172:173], v193 offset:0
    v_add_f32 v216, v216, v2
    ds_read_b64_tr_b16 v[174:175], v193 offset:512
    v_mfma_f32_32x32x16_bf16 v[24:39], v[148:151], v[136:139], 0
    v_add_f32 v217, v217, v3
    ds_read_b64_tr_b16 v[176:177], v189 offset:8192
    v_add_f32 v218, v218, v6
    ds_read_b64_tr_b16 v[178:179], v189 offset:8704
    v_mfma_f32_16x16x32_bf16 v[200:203], v[148:151], v[204:207], v[200:203]
    v_add_f32 v219, v219, v7
    ds_read_b64_tr_b16 v[180:181], v193 offset:8192
    ds_read_b64_tr_b16 v[182:183], v193 offset:8704
    v_mfma_f32_32x32x16_bf16 v[88:103], v[148:151], v[140:143], 0
    v_lshlrev_b32 v2, 16, v153
    v_and_b32 v3, s86, v153
    v_lshlrev_b32 v6, 16, v157
    v_and_b32 v7, s86, v157
    v_add_f32 v216, v216, v2
    v_mfma_f32_32x32x16_bf16 v[40:55], v[152:155], v[136:139], 0
    v_add_f32 v217, v217, v3
    v_add_f32 v218, v218, v6
    v_add_f32 v219, v219, v7
    v_lshlrev_b32 v2, 16, v154
    v_and_b32 v3, s86, v154
    v_mfma_f32_32x32x16_bf16 v[104:119], v[152:155], v[140:143], 0
    v_lshlrev_b32 v6, 16, v158
    v_and_b32 v7, s86, v158
    v_add_f32 v216, v216, v2
    v_add_f32 v217, v217, v3
    v_add_f32 v218, v218, v6
    v_mfma_f32_32x32x16_bf16 v[56:71], v[156:159], v[136:139], 0
    v_add_f32 v219, v219, v7
    v_lshlrev_b32 v2, 16, v155
    v_and_b32 v3, s86, v155
    v_lshlrev_b32 v6, 16, v159
    v_and_b32 v7, s86, v159
    v_mfma_f32_32x32x16_bf16 v[120:135], v[156:159], v[140:143], 0
    v_add_f32 v216, v216, v2
    v_add_f32 v217, v217, v3
    v_add_f32 v218, v218, v6
    v_add_f32 v219, v219, v7
    s_waitcnt lgkmcnt(0)
    v_mfma_f32_32x32x16_bf16 v[8:23], v[168:171], v[160:163], v[8:23]
    ds_read_b128 v[136:139], v186 offset:0
    v_lshlrev_b32 v2, 16, v176
    ds_read_b64_tr_b16 v[144:145], v190 offset:0
    v_and_b32 v3, s86, v176
    v_mfma_f32_32x32x16_bf16 v[72:87], v[168:171], v[164:167], v[72:87]
    ds_read_b64_tr_b16 v[146:147], v190 offset:512
    v_lshlrev_b32 v6, 16, v180
    ds_read_b128 v[140:143], v186 offset:4096
    v_and_b32 v7, s86, v180
    v_mfma_f32_16x16x32_bf16 v[196:199], v[168:171], v[204:207], v[196:199]
    ds_read_b64_tr_b16 v[148:149], v194 offset:0
    v_add_f32 v216, v216, v2
    ds_read_b64_tr_b16 v[150:151], v194 offset:512
    v_mfma_f32_32x32x16_bf16 v[24:39], v[172:175], v[160:163], v[24:39]
    v_add_f32 v217, v217, v3
    ds_read_b64_tr_b16 v[152:153], v190 offset:8192
    v_add_f32 v218, v218, v6
    ds_read_b64_tr_b16 v[154:155], v190 offset:8704
    v_mfma_f32_16x16x32_bf16 v[200:203], v[172:175], v[204:207], v[200:203]
    v_add_f32 v219, v219, v7
    ds_read_b64_tr_b16 v[156:157], v194 offset:8192
    ds_read_b64_tr_b16 v[158:159], v194 offset:8704
    v_mfma_f32_32x32x16_bf16 v[88:103], v[172:175], v[164:167], v[88:103]
    v_lshlrev_b32 v2, 16, v177
    v_and_b32 v3, s86, v177
    v_lshlrev_b32 v6, 16, v181
    v_and_b32 v7, s86, v181
    v_add_f32 v216, v216, v2
    v_mfma_f32_32x32x16_bf16 v[40:55], v[176:179], v[160:163], v[40:55]
    v_add_f32 v217, v217, v3
    v_add_f32 v218, v218, v6
    v_add_f32 v219, v219, v7
    v_lshlrev_b32 v2, 16, v178
    v_and_b32 v3, s86, v178
    v_mfma_f32_32x32x16_bf16 v[104:119], v[176:179], v[164:167], v[104:119]
    v_lshlrev_b32 v6, 16, v182
    v_and_b32 v7, s86, v182
    v_add_f32 v216, v216, v2
    v_add_f32 v217, v217, v3
    v_add_f32 v218, v218, v6
    v_mfma_f32_32x32x16_bf16 v[56:71], v[180:183], v[160:163], v[56:71]
    v_add_f32 v219, v219, v7
    v_lshlrev_b32 v2, 16, v179
    v_and_b32 v3, s86, v179
    v_lshlrev_b32 v6, 16, v183
    v_and_b32 v7, s86, v183
    v_mfma_f32_32x32x16_bf16 v[120:135], v[180:183], v[164:167], v[120:135]
    v_add_f32 v216, v216, v2
    v_add_f32 v217, v217, v3
    v_add_f32 v218, v218, v6
    v_add_f32 v219, v219, v7
    s_waitcnt lgkmcnt(0)
    v_mfma_f32_32x32x16_bf16 v[8:23], v[144:147], v[136:139], v[8:23]
    ds_read_b128 v[160:163], v187 offset:0
    ds_read_b64_tr_b16 v[168:169], v191 offset:0
    ds_read_b64_tr_b16 v[170:171], v191 offset:512
    v_mfma_f32_32x32x16_bf16 v[72:87], v[144:147], v[140:143], v[72:87]
    ds_read_b128 v[164:167], v187 offset:4096
    ds_read_b64_tr_b16 v[172:173], v195 offset:0
    v_mfma_f32_32x32x16_bf16 v[24:39], v[148:151], v[136:139], v[24:39]
    ds_read_b64_tr_b16 v[174:175], v195 offset:512
    ds_read_b64_tr_b16 v[176:177], v191 offset:8192
    ds_read_b64_tr_b16 v[178:179], v191 offset:8704
    v_mfma_f32_32x32x16_bf16 v[88:103], v[148:151], v[140:143], v[88:103]
    ds_read_b64_tr_b16 v[180:181], v195 offset:8192
    ds_read_b64_tr_b16 v[182:183], v195 offset:8704
    v_mfma_f32_32x32x16_bf16 v[40:55], v[152:155], v[136:139], v[40:55]
    v_mfma_f32_32x32x16_bf16 v[104:119], v[152:155], v[140:143], v[104:119]
    v_mfma_f32_32x32x16_bf16 v[56:71], v[156:159], v[136:139], v[56:71]
    v_mfma_f32_32x32x16_bf16 v[120:135], v[156:159], v[140:143], v[120:135]
    s_waitcnt lgkmcnt(0)
    s_barrier
    v_mfma_f32_32x32x16_bf16 v[8:23], v[168:171], v[160:163], v[8:23]
    ds_read_b128 v[136:139], v184 offset:49152
    ds_read_b64_tr_b16 v[144:145], v188 offset:49152
    ds_read_b64_tr_b16 v[146:147], v188 offset:49664
    v_mfma_f32_32x32x16_bf16 v[72:87], v[168:171], v[164:167], v[72:87]
    ds_read_b128 v[140:143], v184 offset:53248
    ds_read_b64_tr_b16 v[148:149], v192 offset:49152
    v_mfma_f32_32x32x16_bf16 v[24:39], v[172:175], v[160:163], v[24:39]
    ds_read_b64_tr_b16 v[150:151], v192 offset:49664
    ds_read_b64_tr_b16 v[152:153], v188 offset:57344
    ds_read_b64_tr_b16 v[154:155], v188 offset:57856
    v_mfma_f32_32x32x16_bf16 v[88:103], v[172:175], v[164:167], v[88:103]
    ds_read_b64_tr_b16 v[156:157], v192 offset:57344
    ds_read_b64_tr_b16 v[158:159], v192 offset:57856
    v_mfma_f32_32x32x16_bf16 v[40:55], v[176:179], v[160:163], v[40:55]
    v_mfma_f32_32x32x16_bf16 v[104:119], v[176:179], v[164:167], v[104:119]
    v_mfma_f32_32x32x16_bf16 v[56:71], v[180:183], v[160:163], v[56:71]
    v_mfma_f32_32x32x16_bf16 v[120:135], v[180:183], v[164:167], v[120:135]
    s_waitcnt lgkmcnt(0)
    v_mfma_f32_32x32x16_bf16 v[8:23], v[144:147], v[136:139], v[8:23]
    ds_read_b128 v[160:163], v185 offset:49152
    v_lshlrev_b32 v2, 16, v152
    ds_read_b64_tr_b16 v[168:169], v189 offset:49152
    v_and_b32 v3, s86, v152
    v_mfma_f32_32x32x16_bf16 v[72:87], v[144:147], v[140:143], v[72:87]
    ds_read_b64_tr_b16 v[170:171], v189 offset:49664
    v_lshlrev_b32 v6, 16, v156
    ds_read_b128 v[164:167], v185 offset:53248
    v_and_b32 v7, s86, v156
    v_mfma_f32_16x16x32_bf16 v[196:199], v[144:147], v[204:207], v[196:199]
    ds_read_b64_tr_b16 v[172:173], v193 offset:49152
    v_add_f32 v216, v216, v2
    ds_read_b64_tr_b16 v[174:175], v193 offset:49664
    v_mfma_f32_32x32x16_bf16 v[24:39], v[148:151], v[136:139], v[24:39]
    v_add_f32 v217, v217, v3
    ds_read_b64_tr_b16 v[176:177], v189 offset:57344
    v_add_f32 v218, v218, v6
    ds_read_b64_tr_b16 v[178:179], v189 offset:57856
    v_mfma_f32_16x16x32_bf16 v[200:203], v[148:151], v[204:207], v[200:203]
    v_add_f32 v219, v219, v7
    ds_read_b64_tr_b16 v[180:181], v193 offset:57344
    ds_read_b64_tr_b16 v[182:183], v193 offset:57856
    v_mfma_f32_32x32x16_bf16 v[88:103], v[148:151], v[140:143], v[88:103]
    v_lshlrev_b32 v2, 16, v153
    v_and_b32 v3, s86, v153
    v_lshlrev_b32 v6, 16, v157
    v_and_b32 v7, s86, v157
    v_add_f32 v216, v216, v2
    v_mfma_f32_32x32x16_bf16 v[40:55], v[152:155], v[136:139], v[40:55]
    v_add_f32 v217, v217, v3
    v_add_f32 v218, v218, v6
    v_add_f32 v219, v219, v7
    v_lshlrev_b32 v2, 16, v154
    v_and_b32 v3, s86, v154
    v_mfma_f32_32x32x16_bf16 v[104:119], v[152:155], v[140:143], v[104:119]
    v_lshlrev_b32 v6, 16, v158
    v_and_b32 v7, s86, v158
    v_add_f32 v216, v216, v2
    v_add_f32 v217, v217, v3
    v_add_f32 v218, v218, v6
    v_mfma_f32_32x32x16_bf16 v[56:71], v[156:159], v[136:139], v[56:71]
    v_add_f32 v219, v219, v7
    v_lshlrev_b32 v2, 16, v155
    v_and_b32 v3, s86, v155
    v_lshlrev_b32 v6, 16, v159
    v_and_b32 v7, s86, v159
    v_mfma_f32_32x32x16_bf16 v[120:135], v[156:159], v[140:143], v[120:135]
    v_add_f32 v216, v216, v2
    v_add_f32 v217, v217, v3
    v_add_f32 v218, v218, v6
    v_add_f32 v219, v219, v7
    s_waitcnt lgkmcnt(0)
    v_mfma_f32_32x32x16_bf16 v[8:23], v[168:171], v[160:163], v[8:23]
    ds_read_b128 v[136:139], v186 offset:49152
    v_lshlrev_b32 v2, 16, v176
    ds_read_b64_tr_b16 v[144:145], v190 offset:49152
    v_and_b32 v3, s86, v176
    v_mfma_f32_32x32x16_bf16 v[72:87], v[168:171], v[164:167], v[72:87]
    ds_read_b64_tr_b16 v[146:147], v190 offset:49664
    v_lshlrev_b32 v6, 16, v180
    ds_read_b128 v[140:143], v186 offset:53248
    v_and_b32 v7, s86, v180
    v_mfma_f32_16x16x32_bf16 v[196:199], v[168:171], v[204:207], v[196:199]
    ds_read_b64_tr_b16 v[148:149], v194 offset:49152
    v_add_f32 v216, v216, v2
    ds_read_b64_tr_b16 v[150:151], v194 offset:49664
    v_mfma_f32_32x32x16_bf16 v[24:39], v[172:175], v[160:163], v[24:39]
    v_add_f32 v217, v217, v3
    ds_read_b64_tr_b16 v[152:153], v190 offset:57344
    v_add_f32 v218, v218, v6
    ds_read_b64_tr_b16 v[154:155], v190 offset:57856
    v_mfma_f32_16x16x32_bf16 v[200:203], v[172:175], v[204:207], v[200:203]
    v_add_f32 v219, v219, v7
    ds_read_b64_tr_b16 v[156:157], v194 offset:57344
    ds_read_b64_tr_b16 v[158:159], v194 offset:57856
    v_mfma_f32_32x32x16_bf16 v[88:103], v[172:175], v[164:167], v[88:103]
    v_lshlrev_b32 v2, 16, v177
    v_and_b32 v3, s86, v177
    v_lshlrev_b32 v6, 16, v181
    v_and_b32 v7, s86, v181
    v_add_f32 v216, v216, v2
    v_mfma_f32_32x32x16_bf16 v[40:55], v[176:179], v[160:163], v[40:55]
    v_add_f32 v217, v217, v3
    v_add_f32 v218, v218, v6
    v_add_f32 v219, v219, v7
    v_lshlrev_b32 v2, 16, v178
    v_and_b32 v3, s86, v178
    v_mfma_f32_32x32x16_bf16 v[104:119], v[176:179], v[164:167], v[104:119]
    v_lshlrev_b32 v6, 16, v182
    v_and_b32 v7, s86, v182
    v_add_f32 v216, v216, v2
    v_add_f32 v217, v217, v3
    v_add_f32 v218, v218, v6
    v_mfma_f32_32x32x16_bf16 v[56:71], v[180:183], v[160:163], v[56:71]
    v_add_f32 v219, v219, v7
    v_lshlrev_b32 v2, 16, v179
    v_and_b32 v3, s86, v179
    v_lshlrev_b32 v6, 16, v183
    v_and_b32 v7, s86, v183
    v_mfma_f32_32x32x16_bf16 v[120:135], v[180:183], v[164:167], v[120:135]
    v_add_f32 v216, v216, v2
    v_add_f32 v217, v217, v3
    v_add_f32 v218, v218, v6
    v_add_f32 v219, v219, v7
    s_waitcnt lgkmcnt(0)
    v_mfma_f32_32x32x16_bf16 v[8:23], v[144:147], v[136:139], v[8:23]
    ds_read_b128 v[160:163], v187 offset:49152
    ds_read_b64_tr_b16 v[168:169], v191 offset:49152
    ds_read_b64_tr_b16 v[170:171], v191 offset:49664
    v_mfma_f32_32x32x16_bf16 v[72:87], v[144:147], v[140:143], v[72:87]
    ds_read_b128 v[164:167], v187 offset:53248
    ds_read_b64_tr_b16 v[172:173], v195 offset:49152
    v_mfma_f32_32x32x16_bf16 v[24:39], v[148:151], v[136:139], v[24:39]
    ds_read_b64_tr_b16 v[174:175], v195 offset:49664
    ds_read_b64_tr_b16 v[176:177], v191 offset:57344
    ds_read_b64_tr_b16 v[178:179], v191 offset:57856
    v_mfma_f32_32x32x16_bf16 v[88:103], v[148:151], v[140:143], v[88:103]
    ds_read_b64_tr_b16 v[180:181], v195 offset:57344
    ds_read_b64_tr_b16 v[182:183], v195 offset:57856
    v_mfma_f32_32x32x16_bf16 v[40:55], v[152:155], v[136:139], v[40:55]
    v_add_u32 v184, 98304, v184
    v_add_u32 v185, 98304, v185
    v_add_u32 v186, 98304, v186
    v_mfma_f32_32x32x16_bf16 v[104:119], v[152:155], v[140:143], v[104:119]
    v_add_u32 v187, 98304, v187
    v_add_u32 v188, 98304, v188
    v_add_u32 v189, 98304, v189
    v_mfma_f32_32x32x16_bf16 v[56:71], v[156:159], v[136:139], v[56:71]
    v_add_u32 v190, 98304, v190
    v_add_u32 v191, 98304, v191
    v_add_u32 v192, 98304, v192
    v_mfma_f32_32x32x16_bf16 v[120:135], v[156:159], v[140:143], v[120:135]
    v_add_u32 v193, 98304, v193
    v_add_u32 v194, 98304, v194
    v_add_u32 v195, 98304, v195
    s_waitcnt lgkmcnt(0)
    s_barrier
    v_mfma_f32_32x32x16_bf16 v[8:23], v[168:171], v[160:163], v[8:23]
    ds_read_b128 v[136:139], v184 offset:0
    ds_read_b64_tr_b16 v[144:145], v188 offset:0
    ds_read_b64_tr_b16 v[146:147], v188 offset:512
    v_mfma_f32_32x32x16_bf16 v[72:87], v[168:171], v[164:167], v[72:87]
    ds_read_b128 v[140:143], v184 offset:4096
    ds_read_b64_tr_b16 v[148:149], v192 offset:0
    v_mfma_f32_32x32x16_bf16 v[24:39], v[172:175], v[160:163], v[24:39]
    ds_read_b64_tr_b16 v[150:151], v192 offset:512
    ds_read_b64_tr_b16 v[152:153], v188 offset:8192
    ds_read_b64_tr_b16 v[154:155], v188 offset:8704
    v_mfma_f32_32x32x16_bf16 v[88:103], v[172:175], v[164:167], v[88:103]
    ds_read_b64_tr_b16 v[156:157], v192 offset:8192
    ds_read_b64_tr_b16 v[158:159], v192 offset:8704
    v_mfma_f32_32x32x16_bf16 v[40:55], v[176:179], v[160:163], v[40:55]
    v_mfma_f32_32x32x16_bf16 v[104:119], v[176:179], v[164:167], v[104:119]
    v_mfma_f32_32x32x16_bf16 v[56:71], v[180:183], v[160:163], v[56:71]
    v_mfma_f32_32x32x16_bf16 v[120:135], v[180:183], v[164:167], v[120:135]
    s_waitcnt lgkmcnt(0)
    v_mfma_f32_32x32x16_bf16 v[8:23], v[144:147], v[136:139], v[8:23]
    ds_read_b128 v[160:163], v185 offset:0
    v_lshlrev_b32 v2, 16, v152
    ds_read_b64_tr_b16 v[168:169], v189 offset:0
    v_and_b32 v3, s86, v152
    v_mfma_f32_32x32x16_bf16 v[72:87], v[144:147], v[140:143], v[72:87]
    ds_read_b64_tr_b16 v[170:171], v189 offset:512
    v_lshlrev_b32 v6, 16, v156
    ds_read_b128 v[164:167], v185 offset:4096
    v_and_b32 v7, s86, v156
    v_mfma_f32_16x16x32_bf16 v[196:199], v[144:147], v[204:207], v[196:199]
    ds_read_b64_tr_b16 v[172:173], v193 offset:0
    v_add_f32 v216, v216, v2
    ds_read_b64_tr_b16 v[174:175], v193 offset:512
    v_mfma_f32_32x32x16_bf16 v[24:39], v[148:151], v[136:139], v[24:39]
    v_add_f32 v217, v217, v3
    ds_read_b64_tr_b16 v[176:177], v189 offset:8192
    v_add_f32 v218, v218, v6
    ds_read_b64_tr_b16 v[178:179], v189 offset:8704
    v_mfma_f32_16x16x32_bf16 v[200:203], v[148:151], v[204:207], v[200:203]
    v_add_f32 v219, v219, v7
    ds_read_b64_tr_b16 v[180:181], v193 offset:8192
    ds_read_b64_tr_b16 v[182:183], v193 offset:8704
    v_mfma_f32_32x32x16_bf16 v[88:103], v[148:151], v[140:143], v[88:103]
    v_lshlrev_b32 v2, 16, v153
    v_and_b32 v3, s86, v153
    v_lshlrev_b32 v6, 16, v157
    v_and_b32 v7, s86, v157
    v_add_f32 v216, v216, v2
    v_mfma_f32_32x32x16_bf16 v[40:55], v[152:155], v[136:139], v[40:55]
    v_add_f32 v217, v217, v3
    v_add_f32 v218, v218, v6
    v_add_f32 v219, v219, v7
    v_lshlrev_b32 v2, 16, v154
    v_and_b32 v3, s86, v154
    v_mfma_f32_32x32x16_bf16 v[104:119], v[152:155], v[140:143], v[104:119]
    v_lshlrev_b32 v6, 16, v158
    v_and_b32 v7, s86, v158
    v_add_f32 v216, v216, v2
    v_add_f32 v217, v217, v3
    v_add_f32 v218, v218, v6
    v_mfma_f32_32x32x16_bf16 v[56:71], v[156:159], v[136:139], v[56:71]
    v_add_f32 v219, v219, v7
    v_lshlrev_b32 v2, 16, v155
    v_and_b32 v3, s86, v155
    v_lshlrev_b32 v6, 16, v159
    v_and_b32 v7, s86, v159
    v_mfma_f32_32x32x16_bf16 v[120:135], v[156:159], v[140:143], v[120:135]
    v_add_f32 v216, v216, v2
    v_add_f32 v217, v217, v3
    v_add_f32 v218, v218, v6
    v_add_f32 v219, v219, v7
    s_waitcnt lgkmcnt(0)
    v_mfma_f32_32x32x16_bf16 v[8:23], v[168:171], v[160:163], v[8:23]
    ds_read_b128 v[136:139], v186 offset:0
    v_lshlrev_b32 v2, 16, v176
    ds_read_b64_tr_b16 v[144:145], v190 offset:0
    v_and_b32 v3, s86, v176
    v_mfma_f32_32x32x16_bf16 v[72:87], v[168:171], v[164:167], v[72:87]
    ds_read_b64_tr_b16 v[146:147], v190 offset:512
    v_lshlrev_b32 v6, 16, v180
    ds_read_b128 v[140:143], v186 offset:4096
    v_and_b32 v7, s86, v180
    v_mfma_f32_16x16x32_bf16 v[196:199], v[168:171], v[204:207], v[196:199]
    ds_read_b64_tr_b16 v[148:149], v194 offset:0
    v_add_f32 v216, v216, v2
    ds_read_b64_tr_b16 v[150:151], v194 offset:512
    v_mfma_f32_32x32x16_bf16 v[24:39], v[172:175], v[160:163], v[24:39]
    v_add_f32 v217, v217, v3
    ds_read_b64_tr_b16 v[152:153], v190 offset:8192
    v_add_f32 v218, v218, v6
    ds_read_b64_tr_b16 v[154:155], v190 offset:8704
    v_mfma_f32_16x16x32_bf16 v[200:203], v[172:175], v[204:207], v[200:203]
    v_add_f32 v219, v219, v7
    ds_read_b64_tr_b16 v[156:157], v194 offset:8192
    ds_read_b64_tr_b16 v[158:159], v194 offset:8704
    v_mfma_f32_32x32x16_bf16 v[88:103], v[172:175], v[164:167], v[88:103]
    v_lshlrev_b32 v2, 16, v177
    v_and_b32 v3, s86, v177
    v_lshlrev_b32 v6, 16, v181
    v_and_b32 v7, s86, v181
    v_add_f32 v216, v216, v2
    v_mfma_f32_32x32x16_bf16 v[40:55], v[176:179], v[160:163], v[40:55]
    v_add_f32 v217, v217, v3
    v_add_f32 v218, v218, v6
    v_add_f32 v219, v219, v7
    v_lshlrev_b32 v2, 16, v178
    v_and_b32 v3, s86, v178
    v_mfma_f32_32x32x16_bf16 v[104:119], v[176:179], v[164:167], v[104:119]
    v_lshlrev_b32 v6, 16, v182
    v_and_b32 v7, s86, v182
    v_add_f32 v216, v216, v2
    v_add_f32 v217, v217, v3
    v_add_f32 v218, v218, v6
    v_mfma_f32_32x32x16_bf16 v[56:71], v[180:183], v[160:163], v[56:71]
    v_add_f32 v219, v219, v7
    v_lshlrev_b32 v2, 16, v179
    v_and_b32 v3, s86, v179
    v_lshlrev_b32 v6, 16, v183
    v_and_b32 v7, s86, v183
    v_mfma_f32_32x32x16_bf16 v[120:135], v[180:183], v[164:167], v[120:135]
    v_add_f32 v216, v216, v2
    v_add_f32 v217, v217, v3
    v_add_f32 v218, v218, v6
    v_add_f32 v219, v219, v7
    s_waitcnt lgkmcnt(0)
    v_mfma_f32_32x32x16_bf16 v[8:23], v[144:147], v[136:139], v[8:23]
    ds_read_b128 v[160:163], v187 offset:0
    ds_read_b64_tr_b16 v[168:169], v191 offset:0
    ds_read_b64_tr_b16 v[170:171], v191 offset:512
    v_mfma_f32_32x32x16_bf16 v[72:87], v[144:147], v[140:143], v[72:87]
    ds_read_b128 v[164:167], v187 offset:4096
    ds_read_b64_tr_b16 v[172:173], v195 offset:0
    v_mfma_f32_32x32x16_bf16 v[24:39], v[148:151], v[136:139], v[24:39]
    ds_read_b64_tr_b16 v[174:175], v195 offset:512
    ds_read_b64_tr_b16 v[176:177], v191 offset:8192
    ds_read_b64_tr_b16 v[178:179], v191 offset:8704
    v_mfma_f32_32x32x16_bf16 v[88:103], v[148:151], v[140:143], v[88:103]
    ds_read_b64_tr_b16 v[180:181], v195 offset:8192
    ds_read_b64_tr_b16 v[182:183], v195 offset:8704
    v_mfma_f32_32x32x16_bf16 v[40:55], v[152:155], v[136:139], v[40:55]
    v_add_u32 v184, 4294868992, v184
    v_add_u32 v185, 4294868992, v185
    v_add_u32 v186, 4294868992, v186
    v_mfma_f32_32x32x16_bf16 v[104:119], v[152:155], v[140:143], v[104:119]
    v_add_u32 v187, 4294868992, v187
    v_add_u32 v188, 4294868992, v188
    v_add_u32 v189, 4294868992, v189
    v_mfma_f32_32x32x16_bf16 v[56:71], v[156:159], v[136:139], v[56:71]
    v_add_u32 v190, 4294868992, v190
    v_add_u32 v191, 4294868992, v191
    v_add_u32 v192, 4294868992, v192
    v_mfma_f32_32x32x16_bf16 v[120:135], v[156:159], v[140:143], v[120:135]
    v_add_u32 v193, 4294868992, v193
    v_add_u32 v194, 4294868992, v194
    v_add_u32 v195, 4294868992, v195
    s_waitcnt lgkmcnt(0)
    s_barrier
    v_mfma_f32_32x32x16_bf16 v[8:23], v[168:171], v[160:163], v[8:23]
    ds_read_b128 v[136:139], v184 offset:0
    ds_read_b64_tr_b16 v[144:145], v188 offset:0
    ds_read_b64_tr_b16 v[146:147], v188 offset:512
    v_mfma_f32_32x32x16_bf16 v[72:87], v[168:171], v[164:167], v[72:87]
    ds_read_b128 v[140:143], v184 offset:4096
    ds_read_b64_tr_b16 v[148:149], v192 offset:0
    v_mfma_f32_32x32x16_bf16 v[24:39], v[172:175], v[160:163], v[24:39]
    ds_read_b64_tr_b16 v[150:151], v192 offset:512
    ds_read_b64_tr_b16 v[152:153], v188 offset:8192
    ds_read_b64_tr_b16 v[154:155], v188 offset:8704
    v_mfma_f32_32x32x16_bf16 v[88:103], v[172:175], v[164:167], v[88:103]
    ds_read_b64_tr_b16 v[156:157], v192 offset:8192
    ds_read_b64_tr_b16 v[158:159], v192 offset:8704
    v_mfma_f32_32x32x16_bf16 v[40:55], v[176:179], v[160:163], v[40:55]
    v_mfma_f32_32x32x16_bf16 v[104:119], v[176:179], v[164:167], v[104:119]
    v_mfma_f32_32x32x16_bf16 v[56:71], v[180:183], v[160:163], v[56:71]
    v_mfma_f32_32x32x16_bf16 v[120:135], v[180:183], v[164:167], v[120:135]
    s_waitcnt lgkmcnt(0)
    v_mfma_f32_32x32x16_bf16 v[8:23], v[144:147], v[136:139], v[8:23]
    ds_read_b128 v[160:163], v185 offset:0
    v_lshlrev_b32 v2, 16, v152
    ds_read_b64_tr_b16 v[168:169], v189 offset:0
    v_and_b32 v3, s86, v152
    v_mfma_f32_32x32x16_bf16 v[72:87], v[144:147], v[140:143], v[72:87]
    ds_read_b64_tr_b16 v[170:171], v189 offset:512
    v_lshlrev_b32 v6, 16, v156
    ds_read_b128 v[164:167], v185 offset:4096
    v_and_b32 v7, s86, v156
    v_mfma_f32_16x16x32_bf16 v[196:199], v[144:147], v[204:207], v[196:199]
    ds_read_b64_tr_b16 v[172:173], v193 offset:0
    v_add_f32 v216, v216, v2
    ds_read_b64_tr_b16 v[174:175], v193 offset:512
    v_mfma_f32_32x32x16_bf16 v[24:39], v[148:151], v[136:139], v[24:39]
    v_add_f32 v217, v217, v3
    ds_read_b64_tr_b16 v[176:177], v189 offset:8192
    v_add_f32 v218, v218, v6
    ds_read_b64_tr_b16 v[178:179], v189 offset:8704
    v_mfma_f32_16x16x32_bf16 v[200:203], v[148:151], v[204:207], v[200:203]
    v_add_f32 v219, v219, v7
    ds_read_b64_tr_b16 v[180:181], v193 offset:8192
    ds_read_b64_tr_b16 v[182:183], v193 offset:8704
    v_mfma_f32_32x32x16_bf16 v[88:103], v[148:151], v[140:143], v[88:103]
    v_lshlrev_b32 v2, 16, v153
    v_and_b32 v3, s86, v153
    v_lshlrev_b32 v6, 16, v157
    v_and_b32 v7, s86, v157
    v_add_f32 v216, v216, v2
    v_mfma_f32_32x32x16_bf16 v[40:55], v[152:155], v[136:139], v[40:55]
    v_add_f32 v217, v217, v3
    v_add_f32 v218, v218, v6
    v_add_f32 v219, v219, v7
    v_lshlrev_b32 v2, 16, v154
    v_and_b32 v3, s86, v154
    v_mfma_f32_32x32x16_bf16 v[104:119], v[152:155], v[140:143], v[104:119]
    v_lshlrev_b32 v6, 16, v158
    v_and_b32 v7, s86, v158
    v_add_f32 v216, v216, v2
    v_add_f32 v217, v217, v3
    v_add_f32 v218, v218, v6
    v_mfma_f32_32x32x16_bf16 v[56:71], v[156:159], v[136:139], v[56:71]
    v_add_f32 v219, v219, v7
    v_lshlrev_b32 v2, 16, v155
    v_and_b32 v3, s86, v155
    v_lshlrev_b32 v6, 16, v159
    v_and_b32 v7, s86, v159
    v_mfma_f32_32x32x16_bf16 v[120:135], v[156:159], v[140:143], v[120:135]
    v_add_f32 v216, v216, v2
    v_add_f32 v217, v217, v3
    v_add_f32 v218, v218, v6
    v_add_f32 v219, v219, v7
    s_waitcnt lgkmcnt(0)
    v_mfma_f32_32x32x16_bf16 v[8:23], v[168:171], v[160:163], v[8:23]
    ds_read_b128 v[136:139], v186 offset:0
    v_lshlrev_b32 v2, 16, v176
    ds_read_b64_tr_b16 v[144:145], v190 offset:0
    v_and_b32 v3, s86, v176
    v_mfma_f32_32x32x16_bf16 v[72:87], v[168:171], v[164:167], v[72:87]
    ds_read_b64_tr_b16 v[146:147], v190 offset:512
    v_lshlrev_b32 v6, 16, v180
    ds_read_b128 v[140:143], v186 offset:4096
    v_and_b32 v7, s86, v180
    v_mfma_f32_16x16x32_bf16 v[196:199], v[168:171], v[204:207], v[196:199]
    ds_read_b64_tr_b16 v[148:149], v194 offset:0
    v_add_f32 v216, v216, v2
    ds_read_b64_tr_b16 v[150:151], v194 offset:512
    v_mfma_f32_32x32x16_bf16 v[24:39], v[172:175], v[160:163], v[24:39]
    v_add_f32 v217, v217, v3
    ds_read_b64_tr_b16 v[152:153], v190 offset:8192
    v_add_f32 v218, v218, v6
    ds_read_b64_tr_b16 v[154:155], v190 offset:8704
    v_mfma_f32_16x16x32_bf16 v[200:203], v[172:175], v[204:207], v[200:203]
    v_add_f32 v219, v219, v7
    ds_read_b64_tr_b16 v[156:157], v194 offset:8192
    ds_read_b64_tr_b16 v[158:159], v194 offset:8704
    v_mfma_f32_32x32x16_bf16 v[88:103], v[172:175], v[164:167], v[88:103]
    v_lshlrev_b32 v2, 16, v177
    v_and_b32 v3, s86, v177
    v_lshlrev_b32 v6, 16, v181
    v_and_b32 v7, s86, v181
    v_add_f32 v216, v216, v2
    v_mfma_f32_32x32x16_bf16 v[40:55], v[176:179], v[160:163], v[40:55]
    v_add_f32 v217, v217, v3
    v_add_f32 v218, v218, v6
    v_add_f32 v219, v219, v7
    v_lshlrev_b32 v2, 16, v178
    v_and_b32 v3, s86, v178
    v_mfma_f32_32x32x16_bf16 v[104:119], v[176:179], v[164:167], v[104:119]
    v_lshlrev_b32 v6, 16, v182
    v_and_b32 v7, s86, v182
    v_add_f32 v216, v216, v2
    v_add_f32 v217, v217, v3
    v_add_f32 v218, v218, v6
    v_mfma_f32_32x32x16_bf16 v[56:71], v[180:183], v[160:163], v[56:71]
    v_add_f32 v219, v219, v7
    v_lshlrev_b32 v2, 16, v179
    v_and_b32 v3, s86, v179
    v_lshlrev_b32 v6, 16, v183
    v_and_b32 v7, s86, v183
    v_mfma_f32_32x32x16_bf16 v[120:135], v[180:183], v[164:167], v[120:135]
    v_add_f32 v216, v216, v2
    v_add_f32 v217, v217, v3
    v_add_f32 v218, v218, v6
    v_add_f32 v219, v219, v7
    s_waitcnt lgkmcnt(0)
    v_mfma_f32_32x32x16_bf16 v[8:23], v[144:147], v[136:139], v[8:23]
    ds_read_b128 v[160:163], v187 offset:0
    ds_read_b64_tr_b16 v[168:169], v191 offset:0
    ds_read_b64_tr_b16 v[170:171], v191 offset:512
    v_mfma_f32_32x32x16_bf16 v[72:87], v[144:147], v[140:143], v[72:87]
    ds_read_b128 v[164:167], v187 offset:4096
    ds_read_b64_tr_b16 v[172:173], v195 offset:0
    v_mfma_f32_32x32x16_bf16 v[24:39], v[148:151], v[136:139], v[24:39]
    ds_read_b64_tr_b16 v[174:175], v195 offset:512
    ds_read_b64_tr_b16 v[176:177], v191 offset:8192
    ds_read_b64_tr_b16 v[178:179], v191 offset:8704
    v_mfma_f32_32x32x16_bf16 v[88:103], v[148:151], v[140:143], v[88:103]
    ds_read_b64_tr_b16 v[180:181], v195 offset:8192
    ds_read_b64_tr_b16 v[182:183], v195 offset:8704
    v_mfma_f32_32x32x16_bf16 v[40:55], v[152:155], v[136:139], v[40:55]
    v_mfma_f32_32x32x16_bf16 v[104:119], v[152:155], v[140:143], v[104:119]
    v_mfma_f32_32x32x16_bf16 v[56:71], v[156:159], v[136:139], v[56:71]
    v_mfma_f32_32x32x16_bf16 v[120:135], v[156:159], v[140:143], v[120:135]
    s_waitcnt lgkmcnt(0)
    s_barrier
    v_mfma_f32_32x32x16_bf16 v[8:23], v[168:171], v[160:163], v[8:23]
    ds_read_b128 v[136:139], v184 offset:49152
    ds_read_b64_tr_b16 v[144:145], v188 offset:49152
    ds_read_b64_tr_b16 v[146:147], v188 offset:49664
    v_mfma_f32_32x32x16_bf16 v[72:87], v[168:171], v[164:167], v[72:87]
    ds_read_b128 v[140:143], v184 offset:53248
    ds_read_b64_tr_b16 v[148:149], v192 offset:49152
    v_mfma_f32_32x32x16_bf16 v[24:39], v[172:175], v[160:163], v[24:39]
    ds_read_b64_tr_b16 v[150:151], v192 offset:49664
    ds_read_b64_tr_b16 v[152:153], v188 offset:57344
    ds_read_b64_tr_b16 v[154:155], v188 offset:57856
    v_mfma_f32_32x32x16_bf16 v[88:103], v[172:175], v[164:167], v[88:103]
    ds_read_b64_tr_b16 v[156:157], v192 offset:57344
    ds_read_b64_tr_b16 v[158:159], v192 offset:57856
    v_mfma_f32_32x32x16_bf16 v[40:55], v[176:179], v[160:163], v[40:55]
    v_mfma_f32_32x32x16_bf16 v[104:119], v[176:179], v[164:167], v[104:119]
    v_mfma_f32_32x32x16_bf16 v[56:71], v[180:183], v[160:163], v[56:71]
    v_mfma_f32_32x32x16_bf16 v[120:135], v[180:183], v[164:167], v[120:135]
    s_waitcnt lgkmcnt(0)
    v_mfma_f32_32x32x16_bf16 v[8:23], v[144:147], v[136:139], v[8:23]
    ds_read_b128 v[160:163], v185 offset:49152
    v_lshlrev_b32 v2, 16, v152
    ds_read_b64_tr_b16 v[168:169], v189 offset:49152
    v_and_b32 v3, s86, v152
    v_mfma_f32_32x32x16_bf16 v[72:87], v[144:147], v[140:143], v[72:87]
    ds_read_b64_tr_b16 v[170:171], v189 offset:49664
    v_lshlrev_b32 v6, 16, v156
    ds_read_b128 v[164:167], v185 offset:53248
    v_and_b32 v7, s86, v156
    v_mfma_f32_16x16x32_bf16 v[196:199], v[144:147], v[204:207], v[196:199]
    ds_read_b64_tr_b16 v[172:173], v193 offset:49152
    v_add_f32 v216, v216, v2
    ds_read_b64_tr_b16 v[174:175], v193 offset:49664
    v_mfma_f32_32x32x16_bf16 v[24:39], v[148:151], v[136:139], v[24:39]
    v_add_f32 v217, v217, v3
    ds_read_b64_tr_b16 v[176:177], v189 offset:57344
    v_add_f32 v218, v218, v6
    ds_read_b64_tr_b16 v[178:179], v189 offset:57856
    v_mfma_f32_16x16x32_bf16 v[200:203], v[148:151], v[204:207], v[200:203]
    v_add_f32 v219, v219, v7
    ds_read_b64_tr_b16 v[180:181], v193 offset:57344
    ds_read_b64_tr_b16 v[182:183], v193 offset:57856
    v_mfma_f32_32x32x16_bf16 v[88:103], v[148:151], v[140:143], v[88:103]
    v_lshlrev_b32 v2, 16, v153
    v_and_b32 v3, s86, v153
    v_lshlrev_b32 v6, 16, v157
    v_and_b32 v7, s86, v157
    v_add_f32 v216, v216, v2
    v_mfma_f32_32x32x16_bf16 v[40:55], v[152:155], v[136:139], v[40:55]
    v_add_f32 v217, v217, v3
    v_add_f32 v218, v218, v6
    v_add_f32 v219, v219, v7
    v_lshlrev_b32 v2, 16, v154
    v_and_b32 v3, s86, v154
    v_mfma_f32_32x32x16_bf16 v[104:119], v[152:155], v[140:143], v[104:119]
    v_lshlrev_b32 v6, 16, v158
    v_and_b32 v7, s86, v158
    v_add_f32 v216, v216, v2
    v_add_f32 v217, v217, v3
    v_add_f32 v218, v218, v6
    v_mfma_f32_32x32x16_bf16 v[56:71], v[156:159], v[136:139], v[56:71]
    v_add_f32 v219, v219, v7
    v_lshlrev_b32 v2, 16, v155
    v_and_b32 v3, s86, v155
    v_lshlrev_b32 v6, 16, v159
    v_and_b32 v7, s86, v159
    v_mfma_f32_32x32x16_bf16 v[120:135], v[156:159], v[140:143], v[120:135]
    v_add_f32 v216, v216, v2
    v_add_f32 v217, v217, v3
    v_add_f32 v218, v218, v6
    v_add_f32 v219, v219, v7
    s_waitcnt lgkmcnt(0)
    v_mfma_f32_32x32x16_bf16 v[8:23], v[168:171], v[160:163], v[8:23]
    ds_read_b128 v[136:139], v186 offset:49152
    v_lshlrev_b32 v2, 16, v176
    ds_read_b64_tr_b16 v[144:145], v190 offset:49152
    v_and_b32 v3, s86, v176
    v_mfma_f32_32x32x16_bf16 v[72:87], v[168:171], v[164:167], v[72:87]
    ds_read_b64_tr_b16 v[146:147], v190 offset:49664
    v_lshlrev_b32 v6, 16, v180
    ds_read_b128 v[140:143], v186 offset:53248
    v_and_b32 v7, s86, v180
    v_mfma_f32_16x16x32_bf16 v[196:199], v[168:171], v[204:207], v[196:199]
    ds_read_b64_tr_b16 v[148:149], v194 offset:49152
    v_add_f32 v216, v216, v2
    ds_read_b64_tr_b16 v[150:151], v194 offset:49664
    v_mfma_f32_32x32x16_bf16 v[24:39], v[172:175], v[160:163], v[24:39]
    v_add_f32 v217, v217, v3
    ds_read_b64_tr_b16 v[152:153], v190 offset:57344
    v_add_f32 v218, v218, v6
    ds_read_b64_tr_b16 v[154:155], v190 offset:57856
    v_mfma_f32_16x16x32_bf16 v[200:203], v[172:175], v[204:207], v[200:203]
    v_add_f32 v219, v219, v7
    ds_read_b64_tr_b16 v[156:157], v194 offset:57344
    ds_read_b64_tr_b16 v[158:159], v194 offset:57856
    v_mfma_f32_32x32x16_bf16 v[88:103], v[172:175], v[164:167], v[88:103]
    v_lshlrev_b32 v2, 16, v177
    v_and_b32 v3, s86, v177
    v_lshlrev_b32 v6, 16, v181
    v_and_b32 v7, s86, v181
    v_add_f32 v216, v216, v2
    v_mfma_f32_32x32x16_bf16 v[40:55], v[176:179], v[160:163], v[40:55]
    v_add_f32 v217, v217, v3
    v_add_f32 v218, v218, v6
    v_add_f32 v219, v219, v7
    v_lshlrev_b32 v2, 16, v178
    v_and_b32 v3, s86, v178
    v_mfma_f32_32x32x16_bf16 v[104:119], v[176:179], v[164:167], v[104:119]
    v_lshlrev_b32 v6, 16, v182
    v_and_b32 v7, s86, v182
    v_add_f32 v216, v216, v2
    v_add_f32 v217, v217, v3
    v_add_f32 v218, v218, v6
    v_mfma_f32_32x32x16_bf16 v[56:71], v[180:183], v[160:163], v[56:71]
    v_add_f32 v219, v219, v7
    v_lshlrev_b32 v2, 16, v179
    v_and_b32 v3, s86, v179
    v_lshlrev_b32 v6, 16, v183
    v_and_b32 v7, s86, v183
    v_mfma_f32_32x32x16_bf16 v[120:135], v[180:183], v[164:167], v[120:135]
    v_add_f32 v216, v216, v2
    v_add_f32 v217, v217, v3
    v_add_f32 v218, v218, v6
    v_add_f32 v219, v219, v7
    s_waitcnt lgkmcnt(0)
    v_mfma_f32_32x32x16_bf16 v[8:23], v[144:147], v[136:139], v[8:23]
    ds_read_b128 v[160:163], v187 offset:49152
    ds_read_b64_tr_b16 v[168:169], v191 offset:49152
    ds_read_b64_tr_b16 v[170:171], v191 offset:49664
    v_mfma_f32_32x32x16_bf16 v[72:87], v[144:147], v[140:143], v[72:87]
    ds_read_b128 v[164:167], v187 offset:53248
    ds_read_b64_tr_b16 v[172:173], v195 offset:49152
    v_mfma_f32_32x32x16_bf16 v[24:39], v[148:151], v[136:139], v[24:39]
    ds_read_b64_tr_b16 v[174:175], v195 offset:49664
    ds_read_b64_tr_b16 v[176:177], v191 offset:57344
    ds_read_b64_tr_b16 v[178:179], v191 offset:57856
    v_mfma_f32_32x32x16_bf16 v[88:103], v[148:151], v[140:143], v[88:103]
    ds_read_b64_tr_b16 v[180:181], v195 offset:57344
    ds_read_b64_tr_b16 v[182:183], v195 offset:57856
    v_mfma_f32_32x32x16_bf16 v[40:55], v[152:155], v[136:139], v[40:55]
    v_add_u32 v184, 98304, v184
    v_add_u32 v185, 98304, v185
    v_add_u32 v186, 98304, v186
    v_mfma_f32_32x32x16_bf16 v[104:119], v[152:155], v[140:143], v[104:119]
    v_add_u32 v187, 98304, v187
    v_add_u32 v188, 98304, v188
    v_add_u32 v189, 98304, v189
    v_mfma_f32_32x32x16_bf16 v[56:71], v[156:159], v[136:139], v[56:71]
    v_add_u32 v190, 98304, v190
    v_add_u32 v191, 98304, v191
    v_add_u32 v192, 98304, v192
    v_mfma_f32_32x32x16_bf16 v[120:135], v[156:159], v[140:143], v[120:135]
    v_add_u32 v193, 98304, v193
    v_add_u32 v194, 98304, v194
    v_add_u32 v195, 98304, v195
    s_waitcnt lgkmcnt(0)
    s_barrier
    v_mfma_f32_32x32x16_bf16 v[8:23], v[168:171], v[160:163], v[8:23]
    ds_read_b128 v[136:139], v184 offset:0
    ds_read_b64_tr_b16 v[144:145], v188 offset:0
    ds_read_b64_tr_b16 v[146:147], v188 offset:512
    v_mfma_f32_32x32x16_bf16 v[72:87], v[168:171], v[164:167], v[72:87]
    ds_read_b128 v[140:143], v184 offset:4096
    ds_read_b64_tr_b16 v[148:149], v192 offset:0
    v_mfma_f32_32x32x16_bf16 v[24:39], v[172:175], v[160:163], v[24:39]
    ds_read_b64_tr_b16 v[150:151], v192 offset:512
    ds_read_b64_tr_b16 v[152:153], v188 offset:8192
    ds_read_b64_tr_b16 v[154:155], v188 offset:8704
    v_mfma_f32_32x32x16_bf16 v[88:103], v[172:175], v[164:167], v[88:103]
    ds_read_b64_tr_b16 v[156:157], v192 offset:8192
    ds_read_b64_tr_b16 v[158:159], v192 offset:8704
    v_mfma_f32_32x32x16_bf16 v[40:55], v[176:179], v[160:163], v[40:55]
    v_mfma_f32_32x32x16_bf16 v[104:119], v[176:179], v[164:167], v[104:119]
    v_mfma_f32_32x32x16_bf16 v[56:71], v[180:183], v[160:163], v[56:71]
    v_mfma_f32_32x32x16_bf16 v[120:135], v[180:183], v[164:167], v[120:135]
    s_waitcnt lgkmcnt(0)
    v_mfma_f32_32x32x16_bf16 v[8:23], v[144:147], v[136:139], v[8:23]
    ds_read_b128 v[160:163], v185 offset:0
    v_lshlrev_b32 v2, 16, v152
    ds_read_b64_tr_b16 v[168:169], v189 offset:0
    v_and_b32 v3, s86, v152
    v_mfma_f32_32x32x16_bf16 v[72:87], v[144:147], v[140:143], v[72:87]
    ds_read_b64_tr_b16 v[170:171], v189 offset:512
    v_lshlrev_b32 v6, 16, v156
    ds_read_b128 v[164:167], v185 offset:4096
    v_and_b32 v7, s86, v156
    v_mfma_f32_16x16x32_bf16 v[196:199], v[144:147], v[204:207], v[196:199]
    ds_read_b64_tr_b16 v[172:173], v193 offset:0
    v_add_f32 v216, v216, v2
    ds_read_b64_tr_b16 v[174:175], v193 offset:512
    v_mfma_f32_32x32x16_bf16 v[24:39], v[148:151], v[136:139], v[24:39]
    v_add_f32 v217, v217, v3
    ds_read_b64_tr_b16 v[176:177], v189 offset:8192
    v_add_f32 v218, v218, v6
    ds_read_b64_tr_b16 v[178:179], v189 offset:8704
    v_mfma_f32_16x16x32_bf16 v[200:203], v[148:151], v[204:207], v[200:203]
    v_add_f32 v219, v219, v7
    ds_read_b64_tr_b16 v[180:181], v193 offset:8192
    ds_read_b64_tr_b16 v[182:183], v193 offset:8704
    v_mfma_f32_32x32x16_bf16 v[88:103], v[148:151], v[140:143], v[88:103]
    v_lshlrev_b32 v2, 16, v153
    v_and_b32 v3, s86, v153
    v_lshlrev_b32 v6, 16, v157
    v_and_b32 v7, s86, v157
    v_add_f32 v216, v216, v2
    v_mfma_f32_32x32x16_bf16 v[40:55], v[152:155], v[136:139], v[40:55]
    v_add_f32 v217, v217, v3
    v_add_f32 v218, v218, v6
    v_add_f32 v219, v219, v7
    v_lshlrev_b32 v2, 16, v154
    v_and_b32 v3, s86, v154
    v_mfma_f32_32x32x16_bf16 v[104:119], v[152:155], v[140:143], v[104:119]
    v_lshlrev_b32 v6, 16, v158
    v_and_b32 v7, s86, v158
    v_add_f32 v216, v216, v2
    v_add_f32 v217, v217, v3
    v_add_f32 v218, v218, v6
    v_mfma_f32_32x32x16_bf16 v[56:71], v[156:159], v[136:139], v[56:71]
    v_add_f32 v219, v219, v7
    v_lshlrev_b32 v2, 16, v155
    v_and_b32 v3, s86, v155
    v_lshlrev_b32 v6, 16, v159
    v_and_b32 v7, s86, v159
    v_mfma_f32_32x32x16_bf16 v[120:135], v[156:159], v[140:143], v[120:135]
    v_add_f32 v216, v216, v2
    v_add_f32 v217, v217, v3
    v_add_f32 v218, v218, v6
    v_add_f32 v219, v219, v7
    s_waitcnt lgkmcnt(0)
    v_mfma_f32_32x32x16_bf16 v[8:23], v[168:171], v[160:163], v[8:23]
    ds_read_b128 v[136:139], v186 offset:0
    v_lshlrev_b32 v2, 16, v176
    ds_read_b64_tr_b16 v[144:145], v190 offset:0
    v_and_b32 v3, s86, v176
    v_mfma_f32_32x32x16_bf16 v[72:87], v[168:171], v[164:167], v[72:87]
    ds_read_b64_tr_b16 v[146:147], v190 offset:512
    v_lshlrev_b32 v6, 16, v180
    ds_read_b128 v[140:143], v186 offset:4096
    v_and_b32 v7, s86, v180
    v_mfma_f32_16x16x32_bf16 v[196:199], v[168:171], v[204:207], v[196:199]
    ds_read_b64_tr_b16 v[148:149], v194 offset:0
    v_add_f32 v216, v216, v2
    ds_read_b64_tr_b16 v[150:151], v194 offset:512
    v_mfma_f32_32x32x16_bf16 v[24:39], v[172:175], v[160:163], v[24:39]
    v_add_f32 v217, v217, v3
    ds_read_b64_tr_b16 v[152:153], v190 offset:8192
    v_add_f32 v218, v218, v6
    ds_read_b64_tr_b16 v[154:155], v190 offset:8704
    v_mfma_f32_16x16x32_bf16 v[200:203], v[172:175], v[204:207], v[200:203]
    v_add_f32 v219, v219, v7
    ds_read_b64_tr_b16 v[156:157], v194 offset:8192
    ds_read_b64_tr_b16 v[158:159], v194 offset:8704
    v_mfma_f32_32x32x16_bf16 v[88:103], v[172:175], v[164:167], v[88:103]
    v_lshlrev_b32 v2, 16, v177
    v_and_b32 v3, s86, v177
    v_lshlrev_b32 v6, 16, v181
    v_and_b32 v7, s86, v181
    v_add_f32 v216, v216, v2
    v_mfma_f32_32x32x16_bf16 v[40:55], v[176:179], v[160:163], v[40:55]
    v_add_f32 v217, v217, v3
    v_add_f32 v218, v218, v6
    v_add_f32 v219, v219, v7
    v_lshlrev_b32 v2, 16, v178
    v_and_b32 v3, s86, v178
    v_mfma_f32_32x32x16_bf16 v[104:119], v[176:179], v[164:167], v[104:119]
    v_lshlrev_b32 v6, 16, v182
    v_and_b32 v7, s86, v182
    v_add_f32 v216, v216, v2
    v_add_f32 v217, v217, v3
    v_add_f32 v218, v218, v6
    v_mfma_f32_32x32x16_bf16 v[56:71], v[180:183], v[160:163], v[56:71]
    v_add_f32 v219, v219, v7
    v_lshlrev_b32 v2, 16, v179
    v_and_b32 v3, s86, v179
    v_lshlrev_b32 v6, 16, v183
    v_and_b32 v7, s86, v183
    v_mfma_f32_32x32x16_bf16 v[120:135], v[180:183], v[164:167], v[120:135]
    v_add_f32 v216, v216, v2
    v_add_f32 v217, v217, v3
    v_add_f32 v218, v218, v6
    v_add_f32 v219, v219, v7
    s_waitcnt lgkmcnt(0)
    v_mfma_f32_32x32x16_bf16 v[8:23], v[144:147], v[136:139], v[8:23]
    ds_read_b128 v[160:163], v187 offset:0
    ds_read_b64_tr_b16 v[168:169], v191 offset:0
    ds_read_b64_tr_b16 v[170:171], v191 offset:512
    v_mfma_f32_32x32x16_bf16 v[72:87], v[144:147], v[140:143], v[72:87]
    ds_read_b128 v[164:167], v187 offset:4096
    ds_read_b64_tr_b16 v[172:173], v195 offset:0
    v_mfma_f32_32x32x16_bf16 v[24:39], v[148:151], v[136:139], v[24:39]
    ds_read_b64_tr_b16 v[174:175], v195 offset:512
    ds_read_b64_tr_b16 v[176:177], v191 offset:8192
    ds_read_b64_tr_b16 v[178:179], v191 offset:8704
    v_mfma_f32_32x32x16_bf16 v[88:103], v[148:151], v[140:143], v[88:103]
    ds_read_b64_tr_b16 v[180:181], v195 offset:8192
    ds_read_b64_tr_b16 v[182:183], v195 offset:8704
    v_mfma_f32_32x32x16_bf16 v[40:55], v[152:155], v[136:139], v[40:55]
    v_add_u32 v184, 4294868992, v184
    v_add_u32 v185, 4294868992, v185
    v_add_u32 v186, 4294868992, v186
    v_mfma_f32_32x32x16_bf16 v[104:119], v[152:155], v[140:143], v[104:119]
    v_add_u32 v187, 4294868992, v187
    v_add_u32 v188, 4294868992, v188
    v_add_u32 v189, 4294868992, v189
    v_mfma_f32_32x32x16_bf16 v[56:71], v[156:159], v[136:139], v[56:71]
    v_add_u32 v190, 4294868992, v190
    v_add_u32 v191, 4294868992, v191
    v_add_u32 v192, 4294868992, v192
    v_mfma_f32_32x32x16_bf16 v[120:135], v[156:159], v[140:143], v[120:135]
    v_add_u32 v193, 4294868992, v193
    v_add_u32 v194, 4294868992, v194
    v_add_u32 v195, 4294868992, v195
    s_waitcnt lgkmcnt(0)
    s_barrier
    v_mfma_f32_32x32x16_bf16 v[8:23], v[168:171], v[160:163], v[8:23]
    ds_read_b128 v[136:139], v184 offset:0
    ds_read_b64_tr_b16 v[144:145], v188 offset:0
    ds_read_b64_tr_b16 v[146:147], v188 offset:512
    v_mfma_f32_32x32x16_bf16 v[72:87], v[168:171], v[164:167], v[72:87]
    ds_read_b128 v[140:143], v184 offset:4096
    ds_read_b64_tr_b16 v[148:149], v192 offset:0
    v_mfma_f32_32x32x16_bf16 v[24:39], v[172:175], v[160:163], v[24:39]
    ds_read_b64_tr_b16 v[150:151], v192 offset:512
    ds_read_b64_tr_b16 v[152:153], v188 offset:8192
    ds_read_b64_tr_b16 v[154:155], v188 offset:8704
    v_mfma_f32_32x32x16_bf16 v[88:103], v[172:175], v[164:167], v[88:103]
    ds_read_b64_tr_b16 v[156:157], v192 offset:8192
    ds_read_b64_tr_b16 v[158:159], v192 offset:8704
    v_mfma_f32_32x32x16_bf16 v[40:55], v[176:179], v[160:163], v[40:55]
    v_and_b32 v220, 31, v0
    v_lshlrev_b32 v1, 3, v220
    v_lshlrev_b32 v220, 2, v220
    s_lshl_b32 s79, s75, 11
    v_mfma_f32_32x32x16_bf16 v[104:119], v[176:179], v[164:167], v[104:119]
    s_add_u32 s79, s79, 154048
    s_lshl_b32 s78, s74, 7
    v_and_b32 v222, 1, v0
    v_lshlrev_b32 v222, 6, v222
    v_mfma_f32_32x32x16_bf16 v[56:71], v[180:183], v[160:163], v[56:71]
    v_lshrrev_b32 v6, 4, v0
    v_lshl_add_u32 v222, v6, 4, v222
    v_add_u32 v220, s79, v220
    v_add_u32 v221, s78, v220
    v_mfma_f32_32x32x16_bf16 v[120:135], v[180:183], v[164:167], v[120:135]
    s_add_u32 s78, s78, s79
    v_add_u32 v222, s78, v222
    buffer_load_dword v5, v4, s[64:67], 0 offen sc1
    s_waitcnt lgkmcnt(0)
    v_mfma_f32_32x32x16_bf16 v[8:23], v[144:147], v[136:139], v[8:23]
    ds_read_b128 v[160:163], v185 offset:0
    v_lshlrev_b32 v2, 16, v152
    ds_read_b64_tr_b16 v[168:169], v189 offset:0
    v_and_b32 v3, s86, v152
    v_mfma_f32_32x32x16_bf16 v[72:87], v[144:147], v[140:143], v[72:87]
    ds_read_b64_tr_b16 v[170:171], v189 offset:512
    v_lshlrev_b32 v6, 16, v156
    ds_read_b128 v[164:167], v185 offset:4096
    v_and_b32 v7, s86, v156
    v_mfma_f32_16x16x32_bf16 v[196:199], v[144:147], v[204:207], v[196:199]
    ds_read_b64_tr_b16 v[172:173], v193 offset:0
    v_add_f32 v216, v216, v2
    ds_read_b64_tr_b16 v[174:175], v193 offset:512
    v_mfma_f32_32x32x16_bf16 v[24:39], v[148:151], v[136:139], v[24:39]
    v_add_f32 v217, v217, v3
    ds_read_b64_tr_b16 v[176:177], v189 offset:8192
    v_add_f32 v218, v218, v6
    ds_read_b64_tr_b16 v[178:179], v189 offset:8704
    v_mfma_f32_16x16x32_bf16 v[200:203], v[148:151], v[204:207], v[200:203]
    v_add_f32 v219, v219, v7
    ds_read_b64_tr_b16 v[180:181], v193 offset:8192
    ds_read_b64_tr_b16 v[182:183], v193 offset:8704
    v_mfma_f32_32x32x16_bf16 v[88:103], v[148:151], v[140:143], v[88:103]
    v_lshlrev_b32 v2, 16, v153
    v_and_b32 v3, s86, v153
    v_lshlrev_b32 v6, 16, v157
    v_and_b32 v7, s86, v157
    v_add_f32 v216, v216, v2
    v_mfma_f32_32x32x16_bf16 v[40:55], v[152:155], v[136:139], v[40:55]
    v_add_f32 v217, v217, v3
    v_add_f32 v218, v218, v6
    v_add_f32 v219, v219, v7
    v_lshlrev_b32 v2, 16, v154
    v_and_b32 v3, s86, v154
    v_mfma_f32_32x32x16_bf16 v[104:119], v[152:155], v[140:143], v[104:119]
    v_lshlrev_b32 v6, 16, v158
    v_and_b32 v7, s86, v158
    v_add_f32 v216, v216, v2
    v_add_f32 v217, v217, v3
    v_add_f32 v218, v218, v6
    v_mfma_f32_32x32x16_bf16 v[56:71], v[156:159], v[136:139], v[56:71]
    v_add_f32 v219, v219, v7
    v_lshlrev_b32 v2, 16, v155
    v_and_b32 v3, s86, v155
    v_lshlrev_b32 v6, 16, v159
    v_and_b32 v7, s86, v159
    v_mfma_f32_32x32x16_bf16 v[120:135], v[156:159], v[140:143], v[120:135]
    v_add_f32 v216, v216, v2
    v_add_f32 v217, v217, v3
    v_add_f32 v218, v218, v6
    v_add_f32 v219, v219, v7
    s_waitcnt lgkmcnt(0)
    v_mfma_f32_32x32x16_bf16 v[8:23], v[168:171], v[160:163], v[8:23]
    ds_read_b128 v[136:139], v186 offset:0
    v_lshlrev_b32 v2, 16, v176
    ds_read_b64_tr_b16 v[144:145], v190 offset:0
    v_and_b32 v3, s86, v176
    v_mfma_f32_32x32x16_bf16 v[72:87], v[168:171], v[164:167], v[72:87]
    ds_read_b64_tr_b16 v[146:147], v190 offset:512
    v_lshlrev_b32 v6, 16, v180
    ds_read_b128 v[140:143], v186 offset:4096
    v_and_b32 v7, s86, v180
    v_mfma_f32_16x16x32_bf16 v[196:199], v[168:171], v[204:207], v[196:199]
    ds_read_b64_tr_b16 v[148:149], v194 offset:0
    v_add_f32 v216, v216, v2
    ds_read_b64_tr_b16 v[150:151], v194 offset:512
    v_mfma_f32_32x32x16_bf16 v[24:39], v[172:175], v[160:163], v[24:39]
    v_add_f32 v217, v217, v3
    ds_read_b64_tr_b16 v[152:153], v190 offset:8192
    v_add_f32 v218, v218, v6
    ds_read_b64_tr_b16 v[154:155], v190 offset:8704
    v_mfma_f32_16x16x32_bf16 v[200:203], v[172:175], v[204:207], v[200:203]
    v_add_f32 v219, v219, v7
    ds_read_b64_tr_b16 v[156:157], v194 offset:8192
    ds_read_b64_tr_b16 v[158:159], v194 offset:8704
    v_mfma_f32_32x32x16_bf16 v[88:103], v[172:175], v[164:167], v[88:103]
    v_lshlrev_b32 v2, 16, v177
    v_and_b32 v3, s86, v177
    v_lshlrev_b32 v6, 16, v181
    v_and_b32 v7, s86, v181
    v_add_f32 v216, v216, v2
    v_mfma_f32_32x32x16_bf16 v[40:55], v[176:179], v[160:163], v[40:55]
    v_add_f32 v217, v217, v3
    v_add_f32 v218, v218, v6
    v_add_f32 v219, v219, v7
    v_lshlrev_b32 v2, 16, v178
    v_and_b32 v3, s86, v178
    v_mfma_f32_32x32x16_bf16 v[104:119], v[176:179], v[164:167], v[104:119]
    v_lshlrev_b32 v6, 16, v182
    v_and_b32 v7, s86, v182
    v_add_f32 v216, v216, v2
    v_add_f32 v217, v217, v3
    v_add_f32 v218, v218, v6
    v_mfma_f32_32x32x16_bf16 v[56:71], v[180:183], v[160:163], v[56:71]
    v_add_f32 v219, v219, v7
    v_lshlrev_b32 v2, 16, v179
    v_and_b32 v3, s86, v179
    v_lshlrev_b32 v6, 16, v183
    v_and_b32 v7, s86, v183
    v_mfma_f32_32x32x16_bf16 v[120:135], v[180:183], v[164:167], v[120:135]
    v_add_f32 v216, v216, v2
    v_add_f32 v217, v217, v3
    v_add_f32 v218, v218, v6
    v_add_f32 v219, v219, v7
    s_waitcnt lgkmcnt(0)
    v_mfma_f32_32x32x16_bf16 v[8:23], v[144:147], v[136:139], v[8:23]
    ds_read_b128 v[160:163], v187 offset:0
    ds_read_b64_tr_b16 v[168:169], v191 offset:0
    ds_read_b64_tr_b16 v[170:171], v191 offset:512
    v_mfma_f32_32x32x16_bf16 v[72:87], v[144:147], v[140:143], v[72:87]
    ds_read_b128 v[164:167], v187 offset:4096
    ds_read_b64_tr_b16 v[172:173], v195 offset:0
    v_mfma_f32_32x32x16_bf16 v[24:39], v[148:151], v[136:139], v[24:39]
    ds_read_b64_tr_b16 v[174:175], v195 offset:512
    ds_read_b64_tr_b16 v[176:177], v191 offset:8192
    ds_read_b64_tr_b16 v[178:179], v191 offset:8704
    v_mfma_f32_32x32x16_bf16 v[88:103], v[148:151], v[140:143], v[88:103]
    ds_read_b64_tr_b16 v[180:181], v195 offset:8192
    ds_read_b64_tr_b16 v[182:183], v195 offset:8704
    v_mfma_f32_32x32x16_bf16 v[40:55], v[152:155], v[136:139], v[40:55]
    v_mfma_f32_32x32x16_bf16 v[104:119], v[152:155], v[140:143], v[104:119]
    v_mfma_f32_32x32x16_bf16 v[56:71], v[156:159], v[136:139], v[56:71]
    v_mfma_f32_32x32x16_bf16 v[120:135], v[156:159], v[140:143], v[120:135]
    s_waitcnt lgkmcnt(0)
    s_barrier
    v_mfma_f32_32x32x16_bf16 v[8:23], v[168:171], v[160:163], v[8:23]
    ds_read_b128 v[136:139], v184 offset:49152
    ds_read_b64_tr_b16 v[144:145], v188 offset:49152
    ds_read_b64_tr_b16 v[146:147], v188 offset:49664
    v_mfma_f32_32x32x16_bf16 v[72:87], v[168:171], v[164:167], v[72:87]
    ds_read_b128 v[140:143], v184 offset:53248
    ds_read_b64_tr_b16 v[148:149], v192 offset:49152
    v_mfma_f32_32x32x16_bf16 v[24:39], v[172:175], v[160:163], v[24:39]
    ds_read_b64_tr_b16 v[150:151], v192 offset:49664
    ds_read_b64_tr_b16 v[152:153], v188 offset:57344
    ds_read_b64_tr_b16 v[154:155], v188 offset:57856
    v_mfma_f32_32x32x16_bf16 v[88:103], v[172:175], v[164:167], v[88:103]
    ds_read_b64_tr_b16 v[156:157], v192 offset:57344
    ds_read_b64_tr_b16 v[158:159], v192 offset:57856
    v_mfma_f32_32x32x16_bf16 v[40:55], v[176:179], v[160:163], v[40:55]
    s_waitcnt vmcnt(0)
    v_cmp_gt_u32 vcc, 16, v5
    s_nop 0
    s_and_b32 s78, vcc_lo, 0xffff
    s_cbranch_scc1 k1_q_c_cw
k1_q_c_cok:
    s_lshl_b32 s78, s72, 2
    s_add_u32 s78, s78, s83
    s_lshl_b32 s78, s78, 8
    s_add_u32 s78, s78, 65536
    buffer_load_dwordx2 v[208:209], v1, s[56:59], s78 offen sc1
    s_lshl_b32 s78, s72, 2
    s_add_u32 s78, s78, s84
    s_lshl_b32 s78, s78, 8
    s_add_u32 s78, s78, 65536
    buffer_load_dwordx2 v[212:213], v1, s[56:59], s78 offen sc1
    v_mfma_f32_32x32x16_bf16 v[104:119], v[176:179], v[164:167], v[104:119]
    v_mfma_f32_32x32x16_bf16 v[56:71], v[180:183], v[160:163], v[56:71]
    v_mfma_f32_32x32x16_bf16 v[120:135], v[180:183], v[164:167], v[120:135]
    s_waitcnt lgkmcnt(0)
    v_mfma_f32_32x32x16_bf16 v[8:23], v[144:147], v[136:139], v[8:23]
    ds_read_b128 v[160:163], v185 offset:49152
    v_lshlrev_b32 v2, 16, v152
    ds_read_b64_tr_b16 v[168:169], v189 offset:49152
    v_and_b32 v3, s86, v152
    v_mfma_f32_32x32x16_bf16 v[72:87], v[144:147], v[140:143], v[72:87]
    ds_read_b64_tr_b16 v[170:171], v189 offset:49664
    v_lshlrev_b32 v6, 16, v156
    ds_read_b128 v[164:167], v185 offset:53248
    v_and_b32 v7, s86, v156
    v_mfma_f32_16x16x32_bf16 v[196:199], v[144:147], v[204:207], v[196:199]
    ds_read_b64_tr_b16 v[172:173], v193 offset:49152
    v_add_f32 v216, v216, v2
    ds_read_b64_tr_b16 v[174:175], v193 offset:49664
    v_mfma_f32_32x32x16_bf16 v[24:39], v[148:151], v[136:139], v[24:39]
    v_add_f32 v217, v217, v3
    ds_read_b64_tr_b16 v[176:177], v189 offset:57344
    v_add_f32 v218, v218, v6
    ds_read_b64_tr_b16 v[178:179], v189 offset:57856
    v_mfma_f32_16x16x32_bf16 v[200:203], v[148:151], v[204:207], v[200:203]
    v_add_f32 v219, v219, v7
    ds_read_b64_tr_b16 v[180:181], v193 offset:57344
    ds_read_b64_tr_b16 v[182:183], v193 offset:57856
    v_mfma_f32_32x32x16_bf16 v[88:103], v[148:151], v[140:143], v[88:103]
    v_lshlrev_b32 v2, 16, v153
    v_and_b32 v3, s86, v153
    v_lshlrev_b32 v6, 16, v157
    v_and_b32 v7, s86, v157
    v_add_f32 v216, v216, v2
    v_mfma_f32_32x32x16_bf16 v[40:55], v[152:155], v[136:139], v[40:55]
    v_add_f32 v217, v217, v3
    v_add_f32 v218, v218, v6
    v_add_f32 v219, v219, v7
    v_lshlrev_b32 v2, 16, v154
    v_and_b32 v3, s86, v154
    v_mfma_f32_32x32x16_bf16 v[104:119], v[152:155], v[140:143], v[104:119]
    v_lshlrev_b32 v6, 16, v158
    v_and_b32 v7, s86, v158
    v_add_f32 v216, v216, v2
    v_add_f32 v217, v217, v3
    v_add_f32 v218, v218, v6
    v_mfma_f32_32x32x16_bf16 v[56:71], v[156:159], v[136:139], v[56:71]
    v_add_f32 v219, v219, v7
    v_lshlrev_b32 v2, 16, v155
    v_and_b32 v3, s86, v155
    v_lshlrev_b32 v6, 16, v159
    v_and_b32 v7, s86, v159
    v_mfma_f32_32x32x16_bf16 v[120:135], v[156:159], v[140:143], v[120:135]
    v_add_f32 v216, v216, v2
    v_add_f32 v217, v217, v3
    v_add_f32 v218, v218, v6
    v_add_f32 v219, v219, v7
    s_waitcnt lgkmcnt(0)
    v_mfma_f32_32x32x16_bf16 v[8:23], v[168:171], v[160:163], v[8:23]
    ds_read_b128 v[136:139], v186 offset:49152
    v_lshlrev_b32 v2, 16, v176
    ds_read_b64_tr_b16 v[144:145], v190 offset:49152
    v_and_b32 v3, s86, v176
    v_mfma_f32_32x32x16_bf16 v[72:87], v[168:171], v[164:167], v[72:87]
    ds_read_b64_tr_b16 v[146:147], v190 offset:49664
    v_lshlrev_b32 v6, 16, v180
    ds_read_b128 v[140:143], v186 offset:53248
    v_and_b32 v7, s86, v180
    v_mfma_f32_16x16x32_bf16 v[196:199], v[168:171], v[204:207], v[196:199]
    ds_read_b64_tr_b16 v[148:149], v194 offset:49152
    v_add_f32 v216, v216, v2
    ds_read_b64_tr_b16 v[150:151], v194 offset:49664
    v_mfma_f32_32x32x16_bf16 v[24:39], v[172:175], v[160:163], v[24:39]
    v_add_f32 v217, v217, v3
    ds_read_b64_tr_b16 v[152:153], v190 offset:57344
    v_add_f32 v218, v218, v6
    ds_read_b64_tr_b16 v[154:155], v190 offset:57856
    v_mfma_f32_16x16x32_bf16 v[200:203], v[172:175], v[204:207], v[200:203]
    v_add_f32 v219, v219, v7
    ds_read_b64_tr_b16 v[156:157], v194 offset:57344
    ds_read_b64_tr_b16 v[158:159], v194 offset:57856
    v_mfma_f32_32x32x16_bf16 v[88:103], v[172:175], v[164:167], v[88:103]
    v_lshlrev_b32 v2, 16, v177
    v_and_b32 v3, s86, v177
    v_lshlrev_b32 v6, 16, v181
    v_and_b32 v7, s86, v181
    v_add_f32 v216, v216, v2
    v_mfma_f32_32x32x16_bf16 v[40:55], v[176:179], v[160:163], v[40:55]
    v_add_f32 v217, v217, v3
    v_add_f32 v218, v218, v6
    v_add_f32 v219, v219, v7
    v_lshlrev_b32 v2, 16, v178
    v_and_b32 v3, s86, v178
    v_mfma_f32_32x32x16_bf16 v[104:119], v[176:179], v[164:167], v[104:119]
    v_lshlrev_b32 v6, 16, v182
    v_and_b32 v7, s86, v182
    v_add_f32 v216, v216, v2
    v_add_f32 v217, v217, v3
    v_add_f32 v218, v218, v6
    v_mfma_f32_32x32x16_bf16 v[56:71], v[180:183], v[160:163], v[56:71]
    v_add_f32 v219, v219, v7
    v_lshlrev_b32 v2, 16, v179
    v_and_b32 v3, s86, v179
    v_lshlrev_b32 v6, 16, v183
    v_and_b32 v7, s86, v183
    v_mfma_f32_32x32x16_bf16 v[120:135], v[180:183], v[164:167], v[120:135]
    v_add_f32 v216, v216, v2
    v_add_f32 v217, v217, v3
    v_add_f32 v218, v218, v6
    v_add_f32 v219, v219, v7
    s_waitcnt lgkmcnt(0)
    v_mfma_f32_32x32x16_bf16 v[8:23], v[144:147], v[136:139], v[8:23]
    ds_read_b128 v[160:163], v187 offset:49152
    ds_read_b64_tr_b16 v[168:169], v191 offset:49152
    ds_read_b64_tr_b16 v[170:171], v191 offset:49664
    ds_read_b128 v[164:167], v187 offset:53248
    ds_read_b64_tr_b16 v[172:173], v195 offset:49152
    ds_read_b64_tr_b16 v[174:175], v195 offset:49664
    v_mfma_f32_32x32x16_bf16 v[72:87], v[144:147], v[140:143], v[72:87]
    ds_read_b64_tr_b16 v[176:177], v191 offset:57344
    ds_read_b64_tr_b16 v[178:179], v191 offset:57856
    ds_read_b64_tr_b16 v[180:181], v195 offset:57344
    ds_read_b64_tr_b16 v[182:183], v195 offset:57856
    v_add_f32 v216, v216, v217
    v_mfma_f32_32x32x16_bf16 v[24:39], v[148:151], v[136:139], v[24:39]
    v_add_f32 v218, v218, v219
    v_mov_b32 v217, v216
    v_mov_b32 v219, v218
    s_nop 0
    v_permlane32_swap_b32 v216, v217
    v_permlane32_swap_b32 v218, v219
    v_add_f32 v216, v216, v217
    v_mfma_f32_32x32x16_bf16 v[88:103], v[148:151], v[140:143], v[88:103]
    v_add_f32 v218, v218, v219
    ds_write_b128 v222, v[196:199] offset:0
    ds_write_b128 v222, v[200:203] offset:512
    ds_write_b32 v221, v216 offset:1024
    ds_write_b32 v221, v218 offset:1536
    s_waitcnt lgkmcnt(0)
    s_barrier
    ds_read_b32 v196, v220 offset:0
    ds_read_b32 v197, v220 offset:128
    ds_read_b32 v200, v220 offset:512
    ds_read_b32 v201, v220 offset:640
    ds_read_b32 v192, v220 offset:1024
    ds_read_b32 v193, v220 offset:1152
    ds_read_b32 v204, v220 offset:1536
    ds_read_b32 v205, v220 offset:1664
    s_waitcnt vmcnt(0)
    s_mov_b32 vcc_lo, -1
    s_mov_b32 vcc_hi, 0
    v_mfma_f32_32x32x16_bf16 v[40:55], v[152:155], v[136:139], v[40:55]
    v_cvt_pk_bf16_f32 v184, v208, v208
    v_cvt_pk_bf16_f32 v188, v212, v212
    v_rsq_f32 v211, v209
    v_rsq_f32 v215, v213
    v_and_b32 v186, s86, v184
    v_mfma_f32_32x32x16_bf16 v[104:119], v[152:155], v[140:143], v[104:119]
    v_and_b32 v190, s86, v188
    v_sub_f32 v186, v208, v186
    v_sub_f32 v190, v212, v190
    v_cvt_pk_bf16_f32 v185, v186, 0
    v_mfma_f32_32x32x16_bf16 v[56:71], v[156:159], v[136:139], v[56:71]
    v_cvt_pk_bf16_f32 v189, v190, 0
    v_cndmask_b32 v184, 0, v184, vcc
    v_cndmask_b32 v188, 0, v188, vcc
    v_cndmask_b32 v185, 0, v185, vcc
    v_cndmask_b32 v189, 0, v189, vcc
    v_mfma_f32_32x32x16_bf16 v[120:135], v[156:159], v[140:143], v[120:135]
    v_mov_b32 v186, 0
    v_mov_b32 v190, 0
    v_mov_b32 v187, 0
    v_mov_b32 v191, 0
    s_waitcnt lgkmcnt(0)
    v_mfma_f32_32x32x16_bf16 v[8:23], v[168:171], v[160:163], v[8:23]
    v_add_f32 v196, v196, v197
    v_add_f32 v200, v200, v201
    v_add_f32 v192, v192, v193
    v_add_f32 v204, v204, v205
    v_cvt_pk_bf16_f32 v197, v196, v196
    v_cvt_pk_bf16_f32 v201, v200, v200
    v_cvt_pk_bf16_f32 v193, v192, v192
    v_cvt_pk_bf16_f32 v205, v204, v204
    v_mfma_f32_32x32x16_bf16 v[72:87], v[168:171], v[164:167], v[72:87]
    v_and_b32 v197, s86, v197
    v_and_b32 v201, s86, v201
    v_and_b32 v193, s86, v193
    v_and_b32 v205, s86, v205
    v_sub_f32 v197, v196, v197
    v_sub_f32 v201, v200, v201
    v_sub_f32 v193, v192, v193
    v_sub_f32 v205, v204, v205
    v_mfma_f32_32x32x16_bf16 v[24:39], v[172:175], v[160:163], v[24:39]
    v_cvt_pk_bf16_f32 v196, v196, v197
    v_cvt_pk_bf16_f32 v200, v200, v201
    v_cvt_pk_bf16_f32 v192, v192, v193
    v_cvt_pk_bf16_f32 v204, v204, v205
    v_mov_b32 v197, v196
    v_mov_b32 v201, v200
    v_mov_b32 v193, v192
    v_mov_b32 v205, v204
    v_mfma_f32_32x32x16_bf16 v[88:103], v[172:175], v[164:167], v[88:103]
    v_mov_b32 v198, 0
    v_mov_b32 v202, 0
    v_mov_b32 v194, 0
    v_mov_b32 v206, 0
    v_mov_b32 v199, 0
    v_mov_b32 v203, 0
    v_mov_b32 v195, 0
    v_mov_b32 v207, 0
    v_mfma_f32_32x32x16_bf16 v[8:23], v[196:199], v[184:187], v[8:23]
    v_mfma_f32_32x32x16_bf16 v[72:87], v[196:199], v[188:191], v[72:87]
    v_mfma_f32_32x32x16_bf16 v[24:39], v[200:203], v[184:187], v[24:39]
    v_mfma_f32_32x32x16_bf16 v[88:103], v[200:203], v[188:191], v[88:103]
    s_nop 8
    v_mul_f32 v8, v8, v211
    v_mul_f32 v9, v9, v211
    v_mul_f32 v10, v10, v211
    v_mul_f32 v11, v11, v211
    v_mul_f32 v12, v12, v211
    v_mul_f32 v13, v13, v211
    v_mul_f32 v14, v14, v211
    v_mul_f32 v15, v15, v211
    v_mul_f32 v16, v16, v211
    v_mul_f32 v17, v17, v211
    v_mul_f32 v18, v18, v211
    v_mul_f32 v19, v19, v211
    v_mul_f32 v20, v20, v211
    v_mul_f32 v21, v21, v211
    v_mul_f32 v22, v22, v211
    v_mul_f32 v23, v23, v211
    v_cvt_pk_bf16_f32 v8, v8, v9
    v_cvt_pk_bf16_f32 v9, v10, v11
    v_cvt_pk_bf16_f32 v10, v12, v13
    v_cvt_pk_bf16_f32 v11, v14, v15
    v_cvt_pk_bf16_f32 v12, v16, v17
    v_cvt_pk_bf16_f32 v13, v18, v19
    v_cvt_pk_bf16_f32 v14, v20, v21
    v_cvt_pk_bf16_f32 v15, v22, v23
    buffer_store_dwordx4 v[8:11], v4, s[40:43], s88 offen offset:0 sc1
    buffer_store_dwordx4 v[12:15], v4, s[40:43], s88 offen offset:1024 sc1
    v_mfma_f32_32x32x16_bf16 v[40:55], v[176:179], v[160:163], v[40:55]
    v_mul_f32 v72, v72, v215
    v_mul_f32 v73, v73, v215
    v_mul_f32 v74, v74, v215
    v_mul_f32 v75, v75, v215
    v_mul_f32 v76, v76, v215
    v_mul_f32 v77, v77, v215
    v_mul_f32 v78, v78, v215
    v_mul_f32 v79, v79, v215
    v_mul_f32 v80, v80, v215
    v_mul_f32 v81, v81, v215
    v_mul_f32 v82, v82, v215
    v_mul_f32 v83, v83, v215
    v_mul_f32 v84, v84, v215
    v_mul_f32 v85, v85, v215
    v_mul_f32 v86, v86, v215
    v_mul_f32 v87, v87, v215
    v_mfma_f32_32x32x16_bf16 v[40:55], v[192:195], v[184:187], v[40:55]
    v_cvt_pk_bf16_f32 v72, v72, v73
    v_cvt_pk_bf16_f32 v73, v74, v75
    v_cvt_pk_bf16_f32 v74, v76, v77
    v_cvt_pk_bf16_f32 v75, v78, v79
    v_cvt_pk_bf16_f32 v76, v80, v81
    v_cvt_pk_bf16_f32 v77, v82, v83
    v_cvt_pk_bf16_f32 v78, v84, v85
    v_cvt_pk_bf16_f32 v79, v86, v87
    buffer_store_dwordx4 v[72:75], v4, s[40:43], s90 offen offset:0 sc1
    buffer_store_dwordx4 v[76:79], v4, s[40:43], s90 offen offset:1024 sc1
    v_mfma_f32_32x32x16_bf16 v[104:119], v[176:179], v[164:167], v[104:119]
    v_mul_f32 v24, v24, v211
    v_mul_f32 v25, v25, v211
    v_mul_f32 v26, v26, v211
    v_mul_f32 v27, v27, v211
    v_mul_f32 v28, v28, v211
    v_mul_f32 v29, v29, v211
    v_mul_f32 v30, v30, v211
    v_mul_f32 v31, v31, v211
    v_mul_f32 v32, v32, v211
    v_mul_f32 v33, v33, v211
    v_mul_f32 v34, v34, v211
    v_mul_f32 v35, v35, v211
    v_mul_f32 v36, v36, v211
    v_mul_f32 v37, v37, v211
    v_mul_f32 v38, v38, v211
    v_mul_f32 v39, v39, v211
    v_mfma_f32_32x32x16_bf16 v[104:119], v[192:195], v[188:191], v[104:119]
    v_cvt_pk_bf16_f32 v24, v24, v25
    v_cvt_pk_bf16_f32 v25, v26, v27
    v_cvt_pk_bf16_f32 v26, v28, v29
    v_cvt_pk_bf16_f32 v27, v30, v31
    v_cvt_pk_bf16_f32 v28, v32, v33
    v_cvt_pk_bf16_f32 v29, v34, v35
    v_cvt_pk_bf16_f32 v30, v36, v37
    v_cvt_pk_bf16_f32 v31, v38, v39
    buffer_store_dwordx4 v[24:27], v4, s[40:43], s88 offen offset:2048 sc1
    buffer_store_dwordx4 v[28:31], v4, s[40:43], s88 offen offset:3072 sc1
    v_mfma_f32_32x32x16_bf16 v[56:71], v[180:183], v[160:163], v[56:71]
    v_mul_f32 v88, v88, v215
    v_mul_f32 v89, v89, v215
    v_mul_f32 v90, v90, v215
    v_mul_f32 v91, v91, v215
    v_mul_f32 v92, v92, v215
    v_mul_f32 v93, v93, v215
    v_mul_f32 v94, v94, v215
    v_mul_f32 v95, v95, v215
    v_mul_f32 v96, v96, v215
    v_mul_f32 v97, v97, v215
    v_mul_f32 v98, v98, v215
    v_mul_f32 v99, v99, v215
    v_mul_f32 v100, v100, v215
    v_mul_f32 v101, v101, v215
    v_mul_f32 v102, v102, v215
    v_mul_f32 v103, v103, v215
    v_mfma_f32_32x32x16_bf16 v[56:71], v[204:207], v[184:187], v[56:71]
    v_cvt_pk_bf16_f32 v88, v88, v89
    v_cvt_pk_bf16_f32 v89, v90, v91
    v_cvt_pk_bf16_f32 v90, v92, v93
    v_cvt_pk_bf16_f32 v91, v94, v95
    v_cvt_pk_bf16_f32 v92, v96, v97
    v_cvt_pk_bf16_f32 v93, v98, v99
    v_cvt_pk_bf16_f32 v94, v100, v101
    v_cvt_pk_bf16_f32 v95, v102, v103
    buffer_store_dwordx4 v[88:91], v4, s[40:43], s90 offen offset:2048 sc1
    buffer_store_dwordx4 v[92:95], v4, s[40:43], s90 offen offset:3072 sc1
    v_mfma_f32_32x32x16_bf16 v[120:135], v[180:183], v[164:167], v[120:135]
    v_mul_f32 v40, v40, v211
    v_mul_f32 v41, v41, v211
    v_mul_f32 v42, v42, v211
    v_mul_f32 v43, v43, v211
    v_mul_f32 v44, v44, v211
    v_mul_f32 v45, v45, v211
    v_mul_f32 v46, v46, v211
    v_mul_f32 v47, v47, v211
    v_mul_f32 v48, v48, v211
    v_mul_f32 v49, v49, v211
    v_mul_f32 v50, v50, v211
    v_mul_f32 v51, v51, v211
    v_mul_f32 v52, v52, v211
    v_mul_f32 v53, v53, v211
    v_mul_f32 v54, v54, v211
    v_mul_f32 v55, v55, v211
    v_mfma_f32_32x32x16_bf16 v[120:135], v[204:207], v[188:191], v[120:135]
    v_cvt_pk_bf16_f32 v40, v40, v41
    v_cvt_pk_bf16_f32 v41, v42, v43
    v_cvt_pk_bf16_f32 v42, v44, v45
    v_cvt_pk_bf16_f32 v43, v46, v47
    v_cvt_pk_bf16_f32 v44, v48, v49
    v_cvt_pk_bf16_f32 v45, v50, v51
    v_cvt_pk_bf16_f32 v46, v52, v53
    v_cvt_pk_bf16_f32 v47, v54, v55
    buffer_store_dwordx4 v[40:43], v4, s[40:43], s89 offen offset:0 sc1
    buffer_store_dwordx4 v[44:47], v4, s[40:43], s89 offen offset:1024 sc1
    v_mul_f32 v104, v104, v215
    v_mul_f32 v105, v105, v215
    v_mul_f32 v106, v106, v215
    v_mul_f32 v107, v107, v215
    v_mul_f32 v108, v108, v215
    v_mul_f32 v109, v109, v215
    v_mul_f32 v110, v110, v215
    v_mul_f32 v111, v111, v215
    v_mul_f32 v112, v112, v215
    v_mul_f32 v113, v113, v215
    v_mul_f32 v114, v114, v215
    v_mul_f32 v115, v115, v215
    v_mul_f32 v116, v116, v215
    v_mul_f32 v117, v117, v215
    v_mul_f32 v118, v118, v215
    v_mul_f32 v119, v119, v215
    v_cvt_pk_bf16_f32 v104, v104, v105
    v_cvt_pk_bf16_f32 v105, v106, v107
    v_cvt_pk_bf16_f32 v106, v108, v109
    v_cvt_pk_bf16_f32 v107, v110, v111
    v_cvt_pk_bf16_f32 v108, v112, v113
    v_cvt_pk_bf16_f32 v109, v114, v115
    v_cvt_pk_bf16_f32 v110, v116, v117
    v_cvt_pk_bf16_f32 v111, v118, v119
    buffer_store_dwordx4 v[104:107], v4, s[40:43], s91 offen offset:0 sc1
    buffer_store_dwordx4 v[108:111], v4, s[40:43], s91 offen offset:1024 sc1
    v_mul_f32 v56, v56, v211
    v_mul_f32 v57, v57, v211
    v_mul_f32 v58, v58, v211
    v_mul_f32 v59, v59, v211
    v_mul_f32 v60, v60, v211
    v_mul_f32 v61, v61, v211
    v_mul_f32 v62, v62, v211
    v_mul_f32 v63, v63, v211
    v_mul_f32 v64, v64, v211
    v_mul_f32 v65, v65, v211
    v_mul_f32 v66, v66, v211
    v_mul_f32 v67, v67, v211
    v_mul_f32 v68, v68, v211
    v_mul_f32 v69, v69, v211
    v_mul_f32 v70, v70, v211
    v_mul_f32 v71, v71, v211
    v_cvt_pk_bf16_f32 v56, v56, v57
    v_cvt_pk_bf16_f32 v57, v58, v59
    v_cvt_pk_bf16_f32 v58, v60, v61
    v_cvt_pk_bf16_f32 v59, v62, v63
    v_cvt_pk_bf16_f32 v60, v64, v65
    v_cvt_pk_bf16_f32 v61, v66, v67
    v_cvt_pk_bf16_f32 v62, v68, v69
    v_cvt_pk_bf16_f32 v63, v70, v71
    buffer_store_dwordx4 v[56:59], v4, s[40:43], s89 offen offset:2048 sc1
    buffer_store_dwordx4 v[60:63], v4, s[40:43], s89 offen offset:3072 sc1
    v_mul_f32 v120, v120, v215
    v_mul_f32 v121, v121, v215
    v_mul_f32 v122, v122, v215
    v_mul_f32 v123, v123, v215
    v_mul_f32 v124, v124, v215
    v_mul_f32 v125, v125, v215
    v_mul_f32 v126, v126, v215
    v_mul_f32 v127, v127, v215
    v_mul_f32 v128, v128, v215
    v_mul_f32 v129, v129, v215
    v_mul_f32 v130, v130, v215
    v_mul_f32 v131, v131, v215
    v_mul_f32 v132, v132, v215
    v_mul_f32 v133, v133, v215
    v_mul_f32 v134, v134, v215
    v_mul_f32 v135, v135, v215
    v_cvt_pk_bf16_f32 v120, v120, v121
    v_cvt_pk_bf16_f32 v121, v122, v123
    v_cvt_pk_bf16_f32 v122, v124, v125
    v_cvt_pk_bf16_f32 v123, v126, v127
    v_cvt_pk_bf16_f32 v124, v128, v129
    v_cvt_pk_bf16_f32 v125, v130, v131
    v_cvt_pk_bf16_f32 v126, v132, v133
    v_cvt_pk_bf16_f32 v127, v134, v135
    buffer_store_dwordx4 v[120:123], v4, s[40:43], s91 offen offset:2048 sc1
    buffer_store_dwordx4 v[124:127], v4, s[40:43], s91 offen offset:3072 sc1
    v_mov_b32 v6, 1
    s_waitcnt vmcnt(0)
    s_mov_b64 exec, 1
    buffer_store_dword v6, off, s[56:59], s3 sc1
    s_mov_b64 exec, -1
    s_branch p2_gemm
k1_q_c_cw:
    s_mov_b32 s98, 0
k1_q_c_cl:
    s_sleep 4
    buffer_load_dword v5, v4, s[64:67], 0 offen sc1
    s_waitcnt vmcnt(0)
    v_cmp_gt_u32 vcc, 16, v5
    s_add_u32 s98, s98, 1
    s_cmp_gt_u32 s98, 0x8000
    s_cbranch_scc1 k1_q_c_cok
    s_and_b32 s78, vcc_lo, 0xffff
    s_cbranch_scc1 k1_q_c_cl
    s_branch k1_q_c_cok
k_end:
    s_endpgm
.fill 20000, 4, 0xbf810000
.section .rodata,"a"
.p2align 6
.amdhsa_kernel parallel_sum__linear_kernel_hedgehog__glu_gated_swiglu__prompt_kernel
  .amdhsa_next_free_vgpr 256
  .amdhsa_next_free_sgpr 102
  .amdhsa_accum_offset 256
  .amdhsa_group_segment_fixed_size 0
  .amdhsa_kernarg_size 88
  .amdhsa_user_sgpr_count 2
  .amdhsa_user_sgpr_kernarg_segment_ptr 1
  .amdhsa_system_sgpr_workgroup_id_x 1
.end_amdhsa_kernel
```
